```python
import torch

def _softmax(x, axis=-1):
    return torch.softmax(x, dim=axis)
def _gelu(x):
    return torch.nn.functional.gelu(x, approximate="tanh")
def _silu(x):
    return torch.nn.functional.silu(x)
def _sigmoid(x):
    return torch.sigmoid(x)
def _layernorm(x, axis=-1, eps=1e-5):
    m = x.mean(dim=axis, keepdim=True)
    v = x.var(dim=axis, keepdim=True, unbiased=False)
    return (x - m) / torch.sqrt(v + eps)
def _scatter_add(tgt, idx, src, axis=0):
    return tgt.clone().index_add_(axis, idx, src)
def _segment_sum(src, seg, n):
    out = torch.zeros((n,) + src.shape[1:], dtype=src.dtype)
    return out.index_add_(0, seg, src)
def _pad(x, pw):
    flat = tuple(v for pair in reversed(pw) for v in pair)
    return torch.nn.functional.pad(x, flat)

kernel_name = 'recurrent_scan__spectral_gfnet__dense_activation_relu__prompt'

def setup_inputs():

    _w = (lambda a: (lambda t: t.to(torch.bfloat16) if t.is_floating_point() else t)(torch.as_tensor(a)))
    def _A_setup():
        B, S, D = 1, 2048, 448
        Df = D // 2 + 1
        return {
            "x": _w((lambda *s: torch.randn(*s, dtype=torch.bfloat16) * 0.05)(B, S, D)),
            "w_r": _w((lambda *s: torch.randn(*s, dtype=torch.bfloat16) * 0.1)(S, Df) * 0.02),
            "w_i": _w((lambda *s: torch.randn(*s, dtype=torch.bfloat16) * 0.1)(S, Df) * 0.02),
        }
    _A_in = _A_setup()

    def _B_setup():
        B, S, D, Dff = 1, 2048, 448, 1792
        return {
            "x": _w((lambda *s: torch.randn(*s, dtype=torch.bfloat16) * 0.05)(B, S, D)),
            "w1": _w((lambda *s: torch.randn(*s, dtype=torch.bfloat16) * 0.05)(D, Dff)),
            "w2": _w((lambda *s: torch.randn(*s, dtype=torch.bfloat16) * 0.05)(Dff, D)),
        }
    _B_in = _B_setup()

    return {
        "A_x": _A_in["x"],
        "A_w_r": _A_in["w_r"],
        "A_w_i": _A_in["w_i"],
        "B_x": _B_in["x"],
        "B_w1": _B_in["w1"],
        "B_w2": _B_in["w2"],
    }

def reference(A_x, A_w_r, A_w_i, B_x, B_w1, B_w2):
    def _A_ref(x, w_r, w_i):
        B, S, D = x.shape
        X = (lambda x, axes=(-2,-1): torch.fft.rfft2(x.float(), dim=axes))(x, axes=(-2, -1))
        W = w_r + 1j * w_i
        X = X * W
        y = (lambda x, s, axes=(-2,-1): torch.fft.irfft2(x, s=s, dim=axes).to(torch.bfloat16))(X, (S, D), axes=(-2, -1))
        return y

    def _B_ref(x, w1, w2):
        h = torch.einsum("bsd,df->bsf", x, w1)
        zero = torch.zeros_like(h)
        h = torch.maximum(h, zero)
        return torch.einsum("bsf,fd->bsd", h, w2)

    x = A_x
    xn = _layernorm(x, axis=-1)
    s = _A_ref(xn, A_w_r, A_w_i)
    g = _silu(_B_ref(xn, B_w1, B_w2))
    return x + s * g
```

```asm
; @launch kernel=k1_kernel grid=(256,1,1) block=(512,1,1) lds=160768
; @launch kernel=k2_kernel grid=(449,1,1) block=(256,1,1) lds=69632
.amdgcn_target "amdgcn-amd-amdhsa--gfx950"
.text
.globl k1_kernel
.p2align 8
.type k1_kernel,@function
k1_kernel:
  s_cmp_ge_u32 s2, 256
  s_cbranch_scc1 k1_end
  s_load_dwordx2 s[4:5], s[0:1], 0
  s_load_dwordx4 s[8:11], s[0:1], 8
  s_load_dwordx4 s[40:43], s[0:1], 32
  s_load_dwordx2 s[12:13], s[0:1], 64
  v_lshrrev_b32 v1, 6, v0
  v_and_b32 v0, 63, v0
  s_nop 0
  v_readfirstlane_b32 s3, v1
  s_getpc_b64 s[20:21]
  s_add_u32 s20, s20, tabF@rel32@lo+4
  s_addc_u32 s21, s21, tabF@rel32@hi+12
  s_cmp_ge_u32 s2, 224
  s_cbranch_scc1 k1_prep
  s_and_b32 s14, s2, 7
  s_lshr_b32 s15, s2, 3
  s_lshr_b32 s16, s14, 1
  s_lshl_b32 s16, s16, 2
  s_and_b32 s17, s15, 3
  s_add_u32 s16, s16, s17
  s_and_b32 s14, s14, 1
  s_mul_i32 s14, s14, 7
  s_lshr_b32 s15, s15, 2
  s_add_u32 s17, s14, s15
  s_mul_i32 s18, s17, 160
  s_and_b32 s15, s3, 3
  s_lshl_b32 s19, s16, 2
  s_add_u32 s19, s19, s15
  s_cmp_lt_u32 s3, 4
  s_cbranch_scc1 k1_comp
  v_lshrrev_b32 v4, 3, v0
  v_lshrrev_b32 v5, 4, v0
  v_and_b32 v6, 7, v0
  s_lshl_b32 s22, s19, 5
  v_add_u32 v7, s22, v4
  v_mul_u32_u24 v7, 896, v7
  v_xor_b32 v8, v6, v5
  v_lshl_add_u32 v2, v8, 4, v7
  v_xor_b32 v8, 4, v8
  v_lshl_add_u32 v3, v8, 4, v7
  v_add_u32 v3, 7168, v3
  s_lshl_b32 s28, s15, 12
  s_lshl_b32 s29, s15, 11
  s_lshl_b32 s30, s15, 10
  s_movk_i32 s44, 896
  s_movk_i32 s45, 3584
  s_lshl_b32 s46, s18, 1
  s_sub_u32 s47, s46, 896
  s_cmp_le_u32 s17, 2
  s_cselect_b32 s48, s44, s45
  s_cselect_b32 s49, s46, s47
  s_cmp_le_u32 s17, 1
  s_cselect_b32 s50, s44, s45
  s_cselect_b32 s51, s46, s47
  s_add_u32 s51, s51, 256
  v_and_b32 v5, 1, v5
  v_lshlrev_b32 v5, 2, v5
  v_xor_b32 v5, v5, v6
  v_mul_u32_u24 v4, s48, v4
  v_lshl_add_u32 v4, v5, 4, v4
  v_lshrrev_b32 v5, 2, v0
  v_mul_u32_u24 v5, s50, v5
  v_and_b32 v6, 3, v0
  v_lshl_add_u32 v5, v6, 4, v5
  s_lshl_b32 s22, s15, 4
  s_mul_i32 s23, s22, s48
  s_add_u32 s49, s49, s23
  s_mul_i32 s23, s22, s50
  s_add_u32 s51, s51, s23
  s_lshl_b32 s52, s48, 3
  s_lshl_b32 s48, s48, 6
  s_lshl_b32 s50, s50, 6
  s_add_u32 s53, s49, 128
  s_waitcnt lgkmcnt(0)
  s_mov_b32 s24, s4
  s_mov_b32 s25, s5
  s_mov_b32 s26, 0x1c0000
  s_mov_b32 s27, 0x20000
  s_cmp_le_u32 s17, 2
  s_cselect_b32 s32, s20, s40
  s_cselect_b32 s33, s21, s41
  s_mov_b32 s34, 1605632
  s_cselect_b32 s34, 401408, s34
  s_mov_b32 s35, 0x20000
  s_cmp_le_u32 s17, 1
  s_cselect_b32 s36, s20, s40
  s_cselect_b32 s37, s21, s41
  s_mov_b32 s38, 1605632
  s_cselect_b32 s38, 401408, s38
  s_mov_b32 s39, 0x20000
  s_add_u32 m0, s28, 0
  s_mov_b32 s31, 0
  buffer_load_dwordx4 v2, s[24:27], s31 offen lds
  s_add_u32 m0, s28, 1024
  s_mov_b32 s31, 0
  buffer_load_dwordx4 v3, s[24:27], s31 offen lds
  s_add_u32 m0, s28, 2048
  s_mov_b32 s31, 14336
  buffer_load_dwordx4 v2, s[24:27], s31 offen lds
  s_add_u32 m0, s28, 3072
  s_mov_b32 s31, 14336
  buffer_load_dwordx4 v3, s[24:27], s31 offen lds
  s_add_u32 m0, s29, 114688
  s_add_u32 s31, s49, s52
  buffer_load_dwordx4 v4, s[32:35], s49 offen lds
  s_add_u32 m0, s29, 115712
  s_add_u32 s49, s49, s48
  buffer_load_dwordx4 v4, s[32:35], s31 offen lds
  s_add_u32 m0, s28, 16384
  s_mov_b32 s31, 128
  buffer_load_dwordx4 v2, s[24:27], s31 offen lds
  s_add_u32 m0, s28, 17408
  s_mov_b32 s31, 128
  buffer_load_dwordx4 v3, s[24:27], s31 offen lds
  s_add_u32 m0, s28, 18432
  s_mov_b32 s31, 14464
  buffer_load_dwordx4 v2, s[24:27], s31 offen lds
  s_add_u32 m0, s28, 19456
  s_mov_b32 s31, 14464
  buffer_load_dwordx4 v3, s[24:27], s31 offen lds
  s_add_u32 m0, s29, 122880
  s_add_u32 s31, s49, s52
  buffer_load_dwordx4 v4, s[32:35], s49 offen lds
  s_add_u32 m0, s29, 123904
  s_add_u32 s49, s49, s48
  buffer_load_dwordx4 v4, s[32:35], s31 offen lds
  s_add_u32 m0, s28, 32768
  s_mov_b32 s31, 256
  buffer_load_dwordx4 v2, s[24:27], s31 offen lds
  s_add_u32 m0, s28, 33792
  s_mov_b32 s31, 256
  buffer_load_dwordx4 v3, s[24:27], s31 offen lds
  s_add_u32 m0, s28, 34816
  s_mov_b32 s31, 14592
  buffer_load_dwordx4 v2, s[24:27], s31 offen lds
  s_add_u32 m0, s28, 35840
  s_mov_b32 s31, 14592
  buffer_load_dwordx4 v3, s[24:27], s31 offen lds
  s_add_u32 m0, s29, 131072
  s_add_u32 s31, s49, s52
  buffer_load_dwordx4 v4, s[32:35], s49 offen lds
  s_add_u32 m0, s29, 132096
  s_add_u32 s49, s49, s48
  buffer_load_dwordx4 v4, s[32:35], s31 offen lds
  v_lshrrev_b32 v40, 5, v0
  v_and_b32 v41, 15, v0
  v_lshrrev_b32 v41, 2, v41
  v_lshl_add_u32 v42, v40, 3, v41
  v_lshrrev_b32 v43, 1, v41
  v_lshlrev_b32 v43, 2, v43
  v_lshrrev_b32 v44, 3, v0
  v_and_b32 v44, 2, v44
  v_or_b32 v43, v43, v44
  v_lshrrev_b32 v45, 1, v0
  v_and_b32 v45, 1, v45
  v_or_b32 v43, v43, v45
  v_lshlrev_b32 v43, 4, v43
  v_lshl_add_u32 v43, v42, 7, v43
  v_and_b32 v45, 1, v0
  v_lshl_add_u32 v8, v45, 3, v43
  v_xor_b32 v9, 64, v8
  v_add_u32 v6, 114688, v8
  v_add_u32 v7, 114688, v9
  v_add_u32 v10, 65536, v8
  v_add_u32 v11, 65536, v9
  v_lshlrev_b32 v42, 6, v42
  v_lshl_add_u32 v42, v44, 4, v42
  v_and_b32 v45, 3, v0
  v_lshl_add_u32 v42, v45, 3, v42
  v_add_u32 v12, 8192, v42
  v_add_u32 v13, 65536, v12
  s_lshl_b32 s31, s15, 11
  v_add_u32 v6, s31, v6
  v_add_u32 v7, s31, v7
  v_add_u32 v8, s31, v8
  v_add_u32 v9, s31, v9
  v_add_u32 v10, s31, v10
  v_add_u32 v11, s31, v11
  v_add_u32 v12, s30, v12
  v_add_u32 v13, s30, v13
  v_mov_b32 v14, 0x3f803f80
  v_mov_b32 v15, 0x3f803f80
  v_and_b32 v60, 31, v0
  v_lshrrev_b32 v61, 5, v0
  v_lshlrev_b32 v60, 5, v60
  v_lshl_add_u32 v60, v61, 2, v60
  s_lshl_b32 s31, s15, 3
  v_add_u32 v60, s31, v60
  v_add_u32 v60, 155648, v60
  v_mov_b32 v16, 0
  v_mov_b32 v17, 0
  v_mov_b32 v18, 0
  v_mov_b32 v19, 0
  v_mov_b32 v20, 0
  v_mov_b32 v21, 0
  v_mov_b32 v22, 0
  v_mov_b32 v23, 0
  v_mov_b32 v24, 0
  v_mov_b32 v25, 0
  v_mov_b32 v26, 0
  v_mov_b32 v27, 0
  v_mov_b32 v28, 0
  v_mov_b32 v29, 0
  v_mov_b32 v30, 0
  v_mov_b32 v31, 0
  v_mov_b32 v32, 0
  v_mov_b32 v33, 0
  v_mov_b32 v34, 0
  v_mov_b32 v35, 0
  s_waitcnt vmcnt(12)
  s_barrier
  ds_read_b64_tr_b16 v[64:65], v6 offset:0
  ds_read_b64_tr_b16 v[66:67], v6 offset:512
  ds_read_b64_tr_b16 v[68:69], v7 offset:0
  ds_read_b64_tr_b16 v[70:71], v7 offset:512
  s_add_u32 m0, s28, 49152
  s_mov_b32 s31, 384
  buffer_load_dwordx4 v2, s[24:27], s31 offen lds
  s_add_u32 m0, s28, 50176
  s_mov_b32 s31, 384
  buffer_load_dwordx4 v3, s[24:27], s31 offen lds
  s_add_u32 m0, s28, 51200
  s_mov_b32 s31, 14720
  buffer_load_dwordx4 v2, s[24:27], s31 offen lds
  s_add_u32 m0, s28, 52224
  s_mov_b32 s31, 14720
  buffer_load_dwordx4 v3, s[24:27], s31 offen lds
  s_add_u32 m0, s29, 139264
  s_add_u32 s31, s49, s52
  buffer_load_dwordx4 v4, s[32:35], s49 offen lds
  s_add_u32 m0, s29, 140288
  s_add_u32 s49, s49, s48
  buffer_load_dwordx4 v4, s[32:35], s31 offen lds
  s_waitcnt lgkmcnt(0)
  v_mfma_f32_4x4x4_16b_bf16 v[16:19], v[14:15], v[64:65], v[16:19]
  v_mfma_f32_4x4x4_16b_bf16 v[20:23], v[14:15], v[68:69], v[20:23]
  s_nop 0
  v_mfma_f32_4x4x4_16b_bf16 v[16:19], v[14:15], v[66:67], v[16:19]
  v_mfma_f32_4x4x4_16b_bf16 v[20:23], v[14:15], v[70:71], v[20:23]
  s_nop 0
  s_waitcnt vmcnt(12)
  s_barrier
  ds_read_b64_tr_b16 v[64:65], v6 offset:8192
  ds_read_b64_tr_b16 v[66:67], v6 offset:8704
  ds_read_b64_tr_b16 v[68:69], v7 offset:8192
  ds_read_b64_tr_b16 v[70:71], v7 offset:8704
  s_add_u32 m0, s28, 65536
  s_mov_b32 s31, 512
  buffer_load_dwordx4 v2, s[24:27], s31 offen lds
  s_add_u32 m0, s28, 66560
  s_mov_b32 s31, 512
  buffer_load_dwordx4 v3, s[24:27], s31 offen lds
  s_add_u32 m0, s28, 67584
  s_mov_b32 s31, 14848
  buffer_load_dwordx4 v2, s[24:27], s31 offen lds
  s_add_u32 m0, s28, 68608
  s_mov_b32 s31, 14848
  buffer_load_dwordx4 v3, s[24:27], s31 offen lds
  s_add_u32 m0, s29, 147456
  s_add_u32 s31, s49, s52
  buffer_load_dwordx4 v4, s[32:35], s49 offen lds
  s_add_u32 m0, s29, 148480
  s_add_u32 s49, s49, s48
  buffer_load_dwordx4 v4, s[32:35], s31 offen lds
  s_add_u32 m0, s29, 0
  s_add_u32 s31, s53, s52
  buffer_load_dwordx4 v4, s[32:35], s53 offen lds
  s_add_u32 m0, s29, 1024
  s_add_u32 s53, s53, s48
  buffer_load_dwordx4 v4, s[32:35], s31 offen lds
  s_waitcnt lgkmcnt(0)
  v_mfma_f32_4x4x4_16b_bf16 v[16:19], v[14:15], v[64:65], v[16:19]
  v_mfma_f32_4x4x4_16b_bf16 v[20:23], v[14:15], v[68:69], v[20:23]
  s_nop 0
  v_mfma_f32_4x4x4_16b_bf16 v[16:19], v[14:15], v[66:67], v[16:19]
  v_mfma_f32_4x4x4_16b_bf16 v[20:23], v[14:15], v[70:71], v[20:23]
  s_nop 0
  s_waitcnt vmcnt(14)
  s_barrier
  ds_read_b64_tr_b16 v[64:65], v6 offset:16384
  ds_read_b64_tr_b16 v[66:67], v6 offset:16896
  ds_read_b64_tr_b16 v[68:69], v7 offset:16384
  ds_read_b64_tr_b16 v[70:71], v7 offset:16896
  s_add_u32 m0, s28, 81920
  s_mov_b32 s31, 640
  buffer_load_dwordx4 v2, s[24:27], s31 offen lds
  s_add_u32 m0, s28, 82944
  s_mov_b32 s31, 640
  buffer_load_dwordx4 v3, s[24:27], s31 offen lds
  s_add_u32 m0, s28, 83968
  s_mov_b32 s31, 14976
  buffer_load_dwordx4 v2, s[24:27], s31 offen lds
  s_add_u32 m0, s28, 84992
  s_mov_b32 s31, 14976
  buffer_load_dwordx4 v3, s[24:27], s31 offen lds
  s_add_u32 m0, s29, 114688
  s_add_u32 s31, s49, s52
  buffer_load_dwordx4 v4, s[32:35], s49 offen lds
  s_add_u32 m0, s29, 115712
  s_add_u32 s49, s49, s48
  buffer_load_dwordx4 v4, s[32:35], s31 offen lds
  s_add_u32 m0, s29, 16384
  s_add_u32 s31, s53, s52
  buffer_load_dwordx4 v4, s[32:35], s53 offen lds
  s_add_u32 m0, s29, 17408
  s_add_u32 s53, s53, s48
  buffer_load_dwordx4 v4, s[32:35], s31 offen lds
  s_waitcnt lgkmcnt(0)
  v_mfma_f32_4x4x4_16b_bf16 v[16:19], v[14:15], v[64:65], v[16:19]
  v_mfma_f32_4x4x4_16b_bf16 v[20:23], v[14:15], v[68:69], v[20:23]
  s_nop 0
  v_mfma_f32_4x4x4_16b_bf16 v[16:19], v[14:15], v[66:67], v[16:19]
  v_mfma_f32_4x4x4_16b_bf16 v[20:23], v[14:15], v[70:71], v[20:23]
  s_nop 0
  s_waitcnt vmcnt(16)
  s_barrier
  ds_read_b64_tr_b16 v[64:65], v6 offset:24576
  ds_read_b64_tr_b16 v[66:67], v6 offset:25088
  ds_read_b64_tr_b16 v[68:69], v7 offset:24576
  ds_read_b64_tr_b16 v[70:71], v7 offset:25088
  s_add_u32 m0, s28, 98304
  s_mov_b32 s31, 768
  buffer_load_dwordx4 v2, s[24:27], s31 offen lds
  s_add_u32 m0, s28, 99328
  s_mov_b32 s31, 768
  buffer_load_dwordx4 v3, s[24:27], s31 offen lds
  s_add_u32 m0, s28, 100352
  s_mov_b32 s31, 15104
  buffer_load_dwordx4 v2, s[24:27], s31 offen lds
  s_add_u32 m0, s28, 101376
  s_mov_b32 s31, 15104
  buffer_load_dwordx4 v3, s[24:27], s31 offen lds
  s_add_u32 m0, s29, 122880
  s_add_u32 s31, s49, s52
  buffer_load_dwordx4 v4, s[32:35], s49 offen lds
  s_add_u32 m0, s29, 123904
  s_add_u32 s49, s49, s48
  buffer_load_dwordx4 v4, s[32:35], s31 offen lds
  s_add_u32 m0, s29, 32768
  s_add_u32 s31, s53, s52
  buffer_load_dwordx4 v4, s[32:35], s53 offen lds
  s_add_u32 m0, s29, 33792
  s_add_u32 s53, s53, s48
  buffer_load_dwordx4 v4, s[32:35], s31 offen lds
  s_waitcnt lgkmcnt(0)
  v_mfma_f32_4x4x4_16b_bf16 v[16:19], v[14:15], v[64:65], v[16:19]
  v_mfma_f32_4x4x4_16b_bf16 v[20:23], v[14:15], v[68:69], v[20:23]
  s_nop 0
  v_mfma_f32_4x4x4_16b_bf16 v[16:19], v[14:15], v[66:67], v[16:19]
  v_mfma_f32_4x4x4_16b_bf16 v[20:23], v[14:15], v[70:71], v[20:23]
  s_nop 0
  s_waitcnt vmcnt(18)
  s_barrier
  ds_read_b64_tr_b16 v[64:65], v6 offset:32768
  ds_read_b64_tr_b16 v[66:67], v6 offset:33280
  ds_read_b64_tr_b16 v[68:69], v7 offset:32768
  ds_read_b64_tr_b16 v[70:71], v7 offset:33280
  s_add_u32 m0, s29, 49152
  s_add_u32 s31, s53, s52
  buffer_load_dwordx4 v4, s[32:35], s53 offen lds
  s_add_u32 m0, s29, 50176
  s_add_u32 s53, s53, s48
  buffer_load_dwordx4 v4, s[32:35], s31 offen lds
  s_waitcnt lgkmcnt(0)
  v_mfma_f32_4x4x4_16b_bf16 v[16:19], v[14:15], v[64:65], v[16:19]
  v_mfma_f32_4x4x4_16b_bf16 v[20:23], v[14:15], v[68:69], v[20:23]
  s_nop 0
  v_mfma_f32_4x4x4_16b_bf16 v[16:19], v[14:15], v[66:67], v[16:19]
  v_mfma_f32_4x4x4_16b_bf16 v[20:23], v[14:15], v[70:71], v[20:23]
  s_nop 0
  s_waitcnt vmcnt(12)
  s_barrier
  ds_read_b64_tr_b16 v[64:65], v6 offset:0
  ds_read_b64_tr_b16 v[66:67], v6 offset:512
  ds_read_b64_tr_b16 v[68:69], v7 offset:0
  ds_read_b64_tr_b16 v[70:71], v7 offset:512
  s_add_u32 m0, s29, 65536
  s_add_u32 s31, s53, s52
  buffer_load_dwordx4 v4, s[32:35], s53 offen lds
  s_add_u32 m0, s29, 66560
  s_add_u32 s53, s53, s48
  buffer_load_dwordx4 v4, s[32:35], s31 offen lds
  s_waitcnt lgkmcnt(0)
  v_mfma_f32_4x4x4_16b_bf16 v[16:19], v[14:15], v[64:65], v[16:19]
  v_mfma_f32_4x4x4_16b_bf16 v[20:23], v[14:15], v[68:69], v[20:23]
  s_nop 0
  v_mfma_f32_4x4x4_16b_bf16 v[16:19], v[14:15], v[66:67], v[16:19]
  v_mfma_f32_4x4x4_16b_bf16 v[20:23], v[14:15], v[70:71], v[20:23]
  s_nop 0
  s_waitcnt vmcnt(6)
  s_barrier
  ds_read_b64_tr_b16 v[64:65], v6 offset:8192
  ds_read_b64_tr_b16 v[66:67], v6 offset:8704
  ds_read_b64_tr_b16 v[68:69], v7 offset:8192
  ds_read_b64_tr_b16 v[70:71], v7 offset:8704
  s_add_u32 m0, s29, 81920
  s_add_u32 s31, s53, s52
  buffer_load_dwordx4 v4, s[32:35], s53 offen lds
  s_add_u32 m0, s29, 82944
  s_add_u32 s53, s53, s48
  buffer_load_dwordx4 v4, s[32:35], s31 offen lds
  s_waitcnt lgkmcnt(0)
  v_mfma_f32_4x4x4_16b_bf16 v[16:19], v[14:15], v[64:65], v[16:19]
  v_mfma_f32_4x4x4_16b_bf16 v[20:23], v[14:15], v[68:69], v[20:23]
  s_nop 0
  v_mfma_f32_4x4x4_16b_bf16 v[16:19], v[14:15], v[66:67], v[16:19]
  v_mfma_f32_4x4x4_16b_bf16 v[20:23], v[14:15], v[70:71], v[20:23]
  s_nop 0
  s_nop 7
  ds_write_b32 v60, v16 offset:0
  ds_write_b32 v60, v20 offset:1024
  s_waitcnt lgkmcnt(0)
  s_waitcnt vmcnt(14)
  s_barrier
  s_add_u32 m0, s29, 98304
  s_add_u32 s31, s53, s52
  buffer_load_dwordx4 v4, s[32:35], s53 offen lds
  s_add_u32 m0, s29, 99328
  s_add_u32 s53, s53, s48
  buffer_load_dwordx4 v4, s[32:35], s31 offen lds
  s_add_u32 m0, s30, 8192
  s_nop 0
  buffer_load_dwordx4 v5, s[36:39], s51 offen lds
  s_add_u32 s51, s51, s50
  s_add_u32 m0, s30, 24576
  s_nop 0
  buffer_load_dwordx4 v5, s[36:39], s51 offen lds
  s_add_u32 s51, s51, s50
  s_add_u32 m0, s30, 40960
  s_nop 0
  buffer_load_dwordx4 v5, s[36:39], s51 offen lds
  s_add_u32 s51, s51, s50
  s_add_u32 m0, s30, 57344
  s_nop 0
  buffer_load_dwordx4 v5, s[36:39], s51 offen lds
  s_add_u32 s51, s51, s50
  s_add_u32 m0, s30, 73728
  s_nop 0
  buffer_load_dwordx4 v5, s[36:39], s51 offen lds
  s_add_u32 s51, s51, s50
  s_add_u32 m0, s30, 90112
  s_nop 0
  buffer_load_dwordx4 v5, s[36:39], s51 offen lds
  s_add_u32 s51, s51, s50
  s_add_u32 m0, s30, 106496
  s_nop 0
  buffer_load_dwordx4 v5, s[36:39], s51 offen lds
  s_add_u32 s51, s51, s50
  ds_read_b64_tr_b16 v[64:65], v8 offset:0
  ds_read_b64_tr_b16 v[66:67], v8 offset:512
  ds_read_b64_tr_b16 v[68:69], v9 offset:0
  ds_read_b64_tr_b16 v[70:71], v9 offset:512
  ds_read_b64_tr_b16 v[72:73], v8 offset:16384
  ds_read_b64_tr_b16 v[74:75], v8 offset:16896
  ds_read_b64_tr_b16 v[76:77], v9 offset:16384
  ds_read_b64_tr_b16 v[78:79], v9 offset:16896
  s_waitcnt lgkmcnt(0)
  v_mfma_f32_4x4x4_16b_bf16 v[24:27], v[14:15], v[64:65], v[24:27]
  v_mfma_f32_4x4x4_16b_bf16 v[28:31], v[14:15], v[68:69], v[28:31]
  s_nop 0
  v_mfma_f32_4x4x4_16b_bf16 v[24:27], v[14:15], v[66:67], v[24:27]
  v_mfma_f32_4x4x4_16b_bf16 v[28:31], v[14:15], v[70:71], v[28:31]
  s_nop 0
  v_mfma_f32_4x4x4_16b_bf16 v[24:27], v[14:15], v[72:73], v[24:27]
  v_mfma_f32_4x4x4_16b_bf16 v[28:31], v[14:15], v[76:77], v[28:31]
  s_nop 0
  v_mfma_f32_4x4x4_16b_bf16 v[24:27], v[14:15], v[74:75], v[24:27]
  v_mfma_f32_4x4x4_16b_bf16 v[28:31], v[14:15], v[78:79], v[28:31]
  s_nop 0
  s_waitcnt vmcnt(13)
  s_barrier
  ds_read_b64_tr_b16 v[64:65], v8 offset:32768
  ds_read_b64_tr_b16 v[66:67], v8 offset:33280
  ds_read_b64_tr_b16 v[68:69], v9 offset:32768
  ds_read_b64_tr_b16 v[70:71], v9 offset:33280
  ds_read_b64_tr_b16 v[72:73], v8 offset:49152
  ds_read_b64_tr_b16 v[74:75], v8 offset:49664
  ds_read_b64_tr_b16 v[76:77], v9 offset:49152
  ds_read_b64_tr_b16 v[78:79], v9 offset:49664
  s_waitcnt lgkmcnt(0)
  v_mfma_f32_4x4x4_16b_bf16 v[24:27], v[14:15], v[64:65], v[24:27]
  v_mfma_f32_4x4x4_16b_bf16 v[28:31], v[14:15], v[68:69], v[28:31]
  s_nop 0
  v_mfma_f32_4x4x4_16b_bf16 v[24:27], v[14:15], v[66:67], v[24:27]
  v_mfma_f32_4x4x4_16b_bf16 v[28:31], v[14:15], v[70:71], v[28:31]
  s_nop 0
  v_mfma_f32_4x4x4_16b_bf16 v[24:27], v[14:15], v[72:73], v[24:27]
  v_mfma_f32_4x4x4_16b_bf16 v[28:31], v[14:15], v[76:77], v[28:31]
  s_nop 0
  v_mfma_f32_4x4x4_16b_bf16 v[24:27], v[14:15], v[74:75], v[24:27]
  v_mfma_f32_4x4x4_16b_bf16 v[28:31], v[14:15], v[78:79], v[28:31]
  s_nop 0
  s_waitcnt vmcnt(7)
  s_barrier
  ds_read_b64_tr_b16 v[64:65], v10 offset:0
  ds_read_b64_tr_b16 v[66:67], v10 offset:512
  ds_read_b64_tr_b16 v[68:69], v11 offset:0
  ds_read_b64_tr_b16 v[70:71], v11 offset:512
  ds_read_b64_tr_b16 v[72:73], v10 offset:16384
  ds_read_b64_tr_b16 v[74:75], v10 offset:16896
  ds_read_b64_tr_b16 v[76:77], v11 offset:16384
  ds_read_b64_tr_b16 v[78:79], v11 offset:16896
  ds_read_b64_tr_b16 v[80:81], v10 offset:32768
  ds_read_b64_tr_b16 v[82:83], v10 offset:33280
  ds_read_b64_tr_b16 v[84:85], v11 offset:32768
  ds_read_b64_tr_b16 v[86:87], v11 offset:33280
  s_waitcnt lgkmcnt(0)
  v_mfma_f32_4x4x4_16b_bf16 v[24:27], v[14:15], v[64:65], v[24:27]
  v_mfma_f32_4x4x4_16b_bf16 v[28:31], v[14:15], v[68:69], v[28:31]
  s_nop 0
  v_mfma_f32_4x4x4_16b_bf16 v[24:27], v[14:15], v[66:67], v[24:27]
  v_mfma_f32_4x4x4_16b_bf16 v[28:31], v[14:15], v[70:71], v[28:31]
  s_nop 0
  v_mfma_f32_4x4x4_16b_bf16 v[24:27], v[14:15], v[72:73], v[24:27]
  v_mfma_f32_4x4x4_16b_bf16 v[28:31], v[14:15], v[76:77], v[28:31]
  s_nop 0
  v_mfma_f32_4x4x4_16b_bf16 v[24:27], v[14:15], v[74:75], v[24:27]
  v_mfma_f32_4x4x4_16b_bf16 v[28:31], v[14:15], v[78:79], v[28:31]
  s_nop 0
  v_mfma_f32_4x4x4_16b_bf16 v[24:27], v[14:15], v[80:81], v[24:27]
  v_mfma_f32_4x4x4_16b_bf16 v[28:31], v[14:15], v[84:85], v[28:31]
  s_nop 0
  v_mfma_f32_4x4x4_16b_bf16 v[24:27], v[14:15], v[82:83], v[24:27]
  v_mfma_f32_4x4x4_16b_bf16 v[28:31], v[14:15], v[86:87], v[28:31]
  s_nop 0
  s_nop 7
  ds_write_b32 v60, v24 offset:2048
  ds_write_b32 v60, v28 offset:3072
  s_waitcnt lgkmcnt(0)
  s_waitcnt vmcnt(0)
  s_barrier
  ds_read_b64_tr_b16 v[64:65], v12 offset:0
  ds_read_b64_tr_b16 v[66:67], v12 offset:256
  ds_read_b64_tr_b16 v[72:73], v12 offset:16384
  ds_read_b64_tr_b16 v[74:75], v12 offset:16640
  ds_read_b64_tr_b16 v[80:81], v12 offset:32768
  ds_read_b64_tr_b16 v[82:83], v12 offset:33024
  ds_read_b64_tr_b16 v[88:89], v12 offset:49152
  ds_read_b64_tr_b16 v[90:91], v12 offset:49408
  ds_read_b64_tr_b16 v[96:97], v13 offset:0
  ds_read_b64_tr_b16 v[98:99], v13 offset:256
  ds_read_b64_tr_b16 v[104:105], v13 offset:16384
  ds_read_b64_tr_b16 v[106:107], v13 offset:16640
  ds_read_b64_tr_b16 v[112:113], v13 offset:32768
  ds_read_b64_tr_b16 v[114:115], v13 offset:33024
  s_waitcnt lgkmcnt(0)
  v_mfma_f32_4x4x4_16b_bf16 v[32:35], v[14:15], v[64:65], v[32:35]
  s_nop 1
  v_mfma_f32_4x4x4_16b_bf16 v[32:35], v[14:15], v[66:67], v[32:35]
  s_nop 1
  v_mfma_f32_4x4x4_16b_bf16 v[32:35], v[14:15], v[72:73], v[32:35]
  s_nop 1
  v_mfma_f32_4x4x4_16b_bf16 v[32:35], v[14:15], v[74:75], v[32:35]
  s_nop 1
  v_mfma_f32_4x4x4_16b_bf16 v[32:35], v[14:15], v[80:81], v[32:35]
  s_nop 1
  v_mfma_f32_4x4x4_16b_bf16 v[32:35], v[14:15], v[82:83], v[32:35]
  s_nop 1
  v_mfma_f32_4x4x4_16b_bf16 v[32:35], v[14:15], v[88:89], v[32:35]
  s_nop 1
  v_mfma_f32_4x4x4_16b_bf16 v[32:35], v[14:15], v[90:91], v[32:35]
  s_nop 1
  v_mfma_f32_4x4x4_16b_bf16 v[32:35], v[14:15], v[96:97], v[32:35]
  s_nop 1
  v_mfma_f32_4x4x4_16b_bf16 v[32:35], v[14:15], v[98:99], v[32:35]
  s_nop 1
  v_mfma_f32_4x4x4_16b_bf16 v[32:35], v[14:15], v[104:105], v[32:35]
  s_nop 1
  v_mfma_f32_4x4x4_16b_bf16 v[32:35], v[14:15], v[106:107], v[32:35]
  s_nop 1
  v_mfma_f32_4x4x4_16b_bf16 v[32:35], v[14:15], v[112:113], v[32:35]
  s_nop 1
  v_mfma_f32_4x4x4_16b_bf16 v[32:35], v[14:15], v[114:115], v[32:35]
  s_nop 1
  s_nop 7
  ds_write_b32 v60, v32 offset:4096
  s_waitcnt lgkmcnt(0)
  s_barrier
  s_waitcnt vmcnt(0)
  s_endpgm
k1_comp:
  s_getpc_b64 s[44:45]
  s_add_u32 s44, s44, k1_kernel@rel32@lo+4
  s_addc_u32 s45, s45, k1_kernel@rel32@hi+12
  s_mov_b32 s48, s44
  s_mov_b32 s49, s45
  s_mov_b32 s50, 0x3c00
  s_mov_b32 s51, 0x20000
  s_lshr_b32 s30, s2, 1
  s_and_b32 s30, s30, 12
  s_add_u32 s30, s30, s3
  s_lshl_b32 s30, s30, 10
  v_lshlrev_b32 v1, 4, v0
  buffer_load_dwordx4 v[252:255], v1, s[48:51], s30 offen
  s_lshl_b32 s28, s15, 12
  v_and_b32 v1, 31, v0
  v_lshrrev_b32 v16, 5, v0
  v_lshrrev_b32 v17, 1, v1
  v_and_b32 v17, 7, v17
  v_xor_b32 v17, v17, v16
  v_lshl_add_u32 v18, v1, 7, s28
  v_xor_b32 v19, 0, v17
  v_lshl_add_u32 v2, v19, 4, v18
  v_add_u32 v6, 65536, v2
  v_xor_b32 v19, 2, v17
  v_lshl_add_u32 v3, v19, 4, v18
  v_add_u32 v7, 65536, v3
  v_xor_b32 v19, 4, v17
  v_lshl_add_u32 v4, v19, 4, v18
  v_add_u32 v8, 65536, v4
  v_xor_b32 v19, 6, v17
  v_lshl_add_u32 v5, v19, 4, v18
  v_add_u32 v9, 65536, v5
  v_lshlrev_b32 v20, 14, v16
  v_lshrrev_b32 v40, 5, v0
  v_and_b32 v41, 15, v0
  v_lshrrev_b32 v41, 2, v41
  v_lshl_add_u32 v42, v40, 3, v41
  v_lshrrev_b32 v43, 1, v41
  v_lshlrev_b32 v43, 2, v43
  v_lshrrev_b32 v44, 3, v0
  v_and_b32 v44, 2, v44
  v_or_b32 v43, v43, v44
  v_lshrrev_b32 v45, 1, v0
  v_and_b32 v45, 1, v45
  v_or_b32 v43, v43, v45
  v_lshlrev_b32 v43, 4, v43
  v_lshl_add_u32 v43, v42, 7, v43
  v_and_b32 v45, 1, v0
  v_lshl_add_u32 v12, v45, 3, v43
  v_xor_b32 v13, 64, v12
  v_add_u32 v10, 114688, v12
  v_add_u32 v11, 114688, v13
  v_add_u32 v14, 65536, v12
  v_add_u32 v15, 65536, v13
  v_lshlrev_b32 v42, 6, v42
  v_lshl_add_u32 v42, v44, 4, v42
  v_and_b32 v45, 3, v0
  v_lshl_add_u32 v42, v45, 3, v42
  v_add_u32 v16, 8192, v42
  v_add_u32 v17, 65536, v16
  s_lshl_b32 s30, s19, 7
  v_lshl_add_u32 v21, v1, 2, s30
  v_add_u32 v250, v20, v21
  v_mov_b32 v251, v21
  v_lshlrev_b32 v249, 4, v0
  v_lshlrev_b32 v248, 5, v1
  v_add_u32 v248, 155648, v248
  v_mov_b32 v22, 0x3f803f80
  v_mov_b32 v23, 0x3f803f80
  s_mul_i32 s36, s19, 112
  s_lshr_b32 s30, s18, 4
  s_add_u32 s36, s36, s30
  s_sub_u32 s36, s36, 28
  s_lshl_b32 s36, s36, 10
  s_lshl_b32 s37, s18, 12
  v_mov_b32 v18, 0
  v_mov_b32 v19, 0
  v_mov_b32 v20, 0
  v_mov_b32 v21, 0
  v_mov_b32 v24, 0
  v_mov_b32 v25, 0
  v_mov_b32 v26, 0
  v_mov_b32 v27, 0
  v_mov_b32 v28, 0
  v_mov_b32 v29, 0
  v_mov_b32 v30, 0
  v_mov_b32 v31, 0
  v_mov_b32 v240, 0
  v_mov_b32 v241, 0
  v_mov_b32 v242, 0
  v_mov_b32 v243, 0
  v_mov_b32 v32, 0
  v_mov_b32 v33, 0
  v_mov_b32 v34, 0
  v_mov_b32 v35, 0
  v_mov_b32 v36, 0
  v_mov_b32 v37, 0
  v_mov_b32 v38, 0
  v_mov_b32 v39, 0
  v_mov_b32 v40, 0
  v_mov_b32 v41, 0
  v_mov_b32 v42, 0
  v_mov_b32 v43, 0
  v_mov_b32 v44, 0
  v_mov_b32 v45, 0
  v_mov_b32 v46, 0
  v_mov_b32 v47, 0
  v_mov_b32 v48, 0
  v_mov_b32 v49, 0
  v_mov_b32 v50, 0
  v_mov_b32 v51, 0
  v_mov_b32 v52, 0
  v_mov_b32 v53, 0
  v_mov_b32 v54, 0
  v_mov_b32 v55, 0
  v_mov_b32 v56, 0
  v_mov_b32 v57, 0
  v_mov_b32 v58, 0
  v_mov_b32 v59, 0
  v_mov_b32 v60, 0
  v_mov_b32 v61, 0
  v_mov_b32 v62, 0
  v_mov_b32 v63, 0
  v_mov_b32 v64, 0
  v_mov_b32 v65, 0
  v_mov_b32 v66, 0
  v_mov_b32 v67, 0
  v_mov_b32 v68, 0
  v_mov_b32 v69, 0
  v_mov_b32 v70, 0
  v_mov_b32 v71, 0
  v_mov_b32 v72, 0
  v_mov_b32 v73, 0
  v_mov_b32 v74, 0
  v_mov_b32 v75, 0
  v_mov_b32 v76, 0
  v_mov_b32 v77, 0
  v_mov_b32 v78, 0
  v_mov_b32 v79, 0
  v_mov_b32 v80, 0
  v_mov_b32 v81, 0
  v_mov_b32 v82, 0
  v_mov_b32 v83, 0
  v_mov_b32 v84, 0
  v_mov_b32 v85, 0
  v_mov_b32 v86, 0
  v_mov_b32 v87, 0
  v_mov_b32 v88, 0
  v_mov_b32 v89, 0
  v_mov_b32 v90, 0
  v_mov_b32 v91, 0
  v_mov_b32 v92, 0
  v_mov_b32 v93, 0
  v_mov_b32 v94, 0
  v_mov_b32 v95, 0
  v_mov_b32 v96, 0
  v_mov_b32 v97, 0
  v_mov_b32 v98, 0
  v_mov_b32 v99, 0
  v_mov_b32 v100, 0
  v_mov_b32 v101, 0
  v_mov_b32 v102, 0
  v_mov_b32 v103, 0
  v_mov_b32 v104, 0
  v_mov_b32 v105, 0
  v_mov_b32 v106, 0
  v_mov_b32 v107, 0
  v_mov_b32 v108, 0
  v_mov_b32 v109, 0
  v_mov_b32 v110, 0
  v_mov_b32 v111, 0
  s_waitcnt lgkmcnt(0)
  s_add_u32 s24, s12, 0x200000
  s_addc_u32 s25, s13, 0
  s_mov_b32 s26, 0x700000
  s_mov_b32 s27, 0x20000
  s_mov_b32 s32, s12
  s_mov_b32 s33, s13
  s_mov_b32 s34, 0x1c0000
  s_mov_b32 s35, 0x20000
  s_add_u32 s40, s12, 0xfe0000
  s_addc_u32 s41, s13, 0
  s_mov_b32 s42, 0x2000
  s_mov_b32 s43, 0x20000
  s_barrier
  ds_read_b128 v[112:115], v2 offset:0
  ds_read_b64_tr_b16 v[224:225], v10 offset:0
  ds_read_b64_tr_b16 v[226:227], v10 offset:512
  ds_read_b64_tr_b16 v[228:229], v11 offset:0
  ds_read_b64_tr_b16 v[230:231], v11 offset:512
  s_waitcnt lgkmcnt(0)
  v_mfma_f32_32x32x16_bf16 v[32:47], v[224:227], v[112:115], v[32:47]
  ds_read_b128 v[116:119], v3 offset:0
  ds_read_b64_tr_b16 v[232:233], v10 offset:2048
  ds_read_b64_tr_b16 v[234:235], v10 offset:2560
  ds_read_b64_tr_b16 v[236:237], v11 offset:2048
  ds_read_b64_tr_b16 v[238:239], v11 offset:2560
  v_mfma_f32_4x4x4_16b_bf16 v[18:21], v[22:23], v[112:113], v[18:21]
  v_mfma_f32_4x4x4_16b_bf16 v[240:243], v[112:113], v[112:113], v[240:243]
  v_mfma_f32_32x32x16_bf16 v[48:63], v[228:231], v[112:115], v[48:63]
  v_mfma_f32_4x4x4_16b_bf16 v[18:21], v[22:23], v[114:115], v[18:21]
  v_mfma_f32_4x4x4_16b_bf16 v[240:243], v[114:115], v[114:115], v[240:243]
  s_waitcnt lgkmcnt(0)
  v_mfma_f32_32x32x16_bf16 v[32:47], v[232:235], v[116:119], v[32:47]
  ds_read_b128 v[120:123], v4 offset:0
  ds_read_b64_tr_b16 v[224:225], v10 offset:4096
  ds_read_b64_tr_b16 v[226:227], v10 offset:4608
  ds_read_b64_tr_b16 v[228:229], v11 offset:4096
  ds_read_b64_tr_b16 v[230:231], v11 offset:4608
  v_mfma_f32_4x4x4_16b_bf16 v[18:21], v[22:23], v[116:117], v[18:21]
  v_mfma_f32_4x4x4_16b_bf16 v[240:243], v[116:117], v[116:117], v[240:243]
  v_mfma_f32_32x32x16_bf16 v[48:63], v[236:239], v[116:119], v[48:63]
  v_mfma_f32_4x4x4_16b_bf16 v[18:21], v[22:23], v[118:119], v[18:21]
  v_mfma_f32_4x4x4_16b_bf16 v[240:243], v[118:119], v[118:119], v[240:243]
  s_waitcnt lgkmcnt(0)
  v_mfma_f32_32x32x16_bf16 v[32:47], v[224:227], v[120:123], v[32:47]
  ds_read_b128 v[124:127], v5 offset:0
  ds_read_b64_tr_b16 v[232:233], v10 offset:6144
  ds_read_b64_tr_b16 v[234:235], v10 offset:6656
  ds_read_b64_tr_b16 v[236:237], v11 offset:6144
  ds_read_b64_tr_b16 v[238:239], v11 offset:6656
  v_mfma_f32_4x4x4_16b_bf16 v[18:21], v[22:23], v[120:121], v[18:21]
  v_mfma_f32_4x4x4_16b_bf16 v[240:243], v[120:121], v[120:121], v[240:243]
  v_mfma_f32_32x32x16_bf16 v[48:63], v[228:231], v[120:123], v[48:63]
  v_mfma_f32_4x4x4_16b_bf16 v[18:21], v[22:23], v[122:123], v[18:21]
  v_mfma_f32_4x4x4_16b_bf16 v[240:243], v[122:123], v[122:123], v[240:243]
  s_waitcnt lgkmcnt(0)
  s_barrier
  v_mfma_f32_32x32x16_bf16 v[32:47], v[232:235], v[124:127], v[32:47]
  ds_read_b128 v[128:131], v2 offset:16384
  ds_read_b64_tr_b16 v[224:225], v10 offset:8192
  ds_read_b64_tr_b16 v[226:227], v10 offset:8704
  ds_read_b64_tr_b16 v[228:229], v11 offset:8192
  ds_read_b64_tr_b16 v[230:231], v11 offset:8704
  v_mfma_f32_4x4x4_16b_bf16 v[18:21], v[22:23], v[124:125], v[18:21]
  v_mfma_f32_4x4x4_16b_bf16 v[240:243], v[124:125], v[124:125], v[240:243]
  v_mfma_f32_32x32x16_bf16 v[48:63], v[236:239], v[124:127], v[48:63]
  v_mfma_f32_4x4x4_16b_bf16 v[18:21], v[22:23], v[126:127], v[18:21]
  v_mfma_f32_4x4x4_16b_bf16 v[240:243], v[126:127], v[126:127], v[240:243]
  s_waitcnt lgkmcnt(0)
  v_mfma_f32_32x32x16_bf16 v[32:47], v[224:227], v[128:131], v[32:47]
  ds_read_b128 v[132:135], v3 offset:16384
  ds_read_b64_tr_b16 v[232:233], v10 offset:10240
  ds_read_b64_tr_b16 v[234:235], v10 offset:10752
  ds_read_b64_tr_b16 v[236:237], v11 offset:10240
  ds_read_b64_tr_b16 v[238:239], v11 offset:10752
  v_mfma_f32_4x4x4_16b_bf16 v[18:21], v[22:23], v[128:129], v[18:21]
  v_mfma_f32_4x4x4_16b_bf16 v[240:243], v[128:129], v[128:129], v[240:243]
  v_mfma_f32_32x32x16_bf16 v[48:63], v[228:231], v[128:131], v[48:63]
  v_mfma_f32_4x4x4_16b_bf16 v[18:21], v[22:23], v[130:131], v[18:21]
  v_mfma_f32_4x4x4_16b_bf16 v[240:243], v[130:131], v[130:131], v[240:243]
  s_waitcnt lgkmcnt(0)
  v_mfma_f32_32x32x16_bf16 v[32:47], v[232:235], v[132:135], v[32:47]
  ds_read_b128 v[136:139], v4 offset:16384
  ds_read_b64_tr_b16 v[224:225], v10 offset:12288
  ds_read_b64_tr_b16 v[226:227], v10 offset:12800
  ds_read_b64_tr_b16 v[228:229], v11 offset:12288
  ds_read_b64_tr_b16 v[230:231], v11 offset:12800
  v_mfma_f32_4x4x4_16b_bf16 v[18:21], v[22:23], v[132:133], v[18:21]
  v_mfma_f32_4x4x4_16b_bf16 v[240:243], v[132:133], v[132:133], v[240:243]
  v_mfma_f32_32x32x16_bf16 v[48:63], v[236:239], v[132:135], v[48:63]
  v_mfma_f32_4x4x4_16b_bf16 v[18:21], v[22:23], v[134:135], v[18:21]
  v_mfma_f32_4x4x4_16b_bf16 v[240:243], v[134:135], v[134:135], v[240:243]
  s_waitcnt lgkmcnt(0)
  v_mfma_f32_32x32x16_bf16 v[32:47], v[224:227], v[136:139], v[32:47]
  ds_read_b128 v[140:143], v5 offset:16384
  ds_read_b64_tr_b16 v[232:233], v10 offset:14336
  ds_read_b64_tr_b16 v[234:235], v10 offset:14848
  ds_read_b64_tr_b16 v[236:237], v11 offset:14336
  ds_read_b64_tr_b16 v[238:239], v11 offset:14848
  v_mfma_f32_4x4x4_16b_bf16 v[18:21], v[22:23], v[136:137], v[18:21]
  v_mfma_f32_4x4x4_16b_bf16 v[240:243], v[136:137], v[136:137], v[240:243]
  v_mfma_f32_32x32x16_bf16 v[48:63], v[228:231], v[136:139], v[48:63]
  v_mfma_f32_4x4x4_16b_bf16 v[18:21], v[22:23], v[138:139], v[18:21]
  v_mfma_f32_4x4x4_16b_bf16 v[240:243], v[138:139], v[138:139], v[240:243]
  s_waitcnt lgkmcnt(0)
  s_barrier
  v_mfma_f32_32x32x16_bf16 v[32:47], v[232:235], v[140:143], v[32:47]
  ds_read_b128 v[144:147], v2 offset:32768
  ds_read_b64_tr_b16 v[224:225], v10 offset:16384
  ds_read_b64_tr_b16 v[226:227], v10 offset:16896
  ds_read_b64_tr_b16 v[228:229], v11 offset:16384
  ds_read_b64_tr_b16 v[230:231], v11 offset:16896
  v_mfma_f32_4x4x4_16b_bf16 v[18:21], v[22:23], v[140:141], v[18:21]
  v_mfma_f32_4x4x4_16b_bf16 v[240:243], v[140:141], v[140:141], v[240:243]
  v_mfma_f32_32x32x16_bf16 v[48:63], v[236:239], v[140:143], v[48:63]
  v_mfma_f32_4x4x4_16b_bf16 v[18:21], v[22:23], v[142:143], v[18:21]
  v_mfma_f32_4x4x4_16b_bf16 v[240:243], v[142:143], v[142:143], v[240:243]
  s_waitcnt lgkmcnt(0)
  v_mfma_f32_32x32x16_bf16 v[32:47], v[224:227], v[144:147], v[32:47]
  ds_read_b128 v[148:151], v3 offset:32768
  ds_read_b64_tr_b16 v[232:233], v10 offset:18432
  ds_read_b64_tr_b16 v[234:235], v10 offset:18944
  ds_read_b64_tr_b16 v[236:237], v11 offset:18432
  ds_read_b64_tr_b16 v[238:239], v11 offset:18944
  v_mfma_f32_4x4x4_16b_bf16 v[18:21], v[22:23], v[144:145], v[18:21]
  v_mfma_f32_4x4x4_16b_bf16 v[240:243], v[144:145], v[144:145], v[240:243]
  v_mfma_f32_32x32x16_bf16 v[48:63], v[228:231], v[144:147], v[48:63]
  v_mfma_f32_4x4x4_16b_bf16 v[18:21], v[22:23], v[146:147], v[18:21]
  v_mfma_f32_4x4x4_16b_bf16 v[240:243], v[146:147], v[146:147], v[240:243]
  s_waitcnt lgkmcnt(0)
  v_mfma_f32_32x32x16_bf16 v[32:47], v[232:235], v[148:151], v[32:47]
  ds_read_b128 v[152:155], v4 offset:32768
  ds_read_b64_tr_b16 v[224:225], v10 offset:20480
  ds_read_b64_tr_b16 v[226:227], v10 offset:20992
  ds_read_b64_tr_b16 v[228:229], v11 offset:20480
  ds_read_b64_tr_b16 v[230:231], v11 offset:20992
  v_mfma_f32_4x4x4_16b_bf16 v[18:21], v[22:23], v[148:149], v[18:21]
  v_mfma_f32_4x4x4_16b_bf16 v[240:243], v[148:149], v[148:149], v[240:243]
  v_mfma_f32_32x32x16_bf16 v[48:63], v[236:239], v[148:151], v[48:63]
  v_mfma_f32_4x4x4_16b_bf16 v[18:21], v[22:23], v[150:151], v[18:21]
  v_mfma_f32_4x4x4_16b_bf16 v[240:243], v[150:151], v[150:151], v[240:243]
  s_waitcnt lgkmcnt(0)
  v_mfma_f32_32x32x16_bf16 v[32:47], v[224:227], v[152:155], v[32:47]
  ds_read_b128 v[156:159], v5 offset:32768
  ds_read_b64_tr_b16 v[232:233], v10 offset:22528
  ds_read_b64_tr_b16 v[234:235], v10 offset:23040
  ds_read_b64_tr_b16 v[236:237], v11 offset:22528
  ds_read_b64_tr_b16 v[238:239], v11 offset:23040
  v_mfma_f32_4x4x4_16b_bf16 v[18:21], v[22:23], v[152:153], v[18:21]
  v_mfma_f32_4x4x4_16b_bf16 v[240:243], v[152:153], v[152:153], v[240:243]
  v_mfma_f32_32x32x16_bf16 v[48:63], v[228:231], v[152:155], v[48:63]
  v_mfma_f32_4x4x4_16b_bf16 v[18:21], v[22:23], v[154:155], v[18:21]
  v_mfma_f32_4x4x4_16b_bf16 v[240:243], v[154:155], v[154:155], v[240:243]
  s_waitcnt lgkmcnt(0)
  s_barrier
  v_mfma_f32_32x32x16_bf16 v[32:47], v[232:235], v[156:159], v[32:47]
  ds_read_b128 v[160:163], v2 offset:49152
  ds_read_b64_tr_b16 v[224:225], v10 offset:24576
  ds_read_b64_tr_b16 v[226:227], v10 offset:25088
  ds_read_b64_tr_b16 v[228:229], v11 offset:24576
  ds_read_b64_tr_b16 v[230:231], v11 offset:25088
  v_mfma_f32_4x4x4_16b_bf16 v[18:21], v[22:23], v[156:157], v[18:21]
  v_mfma_f32_4x4x4_16b_bf16 v[240:243], v[156:157], v[156:157], v[240:243]
  v_mfma_f32_32x32x16_bf16 v[48:63], v[236:239], v[156:159], v[48:63]
  v_mfma_f32_4x4x4_16b_bf16 v[18:21], v[22:23], v[158:159], v[18:21]
  v_mfma_f32_4x4x4_16b_bf16 v[240:243], v[158:159], v[158:159], v[240:243]
  s_waitcnt lgkmcnt(0)
  v_mfma_f32_32x32x16_bf16 v[32:47], v[224:227], v[160:163], v[32:47]
  ds_read_b128 v[164:167], v3 offset:49152
  ds_read_b64_tr_b16 v[232:233], v10 offset:26624
  ds_read_b64_tr_b16 v[234:235], v10 offset:27136
  ds_read_b64_tr_b16 v[236:237], v11 offset:26624
  ds_read_b64_tr_b16 v[238:239], v11 offset:27136
  v_mfma_f32_4x4x4_16b_bf16 v[18:21], v[22:23], v[160:161], v[18:21]
  v_mfma_f32_4x4x4_16b_bf16 v[240:243], v[160:161], v[160:161], v[240:243]
  v_mfma_f32_32x32x16_bf16 v[48:63], v[228:231], v[160:163], v[48:63]
  v_mfma_f32_4x4x4_16b_bf16 v[18:21], v[22:23], v[162:163], v[18:21]
  v_mfma_f32_4x4x4_16b_bf16 v[240:243], v[162:163], v[162:163], v[240:243]
  s_waitcnt lgkmcnt(0)
  v_mfma_f32_32x32x16_bf16 v[32:47], v[232:235], v[164:167], v[32:47]
  ds_read_b128 v[168:171], v4 offset:49152
  ds_read_b64_tr_b16 v[224:225], v10 offset:28672
  ds_read_b64_tr_b16 v[226:227], v10 offset:29184
  ds_read_b64_tr_b16 v[228:229], v11 offset:28672
  ds_read_b64_tr_b16 v[230:231], v11 offset:29184
  v_mfma_f32_4x4x4_16b_bf16 v[18:21], v[22:23], v[164:165], v[18:21]
  v_mfma_f32_4x4x4_16b_bf16 v[240:243], v[164:165], v[164:165], v[240:243]
  v_mfma_f32_32x32x16_bf16 v[48:63], v[236:239], v[164:167], v[48:63]
  v_mfma_f32_4x4x4_16b_bf16 v[18:21], v[22:23], v[166:167], v[18:21]
  v_mfma_f32_4x4x4_16b_bf16 v[240:243], v[166:167], v[166:167], v[240:243]
  s_waitcnt lgkmcnt(0)
  v_mfma_f32_32x32x16_bf16 v[32:47], v[224:227], v[168:171], v[32:47]
  ds_read_b128 v[172:175], v5 offset:49152
  ds_read_b64_tr_b16 v[232:233], v10 offset:30720
  ds_read_b64_tr_b16 v[234:235], v10 offset:31232
  ds_read_b64_tr_b16 v[236:237], v11 offset:30720
  ds_read_b64_tr_b16 v[238:239], v11 offset:31232
  v_mfma_f32_4x4x4_16b_bf16 v[18:21], v[22:23], v[168:169], v[18:21]
  v_mfma_f32_4x4x4_16b_bf16 v[240:243], v[168:169], v[168:169], v[240:243]
  v_mfma_f32_32x32x16_bf16 v[48:63], v[228:231], v[168:171], v[48:63]
  v_mfma_f32_4x4x4_16b_bf16 v[18:21], v[22:23], v[170:171], v[18:21]
  v_mfma_f32_4x4x4_16b_bf16 v[240:243], v[170:171], v[170:171], v[240:243]
  s_waitcnt lgkmcnt(0)
  s_barrier
  v_mfma_f32_32x32x16_bf16 v[32:47], v[232:235], v[172:175], v[32:47]
  ds_read_b128 v[176:179], v6 offset:0
  ds_read_b64_tr_b16 v[224:225], v10 offset:32768
  ds_read_b64_tr_b16 v[226:227], v10 offset:33280
  ds_read_b64_tr_b16 v[228:229], v11 offset:32768
  ds_read_b64_tr_b16 v[230:231], v11 offset:33280
  v_mfma_f32_4x4x4_16b_bf16 v[18:21], v[22:23], v[172:173], v[18:21]
  v_mfma_f32_4x4x4_16b_bf16 v[240:243], v[172:173], v[172:173], v[240:243]
  v_mfma_f32_32x32x16_bf16 v[48:63], v[236:239], v[172:175], v[48:63]
  v_mfma_f32_4x4x4_16b_bf16 v[18:21], v[22:23], v[174:175], v[18:21]
  v_mfma_f32_4x4x4_16b_bf16 v[240:243], v[174:175], v[174:175], v[240:243]
  s_waitcnt lgkmcnt(0)
  v_mfma_f32_32x32x16_bf16 v[32:47], v[224:227], v[176:179], v[32:47]
  ds_read_b128 v[180:183], v7 offset:0
  ds_read_b64_tr_b16 v[232:233], v10 offset:34816
  ds_read_b64_tr_b16 v[234:235], v10 offset:35328
  ds_read_b64_tr_b16 v[236:237], v11 offset:34816
  ds_read_b64_tr_b16 v[238:239], v11 offset:35328
  v_mfma_f32_4x4x4_16b_bf16 v[18:21], v[22:23], v[176:177], v[18:21]
  v_mfma_f32_4x4x4_16b_bf16 v[240:243], v[176:177], v[176:177], v[240:243]
  v_mfma_f32_32x32x16_bf16 v[48:63], v[228:231], v[176:179], v[48:63]
  v_mfma_f32_4x4x4_16b_bf16 v[18:21], v[22:23], v[178:179], v[18:21]
  v_mfma_f32_4x4x4_16b_bf16 v[240:243], v[178:179], v[178:179], v[240:243]
  s_waitcnt lgkmcnt(0)
  v_mfma_f32_32x32x16_bf16 v[32:47], v[232:235], v[180:183], v[32:47]
  ds_read_b128 v[184:187], v8 offset:0
  ds_read_b64_tr_b16 v[224:225], v10 offset:36864
  ds_read_b64_tr_b16 v[226:227], v10 offset:37376
  ds_read_b64_tr_b16 v[228:229], v11 offset:36864
  ds_read_b64_tr_b16 v[230:231], v11 offset:37376
  v_mfma_f32_4x4x4_16b_bf16 v[18:21], v[22:23], v[180:181], v[18:21]
  v_mfma_f32_4x4x4_16b_bf16 v[240:243], v[180:181], v[180:181], v[240:243]
  v_mfma_f32_32x32x16_bf16 v[48:63], v[236:239], v[180:183], v[48:63]
  v_mfma_f32_4x4x4_16b_bf16 v[18:21], v[22:23], v[182:183], v[18:21]
  v_mfma_f32_4x4x4_16b_bf16 v[240:243], v[182:183], v[182:183], v[240:243]
  s_waitcnt lgkmcnt(0)
  v_mfma_f32_32x32x16_bf16 v[32:47], v[224:227], v[184:187], v[32:47]
  ds_read_b128 v[188:191], v9 offset:0
  ds_read_b64_tr_b16 v[232:233], v10 offset:38912
  ds_read_b64_tr_b16 v[234:235], v10 offset:39424
  ds_read_b64_tr_b16 v[236:237], v11 offset:38912
  ds_read_b64_tr_b16 v[238:239], v11 offset:39424
  v_mfma_f32_4x4x4_16b_bf16 v[18:21], v[22:23], v[184:185], v[18:21]
  v_mfma_f32_4x4x4_16b_bf16 v[240:243], v[184:185], v[184:185], v[240:243]
  v_mfma_f32_32x32x16_bf16 v[48:63], v[228:231], v[184:187], v[48:63]
  v_mfma_f32_4x4x4_16b_bf16 v[18:21], v[22:23], v[186:187], v[18:21]
  v_mfma_f32_4x4x4_16b_bf16 v[240:243], v[186:187], v[186:187], v[240:243]
  s_waitcnt lgkmcnt(0)
  s_barrier
  v_mfma_f32_32x32x16_bf16 v[32:47], v[232:235], v[188:191], v[32:47]
  ds_read_b128 v[192:195], v6 offset:16384
  ds_read_b64_tr_b16 v[224:225], v10 offset:0
  ds_read_b64_tr_b16 v[226:227], v10 offset:512
  ds_read_b64_tr_b16 v[228:229], v11 offset:0
  ds_read_b64_tr_b16 v[230:231], v11 offset:512
  v_mfma_f32_4x4x4_16b_bf16 v[18:21], v[22:23], v[188:189], v[18:21]
  v_mfma_f32_4x4x4_16b_bf16 v[240:243], v[188:189], v[188:189], v[240:243]
  v_mfma_f32_32x32x16_bf16 v[48:63], v[236:239], v[188:191], v[48:63]
  v_mfma_f32_4x4x4_16b_bf16 v[18:21], v[22:23], v[190:191], v[18:21]
  v_mfma_f32_4x4x4_16b_bf16 v[240:243], v[190:191], v[190:191], v[240:243]
  s_waitcnt lgkmcnt(0)
  v_mfma_f32_32x32x16_bf16 v[32:47], v[224:227], v[192:195], v[32:47]
  ds_read_b128 v[196:199], v7 offset:16384
  ds_read_b64_tr_b16 v[232:233], v10 offset:2048
  ds_read_b64_tr_b16 v[234:235], v10 offset:2560
  ds_read_b64_tr_b16 v[236:237], v11 offset:2048
  ds_read_b64_tr_b16 v[238:239], v11 offset:2560
  v_mfma_f32_4x4x4_16b_bf16 v[18:21], v[22:23], v[192:193], v[18:21]
  v_mfma_f32_4x4x4_16b_bf16 v[240:243], v[192:193], v[192:193], v[240:243]
  v_mfma_f32_32x32x16_bf16 v[48:63], v[228:231], v[192:195], v[48:63]
  v_mfma_f32_4x4x4_16b_bf16 v[18:21], v[22:23], v[194:195], v[18:21]
  v_mfma_f32_4x4x4_16b_bf16 v[240:243], v[194:195], v[194:195], v[240:243]
  s_waitcnt lgkmcnt(0)
  v_mfma_f32_32x32x16_bf16 v[32:47], v[232:235], v[196:199], v[32:47]
  ds_read_b128 v[200:203], v8 offset:16384
  ds_read_b64_tr_b16 v[224:225], v10 offset:4096
  ds_read_b64_tr_b16 v[226:227], v10 offset:4608
  ds_read_b64_tr_b16 v[228:229], v11 offset:4096
  ds_read_b64_tr_b16 v[230:231], v11 offset:4608
  v_mfma_f32_4x4x4_16b_bf16 v[18:21], v[22:23], v[196:197], v[18:21]
  v_mfma_f32_4x4x4_16b_bf16 v[240:243], v[196:197], v[196:197], v[240:243]
  v_mfma_f32_32x32x16_bf16 v[48:63], v[236:239], v[196:199], v[48:63]
  v_mfma_f32_4x4x4_16b_bf16 v[18:21], v[22:23], v[198:199], v[18:21]
  v_mfma_f32_4x4x4_16b_bf16 v[240:243], v[198:199], v[198:199], v[240:243]
  s_waitcnt lgkmcnt(0)
  v_mfma_f32_32x32x16_bf16 v[32:47], v[224:227], v[200:203], v[32:47]
  ds_read_b128 v[204:207], v9 offset:16384
  ds_read_b64_tr_b16 v[232:233], v10 offset:6144
  ds_read_b64_tr_b16 v[234:235], v10 offset:6656
  ds_read_b64_tr_b16 v[236:237], v11 offset:6144
  ds_read_b64_tr_b16 v[238:239], v11 offset:6656
  v_mfma_f32_4x4x4_16b_bf16 v[18:21], v[22:23], v[200:201], v[18:21]
  v_mfma_f32_4x4x4_16b_bf16 v[240:243], v[200:201], v[200:201], v[240:243]
  v_mfma_f32_32x32x16_bf16 v[48:63], v[228:231], v[200:203], v[48:63]
  v_mfma_f32_4x4x4_16b_bf16 v[18:21], v[22:23], v[202:203], v[18:21]
  v_mfma_f32_4x4x4_16b_bf16 v[240:243], v[202:203], v[202:203], v[240:243]
  s_waitcnt lgkmcnt(0)
  s_barrier
  v_mfma_f32_32x32x16_bf16 v[32:47], v[232:235], v[204:207], v[32:47]
  ds_read_b128 v[208:211], v6 offset:32768
  ds_read_b64_tr_b16 v[224:225], v10 offset:8192
  ds_read_b64_tr_b16 v[226:227], v10 offset:8704
  ds_read_b64_tr_b16 v[228:229], v11 offset:8192
  ds_read_b64_tr_b16 v[230:231], v11 offset:8704
  v_mfma_f32_4x4x4_16b_bf16 v[18:21], v[22:23], v[204:205], v[18:21]
  v_mfma_f32_4x4x4_16b_bf16 v[240:243], v[204:205], v[204:205], v[240:243]
  v_mfma_f32_32x32x16_bf16 v[48:63], v[236:239], v[204:207], v[48:63]
  v_mfma_f32_4x4x4_16b_bf16 v[18:21], v[22:23], v[206:207], v[18:21]
  v_mfma_f32_4x4x4_16b_bf16 v[240:243], v[206:207], v[206:207], v[240:243]
  s_waitcnt lgkmcnt(0)
  v_mfma_f32_32x32x16_bf16 v[32:47], v[224:227], v[208:211], v[32:47]
  ds_read_b128 v[212:215], v7 offset:32768
  ds_read_b64_tr_b16 v[232:233], v10 offset:10240
  ds_read_b64_tr_b16 v[234:235], v10 offset:10752
  ds_read_b64_tr_b16 v[236:237], v11 offset:10240
  ds_read_b64_tr_b16 v[238:239], v11 offset:10752
  v_mfma_f32_4x4x4_16b_bf16 v[18:21], v[22:23], v[208:209], v[18:21]
  v_mfma_f32_4x4x4_16b_bf16 v[240:243], v[208:209], v[208:209], v[240:243]
  v_mfma_f32_32x32x16_bf16 v[48:63], v[228:231], v[208:211], v[48:63]
  v_mfma_f32_4x4x4_16b_bf16 v[18:21], v[22:23], v[210:211], v[18:21]
  v_mfma_f32_4x4x4_16b_bf16 v[240:243], v[210:211], v[210:211], v[240:243]
  s_waitcnt lgkmcnt(0)
  v_mfma_f32_32x32x16_bf16 v[32:47], v[232:235], v[212:215], v[32:47]
  ds_read_b128 v[216:219], v8 offset:32768
  ds_read_b64_tr_b16 v[224:225], v10 offset:12288
  ds_read_b64_tr_b16 v[226:227], v10 offset:12800
  ds_read_b64_tr_b16 v[228:229], v11 offset:12288
  ds_read_b64_tr_b16 v[230:231], v11 offset:12800
  v_mfma_f32_4x4x4_16b_bf16 v[18:21], v[22:23], v[212:213], v[18:21]
  v_mfma_f32_4x4x4_16b_bf16 v[240:243], v[212:213], v[212:213], v[240:243]
  v_mfma_f32_32x32x16_bf16 v[48:63], v[236:239], v[212:215], v[48:63]
  v_mfma_f32_4x4x4_16b_bf16 v[18:21], v[22:23], v[214:215], v[18:21]
  v_mfma_f32_4x4x4_16b_bf16 v[240:243], v[214:215], v[214:215], v[240:243]
  s_waitcnt lgkmcnt(0)
  v_mfma_f32_32x32x16_bf16 v[32:47], v[224:227], v[216:219], v[32:47]
  ds_read_b128 v[220:223], v9 offset:32768
  ds_read_b64_tr_b16 v[232:233], v10 offset:14336
  ds_read_b64_tr_b16 v[234:235], v10 offset:14848
  ds_read_b64_tr_b16 v[236:237], v11 offset:14336
  ds_read_b64_tr_b16 v[238:239], v11 offset:14848
  v_mfma_f32_4x4x4_16b_bf16 v[18:21], v[22:23], v[216:217], v[18:21]
  v_mfma_f32_4x4x4_16b_bf16 v[240:243], v[216:217], v[216:217], v[240:243]
  v_mfma_f32_32x32x16_bf16 v[48:63], v[228:231], v[216:219], v[48:63]
  v_mfma_f32_4x4x4_16b_bf16 v[18:21], v[22:23], v[218:219], v[18:21]
  v_mfma_f32_4x4x4_16b_bf16 v[240:243], v[218:219], v[218:219], v[240:243]
  s_waitcnt lgkmcnt(0)
  s_barrier
  v_mfma_f32_32x32x16_bf16 v[32:47], v[232:235], v[220:223], v[32:47]
  ds_read_b64_tr_b16 v[224:225], v12 offset:0
  ds_read_b64_tr_b16 v[226:227], v12 offset:512
  ds_read_b64_tr_b16 v[228:229], v13 offset:0
  ds_read_b64_tr_b16 v[230:231], v13 offset:512
  v_mfma_f32_4x4x4_16b_bf16 v[18:21], v[22:23], v[220:221], v[18:21]
  v_mfma_f32_4x4x4_16b_bf16 v[240:243], v[220:221], v[220:221], v[240:243]
  v_mfma_f32_32x32x16_bf16 v[48:63], v[236:239], v[220:223], v[48:63]
  v_mfma_f32_4x4x4_16b_bf16 v[18:21], v[22:23], v[222:223], v[18:21]
  v_mfma_f32_4x4x4_16b_bf16 v[240:243], v[222:223], v[222:223], v[240:243]
  s_waitcnt vmcnt(0)
  s_waitcnt lgkmcnt(0)
  v_mfma_f32_32x32x16_bf16 v[64:79], v[224:227], v[112:115], v[64:79]
  ds_read_b64_tr_b16 v[232:233], v12 offset:2048
  ds_read_b64_tr_b16 v[234:235], v12 offset:2560
  ds_read_b64_tr_b16 v[236:237], v13 offset:2048
  ds_read_b64_tr_b16 v[238:239], v13 offset:2560
  v_and_b32 v2, 3, v0
  v_mfma_f32_32x32x16_bf16 v[80:95], v[228:231], v[112:115], v[80:95]
  v_cmp_eq_u32 vcc, 1, v2
  v_cmp_eq_u32 s[44:45], 2, v2
  v_cmp_eq_u32 s[46:47], 3, v2
  s_waitcnt lgkmcnt(0)
  v_mfma_f32_32x32x16_bf16 v[64:79], v[232:235], v[116:119], v[64:79]
  ds_read_b64_tr_b16 v[224:225], v12 offset:4096
  ds_read_b64_tr_b16 v[226:227], v12 offset:4608
  ds_read_b64_tr_b16 v[228:229], v13 offset:4096
  ds_read_b64_tr_b16 v[230:231], v13 offset:4608
  v_cndmask_b32 v20, v240, v241, vcc
  v_mfma_f32_32x32x16_bf16 v[80:95], v[236:239], v[116:119], v[80:95]
  s_nop 0
  v_cndmask_b32 v20, v20, v242, s[44:45]
  v_cndmask_b32 v20, v20, v243, s[46:47]
  s_waitcnt lgkmcnt(0)
  v_mfma_f32_32x32x16_bf16 v[64:79], v[224:227], v[120:123], v[64:79]
  ds_read_b64_tr_b16 v[232:233], v12 offset:6144
  ds_read_b64_tr_b16 v[234:235], v12 offset:6656
  ds_read_b64_tr_b16 v[236:237], v13 offset:6144
  ds_read_b64_tr_b16 v[238:239], v13 offset:6656
  v_mov_b32 v19, v18
  v_mfma_f32_32x32x16_bf16 v[80:95], v[228:231], v[120:123], v[80:95]
  v_mov_b32 v21, v20
  s_nop 1
  v_permlane32_swap_b32 v18, v19
  s_waitcnt lgkmcnt(0)
  v_mfma_f32_32x32x16_bf16 v[64:79], v[232:235], v[124:127], v[64:79]
  ds_read_b64_tr_b16 v[224:225], v12 offset:16384
  ds_read_b64_tr_b16 v[226:227], v12 offset:16896
  ds_read_b64_tr_b16 v[228:229], v13 offset:16384
  ds_read_b64_tr_b16 v[230:231], v13 offset:16896
  v_permlane32_swap_b32 v20, v21
  v_mfma_f32_32x32x16_bf16 v[80:95], v[236:239], v[124:127], v[80:95]
  v_add_f32 v18, v18, v19
  v_add_f32 v20, v20, v21
  v_mul_f32 v18, 0xbb124925, v18
  s_waitcnt lgkmcnt(0)
  v_mfma_f32_32x32x16_bf16 v[64:79], v[224:227], v[128:131], v[64:79]
  ds_read_b64_tr_b16 v[232:233], v12 offset:18432
  ds_read_b64_tr_b16 v[234:235], v12 offset:18944
  ds_read_b64_tr_b16 v[236:237], v13 offset:18432
  ds_read_b64_tr_b16 v[238:239], v13 offset:18944
  v_mul_f32 v20, 0x3b124925, v20
  v_mfma_f32_32x32x16_bf16 v[80:95], v[228:231], v[128:131], v[80:95]
  v_fma_f32 v20, -v18, v18, v20
  v_max_f32 v20, 0, v20
  v_cmp_gt_u32 vcc, 32, v0
  s_waitcnt lgkmcnt(0)
  v_mfma_f32_32x32x16_bf16 v[64:79], v[232:235], v[132:135], v[64:79]
  ds_read_b64_tr_b16 v[224:225], v12 offset:20480
  ds_read_b64_tr_b16 v[226:227], v12 offset:20992
  ds_read_b64_tr_b16 v[228:229], v13 offset:20480
  ds_read_b64_tr_b16 v[230:231], v13 offset:20992
  v_cvt_pk_bf16_f32 v18, v18, v18
  v_mfma_f32_32x32x16_bf16 v[80:95], v[236:239], v[132:135], v[80:95]
  v_cvt_pk_bf16_f32 v20, v20, v20
  v_cndmask_b32 v24, 0, v18, vcc
  v_and_b32 v20, 0xffff0000, v20
  s_waitcnt lgkmcnt(0)
  v_mfma_f32_32x32x16_bf16 v[64:79], v[224:227], v[136:139], v[64:79]
  ds_read_b64_tr_b16 v[232:233], v12 offset:22528
  ds_read_b64_tr_b16 v[234:235], v12 offset:23040
  ds_read_b64_tr_b16 v[236:237], v13 offset:22528
  ds_read_b64_tr_b16 v[238:239], v13 offset:23040
  v_add_f32 v20, 0x3727c5ac, v20
  v_mfma_f32_32x32x16_bf16 v[80:95], v[228:231], v[136:139], v[80:95]
  v_cvt_pk_bf16_f32 v20, v20, v20
  v_and_b32 v20, 0xffff0000, v20
  v_sqrt_f32 v20, v20
  s_waitcnt lgkmcnt(0)
  s_barrier
  v_mfma_f32_32x32x16_bf16 v[64:79], v[232:235], v[140:143], v[64:79]
  ds_read_b64_tr_b16 v[224:225], v12 offset:32768
  ds_read_b64_tr_b16 v[226:227], v12 offset:33280
  ds_read_b64_tr_b16 v[228:229], v13 offset:32768
  ds_read_b64_tr_b16 v[230:231], v13 offset:33280
  s_nop 0
  v_mfma_f32_32x32x16_bf16 v[80:95], v[236:239], v[140:143], v[80:95]
  v_cvt_pk_bf16_f32 v20, v20, v20
  v_and_b32 v20, 0xffff0000, v20
  v_rcp_f32 v22, v20
  s_waitcnt lgkmcnt(0)
  v_mfma_f32_32x32x16_bf16 v[64:79], v[224:227], v[144:147], v[64:79]
  ds_read_b64_tr_b16 v[232:233], v12 offset:34816
  ds_read_b64_tr_b16 v[234:235], v12 offset:35328
  ds_read_b64_tr_b16 v[236:237], v13 offset:34816
  ds_read_b64_tr_b16 v[238:239], v13 offset:35328
  v_mfma_f32_32x32x16_bf16 v[80:95], v[228:231], v[144:147], v[80:95]
  s_nop 0
  buffer_store_dword v22, v251, s[40:43], 0 offen
  s_waitcnt lgkmcnt(0)
  v_mfma_f32_32x32x16_bf16 v[64:79], v[232:235], v[148:151], v[64:79]
  ds_read_b64_tr_b16 v[224:225], v12 offset:36864
  ds_read_b64_tr_b16 v[226:227], v12 offset:37376
  ds_read_b64_tr_b16 v[228:229], v13 offset:36864
  ds_read_b64_tr_b16 v[230:231], v13 offset:37376
  ds_read_b64_tr_b16 v[6:7], v12 offset:38912
  ds_read_b64_tr_b16 v[8:9], v12 offset:39424
  ds_read_b64_tr_b16 v[18:19], v13 offset:38912
  ds_read_b64_tr_b16 v[20:21], v13 offset:39424
  v_mfma_f32_32x32x16_bf16 v[80:95], v[236:239], v[148:151], v[80:95]
  s_waitcnt lgkmcnt(4)
  v_mfma_f32_32x32x16_bf16 v[64:79], v[224:227], v[152:155], v[64:79]
  ds_read_b64_tr_b16 v[232:233], v12 offset:49152
  ds_read_b64_tr_b16 v[234:235], v12 offset:49664
  ds_read_b64_tr_b16 v[236:237], v13 offset:49152
  ds_read_b64_tr_b16 v[238:239], v13 offset:49664
  v_mfma_f32_32x32x16_bf16 v[80:95], v[228:231], v[152:155], v[80:95]
  s_waitcnt lgkmcnt(4)
  v_mfma_f32_32x32x16_bf16 v[64:79], v[6:9], v[156:159], v[64:79]
  ds_read_b64_tr_b16 v[224:225], v12 offset:51200
  ds_read_b64_tr_b16 v[226:227], v12 offset:51712
  ds_read_b64_tr_b16 v[228:229], v13 offset:51200
  ds_read_b64_tr_b16 v[230:231], v13 offset:51712
  v_mfma_f32_32x32x16_bf16 v[80:95], v[18:21], v[156:159], v[80:95]
  s_waitcnt lgkmcnt(4)
  v_mfma_f32_32x32x16_bf16 v[64:79], v[232:235], v[160:163], v[64:79]
  ds_read_b64_tr_b16 v[6:7], v12 offset:53248
  ds_read_b64_tr_b16 v[8:9], v12 offset:53760
  ds_read_b64_tr_b16 v[18:19], v13 offset:53248
  ds_read_b64_tr_b16 v[20:21], v13 offset:53760
  v_mfma_f32_32x32x16_bf16 v[80:95], v[236:239], v[160:163], v[80:95]
  s_waitcnt lgkmcnt(4)
  v_mfma_f32_32x32x16_bf16 v[64:79], v[224:227], v[164:167], v[64:79]
  ds_read_b64_tr_b16 v[232:233], v12 offset:55296
  ds_read_b64_tr_b16 v[234:235], v12 offset:55808
  ds_read_b64_tr_b16 v[236:237], v13 offset:55296
  ds_read_b64_tr_b16 v[238:239], v13 offset:55808
  v_mfma_f32_32x32x16_bf16 v[80:95], v[228:231], v[164:167], v[80:95]
  s_waitcnt lgkmcnt(4)
  s_barrier
  v_mfma_f32_32x32x16_bf16 v[64:79], v[6:9], v[168:171], v[64:79]
  ds_read_b64_tr_b16 v[224:225], v14 offset:0
  ds_read_b64_tr_b16 v[226:227], v14 offset:512
  ds_read_b64_tr_b16 v[228:229], v15 offset:0
  ds_read_b64_tr_b16 v[230:231], v15 offset:512
  v_mfma_f32_32x32x16_bf16 v[80:95], v[18:21], v[168:171], v[80:95]
  s_waitcnt lgkmcnt(4)
  v_mfma_f32_32x32x16_bf16 v[64:79], v[232:235], v[172:175], v[64:79]
  ds_read_b64_tr_b16 v[6:7], v14 offset:2048
  ds_read_b64_tr_b16 v[8:9], v14 offset:2560
  ds_read_b64_tr_b16 v[18:19], v15 offset:2048
  ds_read_b64_tr_b16 v[20:21], v15 offset:2560
  v_mfma_f32_32x32x16_bf16 v[80:95], v[236:239], v[172:175], v[80:95]
  s_cmp_le_u32 s17, 2
  s_cbranch_scc1 k1_yv
  s_waitcnt lgkmcnt(4)
  v_mfma_f32_32x32x16_bf16 v[64:79], v[224:227], v[176:179], v[64:79]
  ds_read_b128 v[252:255], v248 offset:0
  ds_read_b128 v[2:5], v248 offset:16
  ds_read_b64_tr_b16 v[232:233], v14 offset:4096
  ds_read_b64_tr_b16 v[234:235], v14 offset:4608
  ds_read_b64_tr_b16 v[236:237], v15 offset:4096
  ds_read_b64_tr_b16 v[238:239], v15 offset:4608
  v_mfma_f32_32x32x16_bf16 v[80:95], v[228:231], v[176:179], v[80:95]
  s_waitcnt lgkmcnt(4)
  v_mfma_f32_32x32x16_bf16 v[64:79], v[6:9], v[180:183], v[64:79]
  ds_read_b64_tr_b16 v[224:225], v14 offset:6144
  ds_read_b64_tr_b16 v[226:227], v14 offset:6656
  ds_read_b64_tr_b16 v[228:229], v15 offset:6144
  ds_read_b64_tr_b16 v[230:231], v15 offset:6656
  v_add_f32 v252, v252, v2
  v_add_f32 v253, v253, v3
  v_add_f32 v254, v254, v4
  v_add_f32 v255, v255, v5
  v_mfma_f32_32x32x16_bf16 v[80:95], v[18:21], v[180:183], v[80:95]
  v_add_f32 v252, v252, v253
  v_add_f32 v254, v254, v255
  v_add_f32 v252, v252, v254
  v_cvt_pk_bf16_f32 v253, v252, v252
  v_and_b32 v253, 0xffff0000, v253
  v_sub_f32 v253, v252, v253
  v_cvt_pk_bf16_f32 v28, v252, v253
  s_nop 1
  s_waitcnt lgkmcnt(4)
  v_mfma_f32_32x32x16_bf16 v[64:79], v[232:235], v[184:187], v[64:79]
  ds_read_b128 v[252:255], v248 offset:1024
  ds_read_b128 v[2:5], v248 offset:1040
  ds_read_b64_tr_b16 v[6:7], v14 offset:16384
  ds_read_b64_tr_b16 v[8:9], v14 offset:16896
  ds_read_b64_tr_b16 v[18:19], v15 offset:16384
  ds_read_b64_tr_b16 v[20:21], v15 offset:16896
  v_mfma_f32_32x32x16_bf16 v[80:95], v[236:239], v[184:187], v[80:95]
  v_mfma_f32_32x32x16_bf16 v[32:47], v[28:31], v[24:27], v[32:47]
  s_waitcnt lgkmcnt(4)
  v_mfma_f32_32x32x16_bf16 v[64:79], v[224:227], v[188:191], v[64:79]
  ds_read_b64_tr_b16 v[232:233], v14 offset:18432
  ds_read_b64_tr_b16 v[234:235], v14 offset:18944
  ds_read_b64_tr_b16 v[236:237], v15 offset:18432
  ds_read_b64_tr_b16 v[238:239], v15 offset:18944
  v_add_f32 v252, v252, v2
  v_add_f32 v253, v253, v3
  v_add_f32 v254, v254, v4
  v_add_f32 v255, v255, v5
  v_mfma_f32_32x32x16_bf16 v[80:95], v[228:231], v[188:191], v[80:95]
  v_add_f32 v252, v252, v253
  v_add_f32 v254, v254, v255
  v_add_f32 v252, v252, v254
  v_cvt_pk_bf16_f32 v253, v252, v252
  v_and_b32 v253, 0xffff0000, v253
  v_sub_f32 v253, v252, v253
  v_cvt_pk_bf16_f32 v28, v252, v253
  s_nop 1
  s_waitcnt lgkmcnt(4)
  v_mfma_f32_32x32x16_bf16 v[64:79], v[6:9], v[192:195], v[64:79]
  ds_read_b64_tr_b16 v[224:225], v14 offset:20480
  ds_read_b64_tr_b16 v[226:227], v14 offset:20992
  ds_read_b64_tr_b16 v[228:229], v15 offset:20480
  ds_read_b64_tr_b16 v[230:231], v15 offset:20992
  v_mfma_f32_32x32x16_bf16 v[48:63], v[28:31], v[24:27], v[48:63]
  v_cvt_pk_bf16_f32 v240, v32, v33
  v_cvt_pk_bf16_f32 v241, v34, v35
  v_mfma_f32_32x32x16_bf16 v[80:95], v[18:21], v[192:195], v[80:95]
  v_cvt_pk_bf16_f32 v242, v36, v37
  v_cvt_pk_bf16_f32 v243, v38, v39
  v_pk_max_i16 v240, v240, 0
  v_pk_max_i16 v241, v241, 0
  v_pk_max_i16 v242, v242, 0
  v_pk_max_i16 v243, v243, 0
  s_waitcnt lgkmcnt(4)
  v_mfma_f32_32x32x16_bf16 v[64:79], v[232:235], v[196:199], v[64:79]
  ds_read_b64_tr_b16 v[6:7], v14 offset:22528
  ds_read_b64_tr_b16 v[8:9], v14 offset:23040
  ds_read_b64_tr_b16 v[18:19], v15 offset:22528
  ds_read_b64_tr_b16 v[20:21], v15 offset:23040
  s_add_u32 s30, s36, 0
  buffer_store_dwordx4 v[240:243], v249, s[24:27], s30 offen sc0 sc1
  v_cvt_pk_bf16_f32 v244, v40, v41
  v_cvt_pk_bf16_f32 v245, v42, v43
  v_mfma_f32_32x32x16_bf16 v[80:95], v[236:239], v[196:199], v[80:95]
  v_cvt_pk_bf16_f32 v246, v44, v45
  v_cvt_pk_bf16_f32 v247, v46, v47
  v_pk_max_i16 v244, v244, 0
  v_pk_max_i16 v245, v245, 0
  v_pk_max_i16 v246, v246, 0
  v_pk_max_i16 v247, v247, 0
  s_waitcnt lgkmcnt(4)
  v_mfma_f32_32x32x16_bf16 v[64:79], v[224:227], v[200:203], v[64:79]
  ds_read_b64_tr_b16 v[232:233], v14 offset:32768
  ds_read_b64_tr_b16 v[234:235], v14 offset:33280
  ds_read_b64_tr_b16 v[236:237], v15 offset:32768
  ds_read_b64_tr_b16 v[238:239], v15 offset:33280
  v_mfma_f32_32x32x16_bf16 v[80:95], v[228:231], v[200:203], v[80:95]
  s_add_u32 s30, s36, 1024
  buffer_store_dwordx4 v[244:247], v249, s[24:27], s30 offen sc0 sc1
  s_waitcnt lgkmcnt(4)
  v_mfma_f32_32x32x16_bf16 v[64:79], v[6:9], v[204:207], v[64:79]
  ds_read_b64_tr_b16 v[224:225], v14 offset:34816
  ds_read_b64_tr_b16 v[226:227], v14 offset:35328
  ds_read_b64_tr_b16 v[228:229], v15 offset:34816
  ds_read_b64_tr_b16 v[230:231], v15 offset:35328
  s_nop 7
  v_cvt_pk_bf16_f32 v240, v48, v49
  v_cvt_pk_bf16_f32 v241, v50, v51
  v_mfma_f32_32x32x16_bf16 v[80:95], v[18:21], v[204:207], v[80:95]
  v_cvt_pk_bf16_f32 v242, v52, v53
  v_cvt_pk_bf16_f32 v243, v54, v55
  v_pk_max_i16 v240, v240, 0
  v_pk_max_i16 v241, v241, 0
  v_pk_max_i16 v242, v242, 0
  v_pk_max_i16 v243, v243, 0
  s_waitcnt lgkmcnt(4)
  v_mfma_f32_32x32x16_bf16 v[64:79], v[232:235], v[208:211], v[64:79]
  ds_read_b64_tr_b16 v[6:7], v14 offset:36864
  ds_read_b64_tr_b16 v[8:9], v14 offset:37376
  ds_read_b64_tr_b16 v[18:19], v15 offset:36864
  ds_read_b64_tr_b16 v[20:21], v15 offset:37376
  v_mfma_f32_32x32x16_bf16 v[80:95], v[236:239], v[208:211], v[80:95]
  s_add_u32 s30, s36, 2048
  buffer_store_dwordx4 v[240:243], v249, s[24:27], s30 offen sc0 sc1
  s_waitcnt lgkmcnt(4)
  v_mfma_f32_32x32x16_bf16 v[64:79], v[224:227], v[212:215], v[64:79]
  ds_read_b64_tr_b16 v[232:233], v14 offset:38912
  ds_read_b64_tr_b16 v[234:235], v14 offset:39424
  ds_read_b64_tr_b16 v[236:237], v15 offset:38912
  ds_read_b64_tr_b16 v[238:239], v15 offset:39424
  v_cvt_pk_bf16_f32 v244, v56, v57
  v_cvt_pk_bf16_f32 v245, v58, v59
  v_mfma_f32_32x32x16_bf16 v[80:95], v[228:231], v[212:215], v[80:95]
  v_cvt_pk_bf16_f32 v246, v60, v61
  v_cvt_pk_bf16_f32 v247, v62, v63
  v_pk_max_i16 v244, v244, 0
  v_pk_max_i16 v245, v245, 0
  v_pk_max_i16 v246, v246, 0
  v_pk_max_i16 v247, v247, 0
  s_waitcnt lgkmcnt(4)
  s_barrier
  v_mfma_f32_32x32x16_bf16 v[64:79], v[6:9], v[216:219], v[64:79]
  ds_read_b64_tr_b16 v[224:225], v16 offset:0
  ds_read_b64_tr_b16 v[226:227], v16 offset:256
  ds_read_b64_tr_b16 v[228:229], v16 offset:1024
  ds_read_b64_tr_b16 v[230:231], v16 offset:1280
  v_mfma_f32_32x32x16_bf16 v[80:95], v[18:21], v[216:219], v[80:95]
  s_add_u32 s30, s36, 3072
  buffer_store_dwordx4 v[244:247], v249, s[24:27], s30 offen sc0 sc1
  s_waitcnt lgkmcnt(4)
  v_mfma_f32_32x32x16_bf16 v[64:79], v[232:235], v[220:223], v[64:79]
  ds_read_b64_tr_b16 v[6:7], v16 offset:2048
  ds_read_b64_tr_b16 v[8:9], v16 offset:2304
  ds_read_b64_tr_b16 v[18:19], v16 offset:3072
  ds_read_b64_tr_b16 v[20:21], v16 offset:3328
  v_mfma_f32_32x32x16_bf16 v[80:95], v[236:239], v[220:223], v[80:95]
  s_waitcnt lgkmcnt(4)
  v_mfma_f32_32x32x16_bf16 v[96:111], v[224:227], v[112:115], v[96:111]
  ds_read_b128 v[252:255], v248 offset:2048
  ds_read_b128 v[2:5], v248 offset:2064
  ds_read_b64_tr_b16 v[232:233], v16 offset:16384
  ds_read_b64_tr_b16 v[234:235], v16 offset:16640
  ds_read_b64_tr_b16 v[236:237], v16 offset:17408
  ds_read_b64_tr_b16 v[238:239], v16 offset:17664
  v_mfma_f32_32x32x16_bf16 v[32:47], v[228:231], v[116:119], 0
  s_waitcnt lgkmcnt(4)
  v_mfma_f32_32x32x16_bf16 v[96:111], v[6:9], v[120:123], v[96:111]
  ds_read_b64_tr_b16 v[224:225], v16 offset:18432
  ds_read_b64_tr_b16 v[226:227], v16 offset:18688
  ds_read_b64_tr_b16 v[228:229], v16 offset:19456
  ds_read_b64_tr_b16 v[230:231], v16 offset:19712
  v_add_f32 v252, v252, v2
  v_add_f32 v253, v253, v3
  v_add_f32 v254, v254, v4
  v_add_f32 v255, v255, v5
  v_mfma_f32_32x32x16_bf16 v[32:47], v[18:21], v[124:127], v[32:47]
  v_add_f32 v252, v252, v253
  v_add_f32 v254, v254, v255
  v_add_f32 v252, v252, v254
  v_cvt_pk_bf16_f32 v253, v252, v252
  v_and_b32 v253, 0xffff0000, v253
  v_sub_f32 v253, v252, v253
  v_cvt_pk_bf16_f32 v28, v252, v253
  s_nop 1
  s_waitcnt lgkmcnt(4)
  v_mfma_f32_32x32x16_bf16 v[96:111], v[232:235], v[128:131], v[96:111]
  ds_read_b128 v[252:255], v248 offset:3072
  ds_read_b128 v[2:5], v248 offset:3088
  ds_read_b64_tr_b16 v[6:7], v16 offset:32768
  ds_read_b64_tr_b16 v[8:9], v16 offset:33024
  ds_read_b64_tr_b16 v[18:19], v16 offset:33792
  ds_read_b64_tr_b16 v[20:21], v16 offset:34048
  v_mfma_f32_32x32x16_bf16 v[32:47], v[236:239], v[132:135], v[32:47]
  v_mfma_f32_32x32x16_bf16 v[64:79], v[28:31], v[24:27], v[64:79]
  s_waitcnt lgkmcnt(4)
  v_mfma_f32_32x32x16_bf16 v[96:111], v[224:227], v[136:139], v[96:111]
  ds_read_b64_tr_b16 v[232:233], v16 offset:34816
  ds_read_b64_tr_b16 v[234:235], v16 offset:35072
  ds_read_b64_tr_b16 v[236:237], v16 offset:35840
  ds_read_b64_tr_b16 v[238:239], v16 offset:36096
  v_add_f32 v252, v252, v2
  v_add_f32 v253, v253, v3
  v_add_f32 v254, v254, v4
  v_add_f32 v255, v255, v5
  v_mfma_f32_32x32x16_bf16 v[32:47], v[228:231], v[140:143], v[32:47]
  v_add_f32 v252, v252, v253
  v_add_f32 v254, v254, v255
  v_add_f32 v252, v252, v254
  v_cvt_pk_bf16_f32 v253, v252, v252
  v_and_b32 v253, 0xffff0000, v253
  v_sub_f32 v253, v252, v253
  v_cvt_pk_bf16_f32 v28, v252, v253
  s_nop 1
  s_waitcnt lgkmcnt(4)
  v_mfma_f32_32x32x16_bf16 v[96:111], v[6:9], v[144:147], v[96:111]
  ds_read_b64_tr_b16 v[224:225], v16 offset:49152
  ds_read_b64_tr_b16 v[226:227], v16 offset:49408
  ds_read_b64_tr_b16 v[228:229], v16 offset:50176
  ds_read_b64_tr_b16 v[230:231], v16 offset:50432
  v_mfma_f32_32x32x16_bf16 v[80:95], v[28:31], v[24:27], v[80:95]
  v_cvt_pk_bf16_f32 v240, v64, v65
  v_cvt_pk_bf16_f32 v241, v66, v67
  v_mfma_f32_32x32x16_bf16 v[32:47], v[18:21], v[148:151], v[32:47]
  v_cvt_pk_bf16_f32 v242, v68, v69
  v_cvt_pk_bf16_f32 v243, v70, v71
  v_pk_max_i16 v240, v240, 0
  v_pk_max_i16 v241, v241, 0
  v_pk_max_i16 v242, v242, 0
  v_pk_max_i16 v243, v243, 0
  s_waitcnt lgkmcnt(4)
  v_mfma_f32_32x32x16_bf16 v[96:111], v[232:235], v[152:155], v[96:111]
  ds_read_b64_tr_b16 v[6:7], v16 offset:51200
  ds_read_b64_tr_b16 v[8:9], v16 offset:51456
  ds_read_b64_tr_b16 v[18:19], v16 offset:52224
  ds_read_b64_tr_b16 v[20:21], v16 offset:52480
  s_add_u32 s30, s36, 4096
  buffer_store_dwordx4 v[240:243], v249, s[24:27], s30 offen sc0 sc1
  v_cvt_pk_bf16_f32 v244, v72, v73
  v_cvt_pk_bf16_f32 v245, v74, v75
  v_mfma_f32_32x32x16_bf16 v[32:47], v[236:239], v[156:159], v[32:47]
  v_cvt_pk_bf16_f32 v246, v76, v77
  v_cvt_pk_bf16_f32 v247, v78, v79
  v_pk_max_i16 v244, v244, 0
  v_pk_max_i16 v245, v245, 0
  v_pk_max_i16 v246, v246, 0
  v_pk_max_i16 v247, v247, 0
  s_waitcnt lgkmcnt(4)
  v_mfma_f32_32x32x16_bf16 v[96:111], v[224:227], v[160:163], v[96:111]
  ds_read_b64_tr_b16 v[232:233], v17 offset:0
  ds_read_b64_tr_b16 v[234:235], v17 offset:256
  ds_read_b64_tr_b16 v[236:237], v17 offset:1024
  ds_read_b64_tr_b16 v[238:239], v17 offset:1280
  v_mfma_f32_32x32x16_bf16 v[32:47], v[228:231], v[164:167], v[32:47]
  s_add_u32 s30, s36, 5120
  buffer_store_dwordx4 v[244:247], v249, s[24:27], s30 offen sc0 sc1
  s_waitcnt lgkmcnt(4)
  v_mfma_f32_32x32x16_bf16 v[96:111], v[6:9], v[168:171], v[96:111]
  ds_read_b64_tr_b16 v[224:225], v17 offset:2048
  ds_read_b64_tr_b16 v[226:227], v17 offset:2304
  ds_read_b64_tr_b16 v[228:229], v17 offset:3072
  ds_read_b64_tr_b16 v[230:231], v17 offset:3328
  s_nop 7
  v_cvt_pk_bf16_f32 v240, v80, v81
  v_cvt_pk_bf16_f32 v241, v82, v83
  v_mfma_f32_32x32x16_bf16 v[32:47], v[18:21], v[172:175], v[32:47]
  v_cvt_pk_bf16_f32 v242, v84, v85
  v_cvt_pk_bf16_f32 v243, v86, v87
  v_pk_max_i16 v240, v240, 0
  v_pk_max_i16 v241, v241, 0
  v_pk_max_i16 v242, v242, 0
  v_pk_max_i16 v243, v243, 0
  s_waitcnt lgkmcnt(4)
  v_mfma_f32_32x32x16_bf16 v[96:111], v[232:235], v[176:179], v[96:111]
  ds_read_b64_tr_b16 v[6:7], v17 offset:16384
  ds_read_b64_tr_b16 v[8:9], v17 offset:16640
  ds_read_b64_tr_b16 v[18:19], v17 offset:17408
  ds_read_b64_tr_b16 v[20:21], v17 offset:17664
  v_mfma_f32_32x32x16_bf16 v[32:47], v[236:239], v[180:183], v[32:47]
  s_add_u32 s30, s36, 6144
  buffer_store_dwordx4 v[240:243], v249, s[24:27], s30 offen sc0 sc1
  s_waitcnt lgkmcnt(4)
  s_barrier
  v_mfma_f32_32x32x16_bf16 v[96:111], v[224:227], v[184:187], v[96:111]
  ds_read_b64_tr_b16 v[232:233], v17 offset:18432
  ds_read_b64_tr_b16 v[234:235], v17 offset:18688
  ds_read_b64_tr_b16 v[236:237], v17 offset:19456
  ds_read_b64_tr_b16 v[238:239], v17 offset:19712
  v_cvt_pk_bf16_f32 v244, v88, v89
  v_cvt_pk_bf16_f32 v245, v90, v91
  v_mfma_f32_32x32x16_bf16 v[32:47], v[228:231], v[188:191], v[32:47]
  v_cvt_pk_bf16_f32 v246, v92, v93
  v_cvt_pk_bf16_f32 v247, v94, v95
  v_pk_max_i16 v244, v244, 0
  v_pk_max_i16 v245, v245, 0
  v_pk_max_i16 v246, v246, 0
  v_pk_max_i16 v247, v247, 0
  s_waitcnt lgkmcnt(4)
  v_mfma_f32_32x32x16_bf16 v[96:111], v[6:9], v[192:195], v[96:111]
  ds_read_b64_tr_b16 v[224:225], v17 offset:32768
  ds_read_b64_tr_b16 v[226:227], v17 offset:33024
  ds_read_b64_tr_b16 v[228:229], v17 offset:33792
  ds_read_b64_tr_b16 v[230:231], v17 offset:34048
  v_mfma_f32_32x32x16_bf16 v[32:47], v[18:21], v[196:199], v[32:47]
  s_add_u32 s30, s36, 7168
  buffer_store_dwordx4 v[244:247], v249, s[24:27], s30 offen sc0 sc1
  s_waitcnt lgkmcnt(4)
  v_mfma_f32_32x32x16_bf16 v[96:111], v[232:235], v[200:203], v[96:111]
  ds_read_b128 v[252:255], v248 offset:4096
  ds_read_b128 v[2:5], v248 offset:4112
  ds_read_b64_tr_b16 v[6:7], v17 offset:34816
  ds_read_b64_tr_b16 v[8:9], v17 offset:35072
  ds_read_b64_tr_b16 v[18:19], v17 offset:35840
  ds_read_b64_tr_b16 v[20:21], v17 offset:36096
  v_mfma_f32_32x32x16_bf16 v[32:47], v[236:239], v[204:207], v[32:47]
  s_waitcnt lgkmcnt(4)
  v_mfma_f32_32x32x16_bf16 v[96:111], v[224:227], v[208:211], v[96:111]
  v_add_f32 v252, v252, v2
  v_add_f32 v253, v253, v3
  v_add_f32 v254, v254, v4
  v_add_f32 v255, v255, v5
  v_mfma_f32_32x32x16_bf16 v[32:47], v[228:231], v[212:215], v[32:47]
  v_add_f32 v252, v252, v253
  v_add_f32 v254, v254, v255
  v_add_f32 v252, v252, v254
  v_cvt_pk_bf16_f32 v253, v252, v252
  v_and_b32 v253, 0xffff0000, v253
  v_sub_f32 v253, v252, v253
  v_cvt_pk_bf16_f32 v28, v252, v253
  s_nop 1
  s_waitcnt lgkmcnt(0)
  v_mfma_f32_32x32x16_bf16 v[96:111], v[6:9], v[216:219], v[96:111]
  v_mfma_f32_32x32x16_bf16 v[32:47], v[18:21], v[220:223], v[32:47]
  s_branch k1_fin
k1_yv:
  s_waitcnt lgkmcnt(4)
  v_mfma_f32_32x32x16_bf16 v[64:79], v[224:227], v[176:179], v[64:79]
  ds_read_b128 v[252:255], v248 offset:0
  ds_read_b128 v[2:5], v248 offset:16
  ds_read_b64_tr_b16 v[232:233], v14 offset:4096
  ds_read_b64_tr_b16 v[234:235], v14 offset:4608
  ds_read_b64_tr_b16 v[236:237], v15 offset:4096
  ds_read_b64_tr_b16 v[238:239], v15 offset:4608
  v_mfma_f32_32x32x16_bf16 v[80:95], v[228:231], v[176:179], v[80:95]
  s_waitcnt lgkmcnt(4)
  v_mfma_f32_32x32x16_bf16 v[64:79], v[6:9], v[180:183], v[64:79]
  ds_read_b64_tr_b16 v[224:225], v14 offset:6144
  ds_read_b64_tr_b16 v[226:227], v14 offset:6656
  ds_read_b64_tr_b16 v[228:229], v15 offset:6144
  ds_read_b64_tr_b16 v[230:231], v15 offset:6656
  v_add_f32 v252, v252, v2
  v_add_f32 v253, v253, v3
  v_add_f32 v254, v254, v4
  v_add_f32 v255, v255, v5
  v_mfma_f32_32x32x16_bf16 v[80:95], v[18:21], v[180:183], v[80:95]
  v_add_f32 v252, v252, v253
  v_add_f32 v254, v254, v255
  v_add_f32 v252, v252, v254
  v_cvt_pk_bf16_f32 v253, v252, v252
  v_and_b32 v253, 0xffff0000, v253
  v_sub_f32 v253, v252, v253
  v_cvt_pk_bf16_f32 v28, v252, v253
  s_nop 1
  s_waitcnt lgkmcnt(4)
  v_mfma_f32_32x32x16_bf16 v[64:79], v[232:235], v[184:187], v[64:79]
  ds_read_b128 v[252:255], v248 offset:1024
  ds_read_b128 v[2:5], v248 offset:1040
  ds_read_b64_tr_b16 v[6:7], v14 offset:16384
  ds_read_b64_tr_b16 v[8:9], v14 offset:16896
  ds_read_b64_tr_b16 v[18:19], v15 offset:16384
  ds_read_b64_tr_b16 v[20:21], v15 offset:16896
  v_mfma_f32_32x32x16_bf16 v[80:95], v[236:239], v[184:187], v[80:95]
  v_mfma_f32_32x32x16_bf16 v[32:47], v[28:31], v[24:27], v[32:47]
  s_waitcnt lgkmcnt(4)
  v_mfma_f32_32x32x16_bf16 v[64:79], v[224:227], v[188:191], v[64:79]
  ds_read_b64_tr_b16 v[232:233], v14 offset:18432
  ds_read_b64_tr_b16 v[234:235], v14 offset:18944
  ds_read_b64_tr_b16 v[236:237], v15 offset:18432
  ds_read_b64_tr_b16 v[238:239], v15 offset:18944
  v_add_f32 v252, v252, v2
  v_add_f32 v253, v253, v3
  v_add_f32 v254, v254, v4
  v_add_f32 v255, v255, v5
  v_mfma_f32_32x32x16_bf16 v[80:95], v[228:231], v[188:191], v[80:95]
  v_add_f32 v252, v252, v253
  v_add_f32 v254, v254, v255
  v_add_f32 v252, v252, v254
  v_cvt_pk_bf16_f32 v253, v252, v252
  v_and_b32 v253, 0xffff0000, v253
  v_sub_f32 v253, v252, v253
  v_cvt_pk_bf16_f32 v28, v252, v253
  s_nop 1
  s_waitcnt lgkmcnt(4)
  v_mfma_f32_32x32x16_bf16 v[64:79], v[6:9], v[192:195], v[64:79]
  ds_read_b64_tr_b16 v[224:225], v14 offset:20480
  ds_read_b64_tr_b16 v[226:227], v14 offset:20992
  ds_read_b64_tr_b16 v[228:229], v15 offset:20480
  ds_read_b64_tr_b16 v[230:231], v15 offset:20992
  v_mfma_f32_32x32x16_bf16 v[48:63], v[28:31], v[24:27], v[48:63]
  v_mul_f32 v32, v32, v22
  v_mul_f32 v33, v33, v22
  v_mul_f32 v34, v34, v22
  v_mfma_f32_32x32x16_bf16 v[80:95], v[18:21], v[192:195], v[80:95]
  v_mul_f32 v35, v35, v22
  v_mul_f32 v36, v36, v22
  v_mul_f32 v37, v37, v22
  v_mul_f32 v38, v38, v22
  v_mul_f32 v39, v39, v22
  v_cvt_pk_bf16_f32 v240, v32, v33
  v_cvt_pk_bf16_f32 v241, v34, v35
  v_cvt_pk_bf16_f32 v242, v36, v37
  v_cvt_pk_bf16_f32 v243, v38, v39
  s_waitcnt lgkmcnt(4)
  v_mfma_f32_32x32x16_bf16 v[64:79], v[232:235], v[196:199], v[64:79]
  ds_read_b64_tr_b16 v[6:7], v14 offset:22528
  ds_read_b64_tr_b16 v[8:9], v14 offset:23040
  ds_read_b64_tr_b16 v[18:19], v15 offset:22528
  ds_read_b64_tr_b16 v[20:21], v15 offset:23040
  s_add_u32 s30, s37, 0
  buffer_store_dword v240, v250, s[32:35], s30 offen sc0 sc1
  s_add_u32 s30, s37, 8192
  buffer_store_dword v241, v250, s[32:35], s30 offen sc0 sc1
  s_add_u32 s30, s37, 32768
  buffer_store_dword v242, v250, s[32:35], s30 offen sc0 sc1
  s_add_u32 s30, s37, 40960
  buffer_store_dword v243, v250, s[32:35], s30 offen sc0 sc1
  v_mul_f32 v40, v40, v22
  v_mfma_f32_32x32x16_bf16 v[80:95], v[236:239], v[196:199], v[80:95]
  v_mul_f32 v41, v41, v22
  v_mul_f32 v42, v42, v22
  v_mul_f32 v43, v43, v22
  v_mul_f32 v44, v44, v22
  v_mul_f32 v45, v45, v22
  v_mul_f32 v46, v46, v22
  v_mul_f32 v47, v47, v22
  v_cvt_pk_bf16_f32 v244, v40, v41
  v_cvt_pk_bf16_f32 v245, v42, v43
  v_cvt_pk_bf16_f32 v246, v44, v45
  v_cvt_pk_bf16_f32 v247, v46, v47
  s_waitcnt lgkmcnt(4)
  v_mfma_f32_32x32x16_bf16 v[64:79], v[224:227], v[200:203], v[64:79]
  ds_read_b64_tr_b16 v[232:233], v14 offset:32768
  ds_read_b64_tr_b16 v[234:235], v14 offset:33280
  ds_read_b64_tr_b16 v[236:237], v15 offset:32768
  ds_read_b64_tr_b16 v[238:239], v15 offset:33280
  s_add_u32 s30, s37, 65536
  buffer_store_dword v244, v250, s[32:35], s30 offen sc0 sc1
  v_mfma_f32_32x32x16_bf16 v[80:95], v[228:231], v[200:203], v[80:95]
  s_add_u32 s30, s37, 73728
  buffer_store_dword v245, v250, s[32:35], s30 offen sc0 sc1
  s_add_u32 s30, s37, 98304
  buffer_store_dword v246, v250, s[32:35], s30 offen sc0 sc1
  s_add_u32 s30, s37, 106496
  buffer_store_dword v247, v250, s[32:35], s30 offen sc0 sc1
  s_waitcnt lgkmcnt(4)
  v_mfma_f32_32x32x16_bf16 v[64:79], v[6:9], v[204:207], v[64:79]
  ds_read_b64_tr_b16 v[224:225], v14 offset:34816
  ds_read_b64_tr_b16 v[226:227], v14 offset:35328
  ds_read_b64_tr_b16 v[228:229], v15 offset:34816
  ds_read_b64_tr_b16 v[230:231], v15 offset:35328
  s_nop 7
  v_mul_f32 v48, v48, v22
  v_mul_f32 v49, v49, v22
  v_mul_f32 v50, v50, v22
  v_mfma_f32_32x32x16_bf16 v[80:95], v[18:21], v[204:207], v[80:95]
  v_mul_f32 v51, v51, v22
  v_mul_f32 v52, v52, v22
  v_mul_f32 v53, v53, v22
  v_mul_f32 v54, v54, v22
  v_mul_f32 v55, v55, v22
  v_cvt_pk_bf16_f32 v240, v48, v49
  v_cvt_pk_bf16_f32 v241, v50, v51
  v_cvt_pk_bf16_f32 v242, v52, v53
  v_cvt_pk_bf16_f32 v243, v54, v55
  s_waitcnt lgkmcnt(4)
  v_mfma_f32_32x32x16_bf16 v[64:79], v[232:235], v[208:211], v[64:79]
  ds_read_b64_tr_b16 v[6:7], v14 offset:36864
  ds_read_b64_tr_b16 v[8:9], v14 offset:37376
  ds_read_b64_tr_b16 v[18:19], v15 offset:36864
  ds_read_b64_tr_b16 v[20:21], v15 offset:37376
  s_add_u32 s30, s37, 131072
  buffer_store_dword v240, v250, s[32:35], s30 offen sc0 sc1
  v_mfma_f32_32x32x16_bf16 v[80:95], v[236:239], v[208:211], v[80:95]
  s_add_u32 s30, s37, 139264
  buffer_store_dword v241, v250, s[32:35], s30 offen sc0 sc1
  s_add_u32 s30, s37, 163840
  buffer_store_dword v242, v250, s[32:35], s30 offen sc0 sc1
  s_add_u32 s30, s37, 172032
  buffer_store_dword v243, v250, s[32:35], s30 offen sc0 sc1
  s_waitcnt lgkmcnt(4)
  v_mfma_f32_32x32x16_bf16 v[64:79], v[224:227], v[212:215], v[64:79]
  ds_read_b64_tr_b16 v[232:233], v14 offset:38912
  ds_read_b64_tr_b16 v[234:235], v14 offset:39424
  ds_read_b64_tr_b16 v[236:237], v15 offset:38912
  ds_read_b64_tr_b16 v[238:239], v15 offset:39424
  v_mul_f32 v56, v56, v22
  v_mul_f32 v57, v57, v22
  v_mul_f32 v58, v58, v22
  v_mul_f32 v59, v59, v22
  v_mfma_f32_32x32x16_bf16 v[80:95], v[228:231], v[212:215], v[80:95]
  v_mul_f32 v60, v60, v22
  v_mul_f32 v61, v61, v22
  v_mul_f32 v62, v62, v22
  v_mul_f32 v63, v63, v22
  v_cvt_pk_bf16_f32 v244, v56, v57
  v_cvt_pk_bf16_f32 v245, v58, v59
  v_cvt_pk_bf16_f32 v246, v60, v61
  v_cvt_pk_bf16_f32 v247, v62, v63
  s_waitcnt lgkmcnt(4)
  s_barrier
  v_mfma_f32_32x32x16_bf16 v[64:79], v[6:9], v[216:219], v[64:79]
  ds_read_b64_tr_b16 v[224:225], v16 offset:0
  ds_read_b64_tr_b16 v[226:227], v16 offset:256
  ds_read_b64_tr_b16 v[228:229], v16 offset:1024
  ds_read_b64_tr_b16 v[230:231], v16 offset:1280
  s_add_u32 s30, s37, 196608
  buffer_store_dword v244, v250, s[32:35], s30 offen sc0 sc1
  v_mfma_f32_32x32x16_bf16 v[80:95], v[18:21], v[216:219], v[80:95]
  s_add_u32 s30, s37, 204800
  buffer_store_dword v245, v250, s[32:35], s30 offen sc0 sc1
  s_add_u32 s30, s37, 229376
  buffer_store_dword v246, v250, s[32:35], s30 offen sc0 sc1
  s_add_u32 s30, s37, 237568
  buffer_store_dword v247, v250, s[32:35], s30 offen sc0 sc1
  s_waitcnt lgkmcnt(4)
  v_mfma_f32_32x32x16_bf16 v[64:79], v[232:235], v[220:223], v[64:79]
  ds_read_b64_tr_b16 v[6:7], v16 offset:2048
  ds_read_b64_tr_b16 v[8:9], v16 offset:2304
  ds_read_b64_tr_b16 v[18:19], v16 offset:3072
  ds_read_b64_tr_b16 v[20:21], v16 offset:3328
  v_mfma_f32_32x32x16_bf16 v[80:95], v[236:239], v[220:223], v[80:95]
  s_waitcnt lgkmcnt(4)
  v_mfma_f32_32x32x16_bf16 v[96:111], v[224:227], v[112:115], v[96:111]
  ds_read_b128 v[252:255], v248 offset:2048
  ds_read_b128 v[2:5], v248 offset:2064
  ds_read_b64_tr_b16 v[232:233], v16 offset:16384
  ds_read_b64_tr_b16 v[234:235], v16 offset:16640
  ds_read_b64_tr_b16 v[236:237], v16 offset:17408
  ds_read_b64_tr_b16 v[238:239], v16 offset:17664
  v_mfma_f32_32x32x16_bf16 v[32:47], v[228:231], v[116:119], 0
  s_waitcnt lgkmcnt(4)
  v_mfma_f32_32x32x16_bf16 v[96:111], v[6:9], v[120:123], v[96:111]
  ds_read_b64_tr_b16 v[224:225], v16 offset:18432
  ds_read_b64_tr_b16 v[226:227], v16 offset:18688
  ds_read_b64_tr_b16 v[228:229], v16 offset:19456
  ds_read_b64_tr_b16 v[230:231], v16 offset:19712
  v_add_f32 v252, v252, v2
  v_add_f32 v253, v253, v3
  v_add_f32 v254, v254, v4
  v_add_f32 v255, v255, v5
  v_mfma_f32_32x32x16_bf16 v[32:47], v[18:21], v[124:127], v[32:47]
  v_add_f32 v252, v252, v253
  v_add_f32 v254, v254, v255
  v_add_f32 v252, v252, v254
  v_cvt_pk_bf16_f32 v253, v252, v252
  v_and_b32 v253, 0xffff0000, v253
  v_sub_f32 v253, v252, v253
  v_cvt_pk_bf16_f32 v28, v252, v253
  s_nop 1
  s_waitcnt lgkmcnt(4)
  v_mfma_f32_32x32x16_bf16 v[96:111], v[232:235], v[128:131], v[96:111]
  ds_read_b128 v[252:255], v248 offset:3072
  ds_read_b128 v[2:5], v248 offset:3088
  ds_read_b64_tr_b16 v[6:7], v16 offset:32768
  ds_read_b64_tr_b16 v[8:9], v16 offset:33024
  ds_read_b64_tr_b16 v[18:19], v16 offset:33792
  ds_read_b64_tr_b16 v[20:21], v16 offset:34048
  v_mfma_f32_32x32x16_bf16 v[32:47], v[236:239], v[132:135], v[32:47]
  v_mfma_f32_32x32x16_bf16 v[64:79], v[28:31], v[24:27], v[64:79]
  s_waitcnt lgkmcnt(4)
  v_mfma_f32_32x32x16_bf16 v[96:111], v[224:227], v[136:139], v[96:111]
  ds_read_b64_tr_b16 v[232:233], v16 offset:34816
  ds_read_b64_tr_b16 v[234:235], v16 offset:35072
  ds_read_b64_tr_b16 v[236:237], v16 offset:35840
  ds_read_b64_tr_b16 v[238:239], v16 offset:36096
  v_add_f32 v252, v252, v2
  v_add_f32 v253, v253, v3
  v_add_f32 v254, v254, v4
  v_add_f32 v255, v255, v5
  v_mfma_f32_32x32x16_bf16 v[32:47], v[228:231], v[140:143], v[32:47]
  v_add_f32 v252, v252, v253
  v_add_f32 v254, v254, v255
  v_add_f32 v252, v252, v254
  v_cvt_pk_bf16_f32 v253, v252, v252
  v_and_b32 v253, 0xffff0000, v253
  v_sub_f32 v253, v252, v253
  v_cvt_pk_bf16_f32 v28, v252, v253
  s_nop 1
  s_waitcnt lgkmcnt(4)
  v_mfma_f32_32x32x16_bf16 v[96:111], v[6:9], v[144:147], v[96:111]
  ds_read_b64_tr_b16 v[224:225], v16 offset:49152
  ds_read_b64_tr_b16 v[226:227], v16 offset:49408
  ds_read_b64_tr_b16 v[228:229], v16 offset:50176
  ds_read_b64_tr_b16 v[230:231], v16 offset:50432
  v_mfma_f32_32x32x16_bf16 v[80:95], v[28:31], v[24:27], v[80:95]
  v_mul_f32 v64, v64, v22
  v_mul_f32 v65, v65, v22
  v_mul_f32 v66, v66, v22
  v_mfma_f32_32x32x16_bf16 v[32:47], v[18:21], v[148:151], v[32:47]
  v_mul_f32 v67, v67, v22
  v_mul_f32 v68, v68, v22
  v_mul_f32 v69, v69, v22
  v_mul_f32 v70, v70, v22
  v_mul_f32 v71, v71, v22
  v_cvt_pk_bf16_f32 v240, v64, v65
  v_cvt_pk_bf16_f32 v241, v66, v67
  v_cvt_pk_bf16_f32 v242, v68, v69
  v_cvt_pk_bf16_f32 v243, v70, v71
  s_waitcnt lgkmcnt(4)
  v_mfma_f32_32x32x16_bf16 v[96:111], v[232:235], v[152:155], v[96:111]
  ds_read_b64_tr_b16 v[6:7], v16 offset:51200
  ds_read_b64_tr_b16 v[8:9], v16 offset:51456
  ds_read_b64_tr_b16 v[18:19], v16 offset:52224
  ds_read_b64_tr_b16 v[20:21], v16 offset:52480
  s_add_u32 s30, s37, 262144
  buffer_store_dword v240, v250, s[32:35], s30 offen sc0 sc1
  s_add_u32 s30, s37, 270336
  buffer_store_dword v241, v250, s[32:35], s30 offen sc0 sc1
  s_add_u32 s30, s37, 294912
  buffer_store_dword v242, v250, s[32:35], s30 offen sc0 sc1
  s_add_u32 s30, s37, 303104
  buffer_store_dword v243, v250, s[32:35], s30 offen sc0 sc1
  v_mul_f32 v72, v72, v22
  v_mfma_f32_32x32x16_bf16 v[32:47], v[236:239], v[156:159], v[32:47]
  v_mul_f32 v73, v73, v22
  v_mul_f32 v74, v74, v22
  v_mul_f32 v75, v75, v22
  v_mul_f32 v76, v76, v22
  v_mul_f32 v77, v77, v22
  v_mul_f32 v78, v78, v22
  v_mul_f32 v79, v79, v22
  v_cvt_pk_bf16_f32 v244, v72, v73
  v_cvt_pk_bf16_f32 v245, v74, v75
  v_cvt_pk_bf16_f32 v246, v76, v77
  v_cvt_pk_bf16_f32 v247, v78, v79
  s_waitcnt lgkmcnt(4)
  v_mfma_f32_32x32x16_bf16 v[96:111], v[224:227], v[160:163], v[96:111]
  ds_read_b64_tr_b16 v[232:233], v17 offset:0
  ds_read_b64_tr_b16 v[234:235], v17 offset:256
  ds_read_b64_tr_b16 v[236:237], v17 offset:1024
  ds_read_b64_tr_b16 v[238:239], v17 offset:1280
  s_add_u32 s30, s37, 327680
  buffer_store_dword v244, v250, s[32:35], s30 offen sc0 sc1
  v_mfma_f32_32x32x16_bf16 v[32:47], v[228:231], v[164:167], v[32:47]
  s_add_u32 s30, s37, 335872
  buffer_store_dword v245, v250, s[32:35], s30 offen sc0 sc1
  s_add_u32 s30, s37, 360448
  buffer_store_dword v246, v250, s[32:35], s30 offen sc0 sc1
  s_add_u32 s30, s37, 368640
  buffer_store_dword v247, v250, s[32:35], s30 offen sc0 sc1
  s_waitcnt lgkmcnt(4)
  v_mfma_f32_32x32x16_bf16 v[96:111], v[6:9], v[168:171], v[96:111]
  ds_read_b64_tr_b16 v[224:225], v17 offset:2048
  ds_read_b64_tr_b16 v[226:227], v17 offset:2304
  ds_read_b64_tr_b16 v[228:229], v17 offset:3072
  ds_read_b64_tr_b16 v[230:231], v17 offset:3328
  s_nop 7
  v_mul_f32 v80, v80, v22
  v_mul_f32 v81, v81, v22
  v_mul_f32 v82, v82, v22
  v_mfma_f32_32x32x16_bf16 v[32:47], v[18:21], v[172:175], v[32:47]
  v_mul_f32 v83, v83, v22
  v_mul_f32 v84, v84, v22
  v_mul_f32 v85, v85, v22
  v_mul_f32 v86, v86, v22
  v_mul_f32 v87, v87, v22
  v_cvt_pk_bf16_f32 v240, v80, v81
  v_cvt_pk_bf16_f32 v241, v82, v83
  v_cvt_pk_bf16_f32 v242, v84, v85
  v_cvt_pk_bf16_f32 v243, v86, v87
  s_waitcnt lgkmcnt(4)
  v_mfma_f32_32x32x16_bf16 v[96:111], v[232:235], v[176:179], v[96:111]
  ds_read_b64_tr_b16 v[6:7], v17 offset:16384
  ds_read_b64_tr_b16 v[8:9], v17 offset:16640
  ds_read_b64_tr_b16 v[18:19], v17 offset:17408
  ds_read_b64_tr_b16 v[20:21], v17 offset:17664
  s_add_u32 s30, s37, 393216
  buffer_store_dword v240, v250, s[32:35], s30 offen sc0 sc1
  v_mfma_f32_32x32x16_bf16 v[32:47], v[236:239], v[180:183], v[32:47]
  s_add_u32 s30, s37, 401408
  buffer_store_dword v241, v250, s[32:35], s30 offen sc0 sc1
  s_add_u32 s30, s37, 425984
  buffer_store_dword v242, v250, s[32:35], s30 offen sc0 sc1
  s_add_u32 s30, s37, 434176
  buffer_store_dword v243, v250, s[32:35], s30 offen sc0 sc1
  s_waitcnt lgkmcnt(4)
  s_barrier
  v_mfma_f32_32x32x16_bf16 v[96:111], v[224:227], v[184:187], v[96:111]
  ds_read_b64_tr_b16 v[232:233], v17 offset:18432
  ds_read_b64_tr_b16 v[234:235], v17 offset:18688
  ds_read_b64_tr_b16 v[236:237], v17 offset:19456
  ds_read_b64_tr_b16 v[238:239], v17 offset:19712
  v_mul_f32 v88, v88, v22
  v_mul_f32 v89, v89, v22
  v_mul_f32 v90, v90, v22
  v_mul_f32 v91, v91, v22
  v_mfma_f32_32x32x16_bf16 v[32:47], v[228:231], v[188:191], v[32:47]
  v_mul_f32 v92, v92, v22
  v_mul_f32 v93, v93, v22
  v_mul_f32 v94, v94, v22
  v_mul_f32 v95, v95, v22
  v_cvt_pk_bf16_f32 v244, v88, v89
  v_cvt_pk_bf16_f32 v245, v90, v91
  v_cvt_pk_bf16_f32 v246, v92, v93
  v_cvt_pk_bf16_f32 v247, v94, v95
  s_waitcnt lgkmcnt(4)
  v_mfma_f32_32x32x16_bf16 v[96:111], v[6:9], v[192:195], v[96:111]
  ds_read_b64_tr_b16 v[224:225], v17 offset:32768
  ds_read_b64_tr_b16 v[226:227], v17 offset:33024
  ds_read_b64_tr_b16 v[228:229], v17 offset:33792
  ds_read_b64_tr_b16 v[230:231], v17 offset:34048
  s_add_u32 s30, s37, 458752
  buffer_store_dword v244, v250, s[32:35], s30 offen sc0 sc1
  v_mfma_f32_32x32x16_bf16 v[32:47], v[18:21], v[196:199], v[32:47]
  s_add_u32 s30, s37, 466944
  buffer_store_dword v245, v250, s[32:35], s30 offen sc0 sc1
  s_add_u32 s30, s37, 491520
  buffer_store_dword v246, v250, s[32:35], s30 offen sc0 sc1
  s_add_u32 s30, s37, 499712
  buffer_store_dword v247, v250, s[32:35], s30 offen sc0 sc1
  s_waitcnt lgkmcnt(4)
  v_mfma_f32_32x32x16_bf16 v[96:111], v[232:235], v[200:203], v[96:111]
  ds_read_b128 v[252:255], v248 offset:4096
  ds_read_b128 v[2:5], v248 offset:4112
  ds_read_b64_tr_b16 v[6:7], v17 offset:34816
  ds_read_b64_tr_b16 v[8:9], v17 offset:35072
  ds_read_b64_tr_b16 v[18:19], v17 offset:35840
  ds_read_b64_tr_b16 v[20:21], v17 offset:36096
  v_mfma_f32_32x32x16_bf16 v[32:47], v[236:239], v[204:207], v[32:47]
  s_waitcnt lgkmcnt(4)
  v_mfma_f32_32x32x16_bf16 v[96:111], v[224:227], v[208:211], v[96:111]
  v_add_f32 v252, v252, v2
  v_add_f32 v253, v253, v3
  v_add_f32 v254, v254, v4
  v_add_f32 v255, v255, v5
  v_mfma_f32_32x32x16_bf16 v[32:47], v[228:231], v[212:215], v[32:47]
  v_add_f32 v252, v252, v253
  v_add_f32 v254, v254, v255
  v_add_f32 v252, v252, v254
  v_cvt_pk_bf16_f32 v253, v252, v252
  v_and_b32 v253, 0xffff0000, v253
  v_sub_f32 v253, v252, v253
  v_cvt_pk_bf16_f32 v28, v252, v253
  s_nop 1
  s_waitcnt lgkmcnt(0)
  v_mfma_f32_32x32x16_bf16 v[96:111], v[6:9], v[216:219], v[96:111]
  v_mfma_f32_32x32x16_bf16 v[32:47], v[18:21], v[220:223], v[32:47]
k1_fin:
  v_mfma_f32_32x32x16_bf16 v[96:111], v[28:31], v[24:27], v[96:111]
  s_nop 11
  v_add_f32 v96, v96, v32
  v_add_f32 v97, v97, v33
  v_add_f32 v98, v98, v34
  v_add_f32 v99, v99, v35
  v_add_f32 v100, v100, v36
  v_add_f32 v101, v101, v37
  v_add_f32 v102, v102, v38
  v_add_f32 v103, v103, v39
  v_add_f32 v104, v104, v40
  v_add_f32 v105, v105, v41
  v_add_f32 v106, v106, v42
  v_add_f32 v107, v107, v43
  v_add_f32 v108, v108, v44
  v_add_f32 v109, v109, v45
  v_add_f32 v110, v110, v46
  v_add_f32 v111, v111, v47
  s_cmp_le_u32 s17, 1
  s_cbranch_scc1 k1_y4
  v_cvt_pk_bf16_f32 v240, v96, v97
  v_cvt_pk_bf16_f32 v241, v98, v99
  v_cvt_pk_bf16_f32 v242, v100, v101
  v_cvt_pk_bf16_f32 v243, v102, v103
  v_pk_max_i16 v240, v240, 0
  v_pk_max_i16 v241, v241, 0
  v_pk_max_i16 v242, v242, 0
  v_pk_max_i16 v243, v243, 0
  s_add_u32 s30, s36, 8192
  buffer_store_dwordx4 v[240:243], v249, s[24:27], s30 offen sc0 sc1
  v_cvt_pk_bf16_f32 v244, v104, v105
  v_cvt_pk_bf16_f32 v245, v106, v107
  v_cvt_pk_bf16_f32 v246, v108, v109
  v_cvt_pk_bf16_f32 v247, v110, v111
  v_pk_max_i16 v244, v244, 0
  v_pk_max_i16 v245, v245, 0
  v_pk_max_i16 v246, v246, 0
  v_pk_max_i16 v247, v247, 0
  s_add_u32 s30, s36, 9216
  buffer_store_dwordx4 v[244:247], v249, s[24:27], s30 offen sc0 sc1
  s_branch k1_fin2
k1_y4:
  v_mul_f32 v96, v96, v22
  v_mul_f32 v97, v97, v22
  v_mul_f32 v98, v98, v22
  v_mul_f32 v99, v99, v22
  v_mul_f32 v100, v100, v22
  v_mul_f32 v101, v101, v22
  v_mul_f32 v102, v102, v22
  v_mul_f32 v103, v103, v22
  v_cvt_pk_bf16_f32 v240, v96, v97
  v_cvt_pk_bf16_f32 v241, v98, v99
  v_cvt_pk_bf16_f32 v242, v100, v101
  v_cvt_pk_bf16_f32 v243, v102, v103
  s_add_u32 s30, s37, 524288
  buffer_store_dword v240, v250, s[32:35], s30 offen sc0 sc1
  s_add_u32 s30, s37, 532480
  buffer_store_dword v241, v250, s[32:35], s30 offen sc0 sc1
  s_add_u32 s30, s37, 557056
  buffer_store_dword v242, v250, s[32:35], s30 offen sc0 sc1
  s_add_u32 s30, s37, 565248
  buffer_store_dword v243, v250, s[32:35], s30 offen sc0 sc1
  v_mul_f32 v104, v104, v22
  v_mul_f32 v105, v105, v22
  v_mul_f32 v106, v106, v22
  v_mul_f32 v107, v107, v22
  v_mul_f32 v108, v108, v22
  v_mul_f32 v109, v109, v22
  v_mul_f32 v110, v110, v22
  v_mul_f32 v111, v111, v22
  v_cvt_pk_bf16_f32 v244, v104, v105
  v_cvt_pk_bf16_f32 v245, v106, v107
  v_cvt_pk_bf16_f32 v246, v108, v109
  v_cvt_pk_bf16_f32 v247, v110, v111
  s_add_u32 s30, s37, 589824
  buffer_store_dword v244, v250, s[32:35], s30 offen sc0 sc1
  s_add_u32 s30, s37, 598016
  buffer_store_dword v245, v250, s[32:35], s30 offen sc0 sc1
  s_add_u32 s30, s37, 622592
  buffer_store_dword v246, v250, s[32:35], s30 offen sc0 sc1
  s_add_u32 s30, s37, 630784
  buffer_store_dword v247, v250, s[32:35], s30 offen sc0 sc1
k1_fin2:
  s_endpgm
k1_prep:
  s_cmp_lt_u32 s3, 4
  s_cbranch_scc1 k1_pw
  s_getpc_b64 s[22:23]
  s_add_u32 s22, s22, tabFI@rel32@lo+4
  s_addc_u32 s23, s23, tabFI@rel32@hi+12
  s_getpc_b64 s[44:45]
  s_add_u32 s44, s44, tabS@rel32@lo+4
  s_addc_u32 s45, s45, tabS@rel32@hi+12
  s_getpc_b64 s[46:47]
  s_add_u32 s46, s46, k2_kernel@rel32@lo+4
  s_addc_u32 s47, s47, k2_kernel@rel32@hi+12
  s_sub_u32 s14, s2, 224
  s_lshl_b32 s14, s14, 2
  s_add_u32 s14, s14, s3
  s_sub_u32 s14, s14, 4
  v_lshlrev_b32 v2, 4, v0
  s_waitcnt lgkmcnt(0)
  s_mov_b32 s24, s42
  s_mov_b32 s25, s43
  s_mov_b32 s26, 0x188000
  s_mov_b32 s27, 0x20000
  s_mov_b32 s28, s22
  s_mov_b32 s29, s23
  s_mov_b32 s30, 0x62000
  s_mov_b32 s31, 0x20000
  s_mov_b32 s32, s44
  s_mov_b32 s33, s45
  s_mov_b32 s34, 0x6000
  s_mov_b32 s35, 0x20000
  s_mov_b32 s36, s46
  s_mov_b32 s37, s47
  s_mov_b32 s38, 0x2b00
  s_mov_b32 s39, 0x20000
  s_mul_i32 s15, s14, 13312
  v_add_u32 v3, s15, v2
  s_lshl_b32 s15, s14, 12
  v_add_u32 v4, s15, v2
  s_lshl_b32 s15, s14, 10
  v_add_u32 v5, s15, v2
  s_add_u32 s48, s12, 0xff0000
  s_addc_u32 s49, s13, 0
  s_mov_b32 s50, 0x4000
  s_mov_b32 s51, 0x20000
  s_lshl_b32 s15, s14, 8
  v_lshl_add_u32 v6, v0, 2, s15
  v_mov_b32 v7, 0
  buffer_store_dword v7, v6, s[48:51], 0 offen
  s_mov_b32 s52, s40
  s_mov_b32 s53, s41
  s_mov_b32 s54, 0x188000
  s_mov_b32 s55, 0x20000
  s_mov_b32 s56, s20
  s_mov_b32 s57, s21
  s_mov_b32 s58, 0x62000
  s_mov_b32 s59, 0x20000
  v_mov_b32 v6, v3
  buffer_load_dwordx4 v[8:11], v6, s[52:55], 0 offen
  v_add_u32 v6, 1024, v6
  buffer_load_dwordx4 v[12:15], v6, s[52:55], 0 offen
  v_add_u32 v6, 1024, v6
  buffer_load_dwordx4 v[16:19], v6, s[52:55], 0 offen
  v_add_u32 v6, 1024, v6
  buffer_load_dwordx4 v[20:23], v6, s[52:55], 0 offen
  v_add_u32 v6, 1024, v6
  buffer_load_dwordx4 v[24:27], v6, s[52:55], 0 offen
  v_add_u32 v6, 1024, v6
  buffer_load_dwordx4 v[28:31], v6, s[52:55], 0 offen
  v_add_u32 v6, 1024, v6
  buffer_load_dwordx4 v[32:35], v6, s[52:55], 0 offen
  v_add_u32 v6, 1024, v6
  buffer_load_dwordx4 v[36:39], v6, s[52:55], 0 offen
  v_add_u32 v6, 1024, v6
  buffer_load_dwordx4 v[40:43], v6, s[52:55], 0 offen
  v_add_u32 v6, 1024, v6
  buffer_load_dwordx4 v[44:47], v6, s[52:55], 0 offen
  v_add_u32 v6, 1024, v6
  buffer_load_dwordx4 v[48:51], v6, s[52:55], 0 offen
  v_add_u32 v6, 1024, v6
  buffer_load_dwordx4 v[52:55], v6, s[52:55], 0 offen
  v_add_u32 v6, 1024, v6
  buffer_load_dwordx4 v[56:59], v6, s[52:55], 0 offen
  v_add_u32 v6, 1024, v6
  buffer_load_dwordx4 v[64:67], v4, s[56:59], 0 offen offset:0
  buffer_load_dwordx4 v[68:71], v4, s[56:59], 0 offen offset:1024
  buffer_load_dwordx4 v[72:75], v4, s[56:59], 0 offen offset:2048
  buffer_load_dwordx4 v[76:79], v4, s[56:59], 0 offen offset:3072
  s_waitcnt vmcnt(0)
  buffer_load_dwordx4 v[8:11], v3, s[24:27], 0 offen
  v_add_u32 v3, 1024, v3
  buffer_load_dwordx4 v[12:15], v3, s[24:27], 0 offen
  v_add_u32 v3, 1024, v3
  buffer_load_dwordx4 v[16:19], v3, s[24:27], 0 offen
  v_add_u32 v3, 1024, v3
  buffer_load_dwordx4 v[20:23], v3, s[24:27], 0 offen
  v_add_u32 v3, 1024, v3
  buffer_load_dwordx4 v[24:27], v3, s[24:27], 0 offen
  v_add_u32 v3, 1024, v3
  buffer_load_dwordx4 v[28:31], v3, s[24:27], 0 offen
  v_add_u32 v3, 1024, v3
  buffer_load_dwordx4 v[32:35], v3, s[24:27], 0 offen
  v_add_u32 v3, 1024, v3
  buffer_load_dwordx4 v[36:39], v3, s[24:27], 0 offen
  v_add_u32 v3, 1024, v3
  buffer_load_dwordx4 v[40:43], v3, s[24:27], 0 offen
  v_add_u32 v3, 1024, v3
  buffer_load_dwordx4 v[44:47], v3, s[24:27], 0 offen
  v_add_u32 v3, 1024, v3
  buffer_load_dwordx4 v[48:51], v3, s[24:27], 0 offen
  v_add_u32 v3, 1024, v3
  buffer_load_dwordx4 v[52:55], v3, s[24:27], 0 offen
  v_add_u32 v3, 1024, v3
  buffer_load_dwordx4 v[56:59], v3, s[24:27], 0 offen
  v_add_u32 v3, 1024, v3
  buffer_load_dwordx4 v[64:67], v4, s[28:31], 0 offen offset:0
  buffer_load_dwordx4 v[68:71], v4, s[28:31], 0 offen offset:1024
  buffer_load_dwordx4 v[72:75], v4, s[28:31], 0 offen offset:2048
  buffer_load_dwordx4 v[76:79], v4, s[28:31], 0 offen offset:3072
  buffer_load_dwordx4 v[80:83], v5, s[32:35], 0 offen
  buffer_load_dwordx4 v[84:87], v5, s[36:39], 0 offen
  s_waitcnt vmcnt(0)
  s_endpgm
k1_pw:
  s_sub_u32 s14, s2, 224
  s_mul_i32 s15, s14, 28800
  v_lshlrev_b32 v2, 4, v0
  s_waitcnt lgkmcnt(0)
  s_mov_b32 s24, s8
  s_mov_b32 s25, s9
  s_mov_b32 s26, 0xe1000
  s_mov_b32 s27, 0x20000
  s_mov_b32 s28, s10
  s_mov_b32 s29, s11
  s_mov_b32 s30, 0xe1000
  s_mov_b32 s31, 0x20000
  s_add_u32 s32, s12, 0xa00000
  s_addc_u32 s33, s13, 0
  s_mov_b32 s34, 0x1c2000
  s_mov_b32 s35, 0x20000
  s_lshl_b32 s16, s3, 10
  s_add_u32 s15, s15, s16
  v_add_u32 v2, s15, v2
  s_add_u32 m0, s16, 0
  s_nop 0
  buffer_load_dwordx4 v2, s[24:27], 0 offen lds
  s_add_u32 m0, s16, 32768
  s_nop 0
  buffer_load_dwordx4 v2, s[28:31], 0 offen lds
  v_add_u32 v2, 4096, v2
  s_add_u32 m0, s16, 4096
  s_nop 0
  buffer_load_dwordx4 v2, s[24:27], 0 offen lds
  s_add_u32 m0, s16, 36864
  s_nop 0
  buffer_load_dwordx4 v2, s[28:31], 0 offen lds
  v_add_u32 v2, 4096, v2
  s_add_u32 m0, s16, 8192
  s_nop 0
  buffer_load_dwordx4 v2, s[24:27], 0 offen lds
  s_add_u32 m0, s16, 40960
  s_nop 0
  buffer_load_dwordx4 v2, s[28:31], 0 offen lds
  v_add_u32 v2, 4096, v2
  s_add_u32 m0, s16, 12288
  s_nop 0
  buffer_load_dwordx4 v2, s[24:27], 0 offen lds
  s_add_u32 m0, s16, 45056
  s_nop 0
  buffer_load_dwordx4 v2, s[28:31], 0 offen lds
  v_add_u32 v2, 4096, v2
  s_add_u32 m0, s16, 16384
  s_nop 0
  buffer_load_dwordx4 v2, s[24:27], 0 offen lds
  s_add_u32 m0, s16, 49152
  s_nop 0
  buffer_load_dwordx4 v2, s[28:31], 0 offen lds
  v_add_u32 v2, 4096, v2
  s_add_u32 m0, s16, 20480
  s_nop 0
  buffer_load_dwordx4 v2, s[24:27], 0 offen lds
  s_add_u32 m0, s16, 53248
  s_nop 0
  buffer_load_dwordx4 v2, s[28:31], 0 offen lds
  v_add_u32 v2, 4096, v2
  s_add_u32 m0, s16, 24576
  s_nop 0
  buffer_load_dwordx4 v2, s[24:27], 0 offen lds
  s_add_u32 m0, s16, 57344
  s_nop 0
  buffer_load_dwordx4 v2, s[28:31], 0 offen lds
  v_add_u32 v2, 4096, v2
  s_cmp_lg_u32 s3, 0
  s_cbranch_scc1 k1_p1
  s_add_u32 m0, s16, 28672
  s_nop 0
  buffer_load_dwordx4 v2, s[24:27], 0 offen lds
  s_add_u32 m0, s16, 61440
  s_nop 0
  buffer_load_dwordx4 v2, s[28:31], 0 offen lds
  v_add_u32 v2, 4096, v2
k1_p1:
  v_mul_u32_u24 v3, 450, v0
  s_lshl_b32 s17, s3, 1
  v_add_u32 v3, s17, v3
  s_lshl_b32 s17, s14, 8
  v_lshl_add_u32 v4, v0, 2, s17
  s_lshl_b32 s18, s3, 13
  s_mov_b32 s19, 0
  s_waitcnt vmcnt(0)
  s_barrier
k1_p2:
  ds_read_u16 v8, v3 offset:0
  ds_read_u16_d16_hi v16, v3 offset:32768
  ds_read_u16 v9, v3 offset:8
  ds_read_u16_d16_hi v17, v3 offset:32776
  ds_read_u16 v10, v3 offset:16
  ds_read_u16_d16_hi v18, v3 offset:32784
  ds_read_u16 v11, v3 offset:24
  ds_read_u16_d16_hi v19, v3 offset:32792
  ds_read_u16 v12, v3 offset:32
  ds_read_u16_d16_hi v20, v3 offset:32800
  ds_read_u16 v13, v3 offset:40
  ds_read_u16_d16_hi v21, v3 offset:32808
  ds_read_u16 v14, v3 offset:48
  ds_read_u16_d16_hi v22, v3 offset:32816
  ds_read_u16 v15, v3 offset:56
  ds_read_u16_d16_hi v23, v3 offset:32824
  v_add_u32 v3, 64, v3
  s_waitcnt lgkmcnt(0)
  v_and_b32 v16, 0xffff0000, v16
  v_or_b32 v8, v8, v16
  buffer_store_dword v8, v4, s[32:35], s18 offen sc0 sc1
  s_add_u32 s18, s18, 32768
  v_and_b32 v17, 0xffff0000, v17
  v_or_b32 v9, v9, v17
  buffer_store_dword v9, v4, s[32:35], s18 offen sc0 sc1
  s_add_u32 s18, s18, 32768
  v_and_b32 v18, 0xffff0000, v18
  v_or_b32 v10, v10, v18
  buffer_store_dword v10, v4, s[32:35], s18 offen sc0 sc1
  s_add_u32 s18, s18, 32768
  v_and_b32 v19, 0xffff0000, v19
  v_or_b32 v11, v11, v19
  buffer_store_dword v11, v4, s[32:35], s18 offen sc0 sc1
  s_add_u32 s18, s18, 32768
  v_and_b32 v20, 0xffff0000, v20
  v_or_b32 v12, v12, v20
  buffer_store_dword v12, v4, s[32:35], s18 offen sc0 sc1
  s_add_u32 s18, s18, 32768
  v_and_b32 v21, 0xffff0000, v21
  v_or_b32 v13, v13, v21
  buffer_store_dword v13, v4, s[32:35], s18 offen sc0 sc1
  s_add_u32 s18, s18, 32768
  v_and_b32 v22, 0xffff0000, v22
  v_or_b32 v14, v14, v22
  buffer_store_dword v14, v4, s[32:35], s18 offen sc0 sc1
  s_add_u32 s18, s18, 32768
  v_and_b32 v23, 0xffff0000, v23
  v_or_b32 v15, v15, v23
  buffer_store_dword v15, v4, s[32:35], s18 offen sc0 sc1
  s_add_u32 s18, s18, 32768
  s_add_u32 s19, s19, 1
  s_cmp_lt_u32 s19, 8
  s_cbranch_scc1 k1_p2
k1_end:
  s_endpgm
.globl k2_kernel
.p2align 8
.type k2_kernel,@function
k2_kernel:
  s_cmp_ge_u32 s2, 449
  s_cbranch_scc1 k2_end
  s_load_dwordx2 s[4:5], s[0:1], 0
  s_load_dwordx2 s[6:7], s[0:1], 40
  s_load_dwordx4 s[8:11], s[0:1], 48
  s_load_dwordx2 s[12:13], s[0:1], 64
  v_lshrrev_b32 v1, 6, v0
  v_and_b32 v0, 63, v0
  s_nop 0
  v_readfirstlane_b32 s3, v1
  s_cmp_ge_u32 s2, 224
  s_cbranch_scc1 k2_fft
  s_and_b32 s14, s2, 7
  s_lshr_b32 s15, s2, 3
  s_lshl_b32 s14, s14, 2
  s_and_b32 s16, s15, 3
  s_add_u32 s16, s16, s14
  s_lshr_b32 s17, s15, 2
  s_lshl_b32 s18, s17, 7
  s_mul_i32 s19, s16, 229376
  s_mul_i32 s22, s3, 401408
  s_mul_i32 s23, s3, 28672
  s_add_u32 s19, s19, s23
  s_lshr_b32 s47, s3, 1
  s_mul_i32 s23, s47, 114688
  s_add_u32 s44, s19, 114688
  s_add_u32 s19, s19, s23
  s_sub_u32 s44, s44, s23
  s_mul_i32 s45, s3, 17408
  v_lshrrev_b32 v4, 3, v0
  v_lshrrev_b32 v5, 2, v0
  v_and_b32 v5, 4, v5
  v_and_b32 v6, 7, v0
  v_xor_b32 v5, v5, v6
  v_lshlrev_b32 v5, 4, v5
  v_lshl_add_u32 v11, v4, 12, v5
  v_mul_u32_u24 v4, 896, v4
  v_add3_u32 v1, s18, v4, v5
  v_lshlrev_b32 v2, 4, v0
  s_waitcnt lgkmcnt(0)
  s_mov_b32 s24, s6
  s_mov_b32 s25, s7
  s_mov_b32 s26, 0x188000
  s_mov_b32 s27, 0x20000
  s_add_u32 s28, s12, 0x200000
  s_addc_u32 s29, s13, 0
  s_mov_b32 s30, 0x700000
  s_mov_b32 s31, 0x20000
  s_getpc_b64 s[20:21]
  s_add_u32 s20, s20, k2_kernel@rel32@lo+4
  s_addc_u32 s21, s21, k2_kernel@rel32@hi+12
  s_mov_b32 s48, s20
  s_mov_b32 s49, s21
  s_mov_b32 s50, 0x2b00
  s_mov_b32 s51, 0x20000
  s_lshr_b32 s46, s2, 1
  s_and_b32 s46, s46, 12
  s_add_u32 s46, s46, s3
  s_lshl_b32 s46, s46, 10
  buffer_load_dwordx4 v[224:227], v2, s[48:51], s46 offen
  s_add_u32 m0, s45, 0
  s_add_u32 s46, s22, 0
  buffer_load_dwordx4 v1, s[24:27], s46 offen lds
  s_add_u32 m0, s45, 1024
  s_add_u32 s46, s22, 7168
  buffer_load_dwordx4 v1, s[24:27], s46 offen lds
  s_add_u32 s46, s19, 0
  buffer_load_dwordx4 v[96:99], v2, s[28:31], s46 offen
  s_add_u32 s46, s44, 0
  buffer_load_dwordx4 v[100:103], v2, s[28:31], s46 offen
  s_add_u32 m0, s45, 2048
  s_add_u32 s46, s22, 14336
  buffer_load_dwordx4 v1, s[24:27], s46 offen lds
  s_add_u32 m0, s45, 3072
  s_add_u32 s46, s22, 21504
  buffer_load_dwordx4 v1, s[24:27], s46 offen lds
  s_add_u32 s46, s19, 1024
  buffer_load_dwordx4 v[104:107], v2, s[28:31], s46 offen
  s_add_u32 s46, s44, 1024
  buffer_load_dwordx4 v[108:111], v2, s[28:31], s46 offen
  s_add_u32 m0, s45, 4096
  s_add_u32 s46, s22, 28672
  buffer_load_dwordx4 v1, s[24:27], s46 offen lds
  s_add_u32 m0, s45, 5120
  s_add_u32 s46, s22, 35840
  buffer_load_dwordx4 v1, s[24:27], s46 offen lds
  s_add_u32 s46, s19, 2048
  buffer_load_dwordx4 v[112:115], v2, s[28:31], s46 offen
  s_add_u32 s46, s44, 2048
  buffer_load_dwordx4 v[116:119], v2, s[28:31], s46 offen
  s_add_u32 s32, s12, 0xff0000
  s_addc_u32 s33, s13, 0
  s_mov_b32 s34, 0x4000
  s_mov_b32 s35, 0x20000
  s_add_u32 s36, s12, 0xfe0000
  s_addc_u32 s37, s13, 0
  s_mov_b32 s38, 0x2000
  s_mov_b32 s39, 0x20000
  s_mov_b32 s40, s8
  s_mov_b32 s41, s9
  s_mov_b32 s42, 0x1c0000
  s_mov_b32 s43, 0x20000
  s_add_u32 s48, s12, 0xc00000
  s_addc_u32 s49, s13, 0
  s_mov_b32 s50, 0x1c0000
  s_mov_b32 s51, 0x20000
  s_getpc_b64 s[20:21]
  s_add_u32 s20, s20, tabFI@rel32@lo+4
  s_addc_u32 s21, s21, tabFI@rel32@hi+12
  s_mov_b32 s52, s20
  s_mov_b32 s53, s21
  s_mov_b32 s54, 0x62000
  s_mov_b32 s55, 0x20000
  s_mov_b32 s56, s4
  s_mov_b32 s57, s5
  s_mov_b32 s58, 0x1c0000
  s_mov_b32 s59, 0x20000
  s_lshl_b32 s46, s16, 7
  v_add_u32 v11, s46, v11
  s_mul_i32 s60, s3, 458752
  s_mul_i32 s61, s17, 57344
  s_mul_i32 s46, s3, 7168
  s_add_u32 s61, s61, s46
  s_add_u32 s62, s61, 28672
  s_and_b32 s63, s3, 1
  s_mul_i32 s46, s63, 28672
  s_add_u32 s61, s61, s46
  s_sub_u32 s62, s62, s46
  s_mul_i32 s46, s3, 56
  v_add_u32 v241, s46, v0
  v_mov_b32 v240, 224
  v_cmp_eq_u32 vcc, 56, v0
  v_cndmask_b32 v241, v241, v240, vcc
  v_mov_b32 v240, 256
  v_cmp_gt_u32 vcc, 57, v0
  v_cndmask_b32 v241, v240, v241, vcc
  v_cndmask_b32 v240, 0, 1, vcc
  v_lshlrev_b32 v241, 6, v241
  s_lshl_b32 s46, s16, 1
  s_add_u32 s46, s46, s47
  s_lshl_b32 s46, s46, 5
  v_and_b32 v5, 31, v0
  v_add_u32 v7, s46, v5
  v_lshlrev_b32 v13, 2, v7
  v_mul_u32_u24 v7, 896, v7
  v_lshrrev_b32 v6, 5, v0
  v_lshl_add_u32 v7, v6, 4, v7
  s_lshl_b32 s46, s17, 1
  s_add_u32 s46, s46, s63
  s_lshl_b32 s46, s46, 6
  v_add_u32 v3, s46, v7
  v_add_u32 v10, s45, v2
  s_xor_b32 s46, s3, 1
  s_mul_i32 s46, s46, 17408
  v_add_u32 v12, s46, v2
  s_xor_b32 s46, s3, 3
  s_mul_i32 s46, s46, 17408
  v_add_u32 v244, s46, v2
  v_lshrrev_b32 v4, 5, v0
  v_and_b32 v5, 15, v0
  v_lshrrev_b32 v5, 2, v5
  v_lshl_add_u32 v6, v4, 2, v5
  v_lshl_add_u32 v6, v6, 7, s45
  v_lshrrev_b32 v5, 1, v5
  v_lshlrev_b32 v5, 2, v5
  v_lshrrev_b32 v7, 3, v0
  v_and_b32 v7, 2, v7
  v_or_b32 v5, v5, v7
  v_lshrrev_b32 v7, 1, v0
  v_and_b32 v7, 1, v7
  v_or_b32 v5, v5, v7
  v_lshl_add_u32 v6, v5, 4, v6
  v_and_b32 v7, 1, v0
  v_lshl_add_u32 v8, v7, 3, v6
  s_lshl_b32 s46, s47, 6
  v_xor_b32 v242, s46, v8
  v_xor_b32 v243, 64, v242
  s_lshl_b32 s46, s63, 6
  v_xor_b32 v8, s46, v8
  v_xor_b32 v9, 64, v8
  s_add_u32 m0, s45, 6144
  s_add_u32 s46, s22, 43008
  buffer_load_dwordx4 v1, s[24:27], s46 offen lds
  s_add_u32 m0, s45, 7168
  s_add_u32 s46, s22, 50176
  buffer_load_dwordx4 v1, s[24:27], s46 offen lds
  s_add_u32 s46, s19, 3072
  buffer_load_dwordx4 v[120:123], v2, s[28:31], s46 offen
  s_add_u32 s46, s44, 3072
  buffer_load_dwordx4 v[124:127], v2, s[28:31], s46 offen
  s_add_u32 m0, s45, 8192
  s_add_u32 s46, s22, 57344
  buffer_load_dwordx4 v1, s[24:27], s46 offen lds
  s_add_u32 m0, s45, 9216
  s_add_u32 s46, s22, 64512
  buffer_load_dwordx4 v1, s[24:27], s46 offen lds
  s_add_u32 s46, s19, 4096
  buffer_load_dwordx4 v[128:131], v2, s[28:31], s46 offen
  s_add_u32 s46, s44, 4096
  buffer_load_dwordx4 v[132:135], v2, s[28:31], s46 offen
  s_add_u32 m0, s45, 10240
  s_add_u32 s46, s22, 71680
  buffer_load_dwordx4 v1, s[24:27], s46 offen lds
  s_add_u32 m0, s45, 11264
  s_add_u32 s46, s22, 78848
  buffer_load_dwordx4 v1, s[24:27], s46 offen lds
  s_add_u32 s46, s19, 5120
  buffer_load_dwordx4 v[136:139], v2, s[28:31], s46 offen
  s_add_u32 s46, s44, 5120
  buffer_load_dwordx4 v[140:143], v2, s[28:31], s46 offen
  s_add_u32 m0, s45, 12288
  s_add_u32 s46, s22, 86016
  buffer_load_dwordx4 v1, s[24:27], s46 offen lds
  s_add_u32 m0, s45, 13312
  s_add_u32 s46, s22, 93184
  buffer_load_dwordx4 v1, s[24:27], s46 offen lds
  s_add_u32 s46, s19, 6144
  buffer_load_dwordx4 v[144:147], v2, s[28:31], s46 offen
  s_add_u32 s46, s44, 6144
  buffer_load_dwordx4 v[148:151], v2, s[28:31], s46 offen
  s_add_u32 m0, s45, 14336
  s_add_u32 s46, s22, 100352
  buffer_load_dwordx4 v1, s[24:27], s46 offen lds
  s_add_u32 m0, s45, 15360
  s_add_u32 s46, s22, 107520
  buffer_load_dwordx4 v1, s[24:27], s46 offen lds
  s_add_u32 s46, s19, 7168
  buffer_load_dwordx4 v[152:155], v2, s[28:31], s46 offen
  s_add_u32 s46, s44, 7168
  buffer_load_dwordx4 v[156:159], v2, s[28:31], s46 offen
  s_waitcnt vmcnt(28)
  ds_read_b64_tr_b16 v[80:81], v8 offset:0
  ds_read_b64_tr_b16 v[82:83], v8 offset:1024
  ds_read_b64_tr_b16 v[84:85], v9 offset:0
  ds_read_b64_tr_b16 v[86:87], v9 offset:1024
  s_waitcnt vmcnt(24)
  ds_read_b64_tr_b16 v[88:89], v8 offset:2048
  ds_read_b64_tr_b16 v[90:91], v8 offset:3072
  ds_read_b64_tr_b16 v[92:93], v9 offset:2048
  ds_read_b64_tr_b16 v[94:95], v9 offset:3072
  s_waitcnt lgkmcnt(4)
  v_mfma_f32_32x32x16_bf16 v[16:31], v[80:83], v[96:99], 0
  v_mfma_f32_32x32x16_bf16 v[32:47], v[80:83], v[100:103], 0
  s_add_u32 m0, s45, 0
  s_add_u32 s46, s22, 114688
  buffer_load_dwordx4 v1, s[24:27], s46 offen lds
  v_mfma_f32_32x32x16_bf16 v[48:63], v[84:87], v[96:99], 0
  s_add_u32 m0, s45, 1024
  s_add_u32 s46, s22, 121856
  buffer_load_dwordx4 v1, s[24:27], s46 offen lds
  v_mfma_f32_32x32x16_bf16 v[64:79], v[84:87], v[100:103], 0
  s_add_u32 s46, s19, 8192
  buffer_load_dwordx4 v[96:99], v2, s[28:31], s46 offen
  s_add_u32 s46, s44, 8192
  buffer_load_dwordx4 v[100:103], v2, s[28:31], s46 offen
  s_waitcnt vmcnt(24)
  ds_read_b64_tr_b16 v[80:81], v8 offset:4096
  ds_read_b64_tr_b16 v[82:83], v8 offset:5120
  ds_read_b64_tr_b16 v[84:85], v9 offset:4096
  ds_read_b64_tr_b16 v[86:87], v9 offset:5120
  s_waitcnt lgkmcnt(4)
  v_mfma_f32_32x32x16_bf16 v[16:31], v[88:91], v[104:107], v[16:31]
  v_mfma_f32_32x32x16_bf16 v[32:47], v[88:91], v[108:111], v[32:47]
  s_add_u32 m0, s45, 2048
  s_add_u32 s46, s22, 129024
  buffer_load_dwordx4 v1, s[24:27], s46 offen lds
  v_mfma_f32_32x32x16_bf16 v[48:63], v[92:95], v[104:107], v[48:63]
  s_add_u32 m0, s45, 3072
  s_add_u32 s46, s22, 136192
  buffer_load_dwordx4 v1, s[24:27], s46 offen lds
  v_mfma_f32_32x32x16_bf16 v[64:79], v[92:95], v[108:111], v[64:79]
  s_add_u32 s46, s19, 9216
  buffer_load_dwordx4 v[104:107], v2, s[28:31], s46 offen
  s_add_u32 s46, s44, 9216
  buffer_load_dwordx4 v[108:111], v2, s[28:31], s46 offen
  s_waitcnt vmcnt(24)
  ds_read_b64_tr_b16 v[88:89], v8 offset:6144
  ds_read_b64_tr_b16 v[90:91], v8 offset:7168
  ds_read_b64_tr_b16 v[92:93], v9 offset:6144
  ds_read_b64_tr_b16 v[94:95], v9 offset:7168
  s_waitcnt lgkmcnt(4)
  v_mfma_f32_32x32x16_bf16 v[16:31], v[80:83], v[112:115], v[16:31]
  v_mfma_f32_32x32x16_bf16 v[32:47], v[80:83], v[116:119], v[32:47]
  s_add_u32 m0, s45, 4096
  s_add_u32 s46, s22, 143360
  buffer_load_dwordx4 v1, s[24:27], s46 offen lds
  v_mfma_f32_32x32x16_bf16 v[48:63], v[84:87], v[112:115], v[48:63]
  s_add_u32 m0, s45, 5120
  s_add_u32 s46, s22, 150528
  buffer_load_dwordx4 v1, s[24:27], s46 offen lds
  v_mfma_f32_32x32x16_bf16 v[64:79], v[84:87], v[116:119], v[64:79]
  s_add_u32 s46, s19, 10240
  buffer_load_dwordx4 v[112:115], v2, s[28:31], s46 offen
  s_add_u32 s46, s44, 10240
  buffer_load_dwordx4 v[116:119], v2, s[28:31], s46 offen
  s_waitcnt vmcnt(24)
  ds_read_b64_tr_b16 v[80:81], v8 offset:8192
  ds_read_b64_tr_b16 v[82:83], v8 offset:9216
  ds_read_b64_tr_b16 v[84:85], v9 offset:8192
  ds_read_b64_tr_b16 v[86:87], v9 offset:9216
  s_waitcnt lgkmcnt(4)
  v_mfma_f32_32x32x16_bf16 v[16:31], v[88:91], v[120:123], v[16:31]
  v_mfma_f32_32x32x16_bf16 v[32:47], v[88:91], v[124:127], v[32:47]
  s_add_u32 m0, s45, 6144
  s_add_u32 s46, s22, 157696
  buffer_load_dwordx4 v1, s[24:27], s46 offen lds
  v_mfma_f32_32x32x16_bf16 v[48:63], v[92:95], v[120:123], v[48:63]
  s_add_u32 m0, s45, 7168
  s_add_u32 s46, s22, 164864
  buffer_load_dwordx4 v1, s[24:27], s46 offen lds
  v_mfma_f32_32x32x16_bf16 v[64:79], v[92:95], v[124:127], v[64:79]
  s_add_u32 s46, s19, 11264
  buffer_load_dwordx4 v[120:123], v2, s[28:31], s46 offen
  s_add_u32 s46, s44, 11264
  buffer_load_dwordx4 v[124:127], v2, s[28:31], s46 offen
  s_waitcnt vmcnt(24)
  ds_read_b64_tr_b16 v[88:89], v8 offset:10240
  ds_read_b64_tr_b16 v[90:91], v8 offset:11264
  ds_read_b64_tr_b16 v[92:93], v9 offset:10240
  ds_read_b64_tr_b16 v[94:95], v9 offset:11264
  s_waitcnt lgkmcnt(4)
  v_mfma_f32_32x32x16_bf16 v[16:31], v[80:83], v[128:131], v[16:31]
  v_mfma_f32_32x32x16_bf16 v[32:47], v[80:83], v[132:135], v[32:47]
  s_add_u32 m0, s45, 8192
  s_add_u32 s46, s22, 172032
  buffer_load_dwordx4 v1, s[24:27], s46 offen lds
  v_mfma_f32_32x32x16_bf16 v[48:63], v[84:87], v[128:131], v[48:63]
  s_add_u32 m0, s45, 9216
  s_add_u32 s46, s22, 179200
  buffer_load_dwordx4 v1, s[24:27], s46 offen lds
  v_mfma_f32_32x32x16_bf16 v[64:79], v[84:87], v[132:135], v[64:79]
  s_add_u32 s46, s19, 12288
  buffer_load_dwordx4 v[128:131], v2, s[28:31], s46 offen
  s_add_u32 s46, s44, 12288
  buffer_load_dwordx4 v[132:135], v2, s[28:31], s46 offen
  s_waitcnt vmcnt(24)
  ds_read_b64_tr_b16 v[80:81], v8 offset:12288
  ds_read_b64_tr_b16 v[82:83], v8 offset:13312
  ds_read_b64_tr_b16 v[84:85], v9 offset:12288
  ds_read_b64_tr_b16 v[86:87], v9 offset:13312
  s_waitcnt lgkmcnt(4)
  v_mfma_f32_32x32x16_bf16 v[16:31], v[88:91], v[136:139], v[16:31]
  v_mfma_f32_32x32x16_bf16 v[32:47], v[88:91], v[140:143], v[32:47]
  s_add_u32 m0, s45, 10240
  s_add_u32 s46, s22, 186368
  buffer_load_dwordx4 v1, s[24:27], s46 offen lds
  v_mfma_f32_32x32x16_bf16 v[48:63], v[92:95], v[136:139], v[48:63]
  s_add_u32 m0, s45, 11264
  s_add_u32 s46, s22, 193536
  buffer_load_dwordx4 v1, s[24:27], s46 offen lds
  v_mfma_f32_32x32x16_bf16 v[64:79], v[92:95], v[140:143], v[64:79]
  s_add_u32 s46, s19, 13312
  buffer_load_dwordx4 v[136:139], v2, s[28:31], s46 offen
  s_add_u32 s46, s44, 13312
  buffer_load_dwordx4 v[140:143], v2, s[28:31], s46 offen
  s_waitcnt vmcnt(24)
  ds_read_b64_tr_b16 v[88:89], v8 offset:14336
  ds_read_b64_tr_b16 v[90:91], v8 offset:15360
  ds_read_b64_tr_b16 v[92:93], v9 offset:14336
  ds_read_b64_tr_b16 v[94:95], v9 offset:15360
  s_waitcnt lgkmcnt(4)
  v_mfma_f32_32x32x16_bf16 v[16:31], v[80:83], v[144:147], v[16:31]
  v_mfma_f32_32x32x16_bf16 v[32:47], v[80:83], v[148:151], v[32:47]
  s_add_u32 m0, s45, 12288
  s_add_u32 s46, s22, 200704
  buffer_load_dwordx4 v1, s[24:27], s46 offen lds
  v_mfma_f32_32x32x16_bf16 v[48:63], v[84:87], v[144:147], v[48:63]
  s_add_u32 m0, s45, 13312
  s_add_u32 s46, s22, 207872
  buffer_load_dwordx4 v1, s[24:27], s46 offen lds
  v_mfma_f32_32x32x16_bf16 v[64:79], v[84:87], v[148:151], v[64:79]
  s_add_u32 s46, s19, 14336
  buffer_load_dwordx4 v[144:147], v2, s[28:31], s46 offen
  s_add_u32 s46, s44, 14336
  buffer_load_dwordx4 v[148:151], v2, s[28:31], s46 offen
  s_waitcnt vmcnt(24)
  ds_read_b64_tr_b16 v[80:81], v8 offset:0
  ds_read_b64_tr_b16 v[82:83], v8 offset:1024
  ds_read_b64_tr_b16 v[84:85], v9 offset:0
  ds_read_b64_tr_b16 v[86:87], v9 offset:1024
  s_waitcnt lgkmcnt(4)
  v_mfma_f32_32x32x16_bf16 v[16:31], v[88:91], v[152:155], v[16:31]
  v_mfma_f32_32x32x16_bf16 v[32:47], v[88:91], v[156:159], v[32:47]
  s_add_u32 m0, s45, 14336
  s_add_u32 s46, s22, 215040
  buffer_load_dwordx4 v1, s[24:27], s46 offen lds
  v_mfma_f32_32x32x16_bf16 v[48:63], v[92:95], v[152:155], v[48:63]
  s_add_u32 m0, s45, 15360
  s_add_u32 s46, s22, 222208
  buffer_load_dwordx4 v1, s[24:27], s46 offen lds
  v_mfma_f32_32x32x16_bf16 v[64:79], v[92:95], v[156:159], v[64:79]
  s_add_u32 s46, s19, 15360
  buffer_load_dwordx4 v[152:155], v2, s[28:31], s46 offen
  s_add_u32 s46, s44, 15360
  buffer_load_dwordx4 v[156:159], v2, s[28:31], s46 offen
  s_waitcnt vmcnt(24)
  ds_read_b64_tr_b16 v[88:89], v8 offset:2048
  ds_read_b64_tr_b16 v[90:91], v8 offset:3072
  ds_read_b64_tr_b16 v[92:93], v9 offset:2048
  ds_read_b64_tr_b16 v[94:95], v9 offset:3072
  s_waitcnt lgkmcnt(4)
  v_mfma_f32_32x32x16_bf16 v[16:31], v[80:83], v[96:99], v[16:31]
  v_mfma_f32_32x32x16_bf16 v[32:47], v[80:83], v[100:103], v[32:47]
  s_add_u32 m0, s45, 0
  s_add_u32 s46, s22, 229376
  buffer_load_dwordx4 v1, s[24:27], s46 offen lds
  v_mfma_f32_32x32x16_bf16 v[48:63], v[84:87], v[96:99], v[48:63]
  s_add_u32 m0, s45, 1024
  s_add_u32 s46, s22, 236544
  buffer_load_dwordx4 v1, s[24:27], s46 offen lds
  v_mfma_f32_32x32x16_bf16 v[64:79], v[84:87], v[100:103], v[64:79]
  s_add_u32 s46, s19, 16384
  buffer_load_dwordx4 v[96:99], v2, s[28:31], s46 offen
  s_add_u32 s46, s44, 16384
  buffer_load_dwordx4 v[100:103], v2, s[28:31], s46 offen
  s_waitcnt vmcnt(24)
  ds_read_b64_tr_b16 v[80:81], v8 offset:4096
  ds_read_b64_tr_b16 v[82:83], v8 offset:5120
  ds_read_b64_tr_b16 v[84:85], v9 offset:4096
  ds_read_b64_tr_b16 v[86:87], v9 offset:5120
  s_waitcnt lgkmcnt(4)
  v_mfma_f32_32x32x16_bf16 v[16:31], v[88:91], v[104:107], v[16:31]
  v_mfma_f32_32x32x16_bf16 v[32:47], v[88:91], v[108:111], v[32:47]
  s_add_u32 m0, s45, 2048
  s_add_u32 s46, s22, 243712
  buffer_load_dwordx4 v1, s[24:27], s46 offen lds
  v_mfma_f32_32x32x16_bf16 v[48:63], v[92:95], v[104:107], v[48:63]
  s_add_u32 m0, s45, 3072
  s_add_u32 s46, s22, 250880
  buffer_load_dwordx4 v1, s[24:27], s46 offen lds
  v_mfma_f32_32x32x16_bf16 v[64:79], v[92:95], v[108:111], v[64:79]
  s_add_u32 s46, s19, 17408
  buffer_load_dwordx4 v[104:107], v2, s[28:31], s46 offen
  s_add_u32 s46, s44, 17408
  buffer_load_dwordx4 v[108:111], v2, s[28:31], s46 offen
  s_waitcnt vmcnt(24)
  ds_read_b64_tr_b16 v[88:89], v8 offset:6144
  ds_read_b64_tr_b16 v[90:91], v8 offset:7168
  ds_read_b64_tr_b16 v[92:93], v9 offset:6144
  ds_read_b64_tr_b16 v[94:95], v9 offset:7168
  s_waitcnt lgkmcnt(4)
  v_mfma_f32_32x32x16_bf16 v[16:31], v[80:83], v[112:115], v[16:31]
  v_mfma_f32_32x32x16_bf16 v[32:47], v[80:83], v[116:119], v[32:47]
  s_add_u32 m0, s45, 4096
  s_add_u32 s46, s22, 258048
  buffer_load_dwordx4 v1, s[24:27], s46 offen lds
  v_mfma_f32_32x32x16_bf16 v[48:63], v[84:87], v[112:115], v[48:63]
  s_add_u32 m0, s45, 5120
  s_add_u32 s46, s22, 265216
  buffer_load_dwordx4 v1, s[24:27], s46 offen lds
  v_mfma_f32_32x32x16_bf16 v[64:79], v[84:87], v[116:119], v[64:79]
  s_add_u32 s46, s19, 18432
  buffer_load_dwordx4 v[112:115], v2, s[28:31], s46 offen
  s_add_u32 s46, s44, 18432
  buffer_load_dwordx4 v[116:119], v2, s[28:31], s46 offen
  s_waitcnt vmcnt(24)
  ds_read_b64_tr_b16 v[80:81], v8 offset:8192
  ds_read_b64_tr_b16 v[82:83], v8 offset:9216
  ds_read_b64_tr_b16 v[84:85], v9 offset:8192
  ds_read_b64_tr_b16 v[86:87], v9 offset:9216
  s_waitcnt lgkmcnt(4)
  v_mfma_f32_32x32x16_bf16 v[16:31], v[88:91], v[120:123], v[16:31]
  v_mfma_f32_32x32x16_bf16 v[32:47], v[88:91], v[124:127], v[32:47]
  s_add_u32 m0, s45, 6144
  s_add_u32 s46, s22, 272384
  buffer_load_dwordx4 v1, s[24:27], s46 offen lds
  v_mfma_f32_32x32x16_bf16 v[48:63], v[92:95], v[120:123], v[48:63]
  s_add_u32 m0, s45, 7168
  s_add_u32 s46, s22, 279552
  buffer_load_dwordx4 v1, s[24:27], s46 offen lds
  v_mfma_f32_32x32x16_bf16 v[64:79], v[92:95], v[124:127], v[64:79]
  s_add_u32 s46, s19, 19456
  buffer_load_dwordx4 v[120:123], v2, s[28:31], s46 offen
  s_add_u32 s46, s44, 19456
  buffer_load_dwordx4 v[124:127], v2, s[28:31], s46 offen
  s_waitcnt vmcnt(24)
  ds_read_b64_tr_b16 v[88:89], v8 offset:10240
  ds_read_b64_tr_b16 v[90:91], v8 offset:11264
  ds_read_b64_tr_b16 v[92:93], v9 offset:10240
  ds_read_b64_tr_b16 v[94:95], v9 offset:11264
  s_waitcnt lgkmcnt(4)
  v_mfma_f32_32x32x16_bf16 v[16:31], v[80:83], v[128:131], v[16:31]
  v_mfma_f32_32x32x16_bf16 v[32:47], v[80:83], v[132:135], v[32:47]
  s_add_u32 m0, s45, 8192
  s_add_u32 s46, s22, 286720
  buffer_load_dwordx4 v1, s[24:27], s46 offen lds
  v_mfma_f32_32x32x16_bf16 v[48:63], v[84:87], v[128:131], v[48:63]
  s_add_u32 m0, s45, 9216
  s_add_u32 s46, s22, 293888
  buffer_load_dwordx4 v1, s[24:27], s46 offen lds
  v_mfma_f32_32x32x16_bf16 v[64:79], v[84:87], v[132:135], v[64:79]
  s_add_u32 s46, s19, 20480
  buffer_load_dwordx4 v[128:131], v2, s[28:31], s46 offen
  s_add_u32 s46, s44, 20480
  buffer_load_dwordx4 v[132:135], v2, s[28:31], s46 offen
  s_waitcnt vmcnt(24)
  ds_read_b64_tr_b16 v[80:81], v8 offset:12288
  ds_read_b64_tr_b16 v[82:83], v8 offset:13312
  ds_read_b64_tr_b16 v[84:85], v9 offset:12288
  ds_read_b64_tr_b16 v[86:87], v9 offset:13312
  s_waitcnt lgkmcnt(4)
  v_mfma_f32_32x32x16_bf16 v[16:31], v[88:91], v[136:139], v[16:31]
  v_mfma_f32_32x32x16_bf16 v[32:47], v[88:91], v[140:143], v[32:47]
  buffer_load_dword v15, v241, s[32:35], 0 offen sc0 sc1
  s_add_u32 m0, s45, 10240
  s_add_u32 s46, s22, 301056
  buffer_load_dwordx4 v1, s[24:27], s46 offen lds
  v_mfma_f32_32x32x16_bf16 v[48:63], v[92:95], v[136:139], v[48:63]
  s_add_u32 m0, s45, 11264
  s_add_u32 s46, s22, 308224
  buffer_load_dwordx4 v1, s[24:27], s46 offen lds
  v_mfma_f32_32x32x16_bf16 v[64:79], v[92:95], v[140:143], v[64:79]
  s_add_u32 s46, s19, 21504
  buffer_load_dwordx4 v[136:139], v2, s[28:31], s46 offen
  s_add_u32 s46, s44, 21504
  buffer_load_dwordx4 v[140:143], v2, s[28:31], s46 offen
  s_waitcnt vmcnt(25)
  ds_read_b64_tr_b16 v[88:89], v8 offset:14336
  ds_read_b64_tr_b16 v[90:91], v8 offset:15360
  ds_read_b64_tr_b16 v[92:93], v9 offset:14336
  ds_read_b64_tr_b16 v[94:95], v9 offset:15360
  s_waitcnt lgkmcnt(4)
  v_mfma_f32_32x32x16_bf16 v[16:31], v[80:83], v[144:147], v[16:31]
  v_mfma_f32_32x32x16_bf16 v[32:47], v[80:83], v[148:151], v[32:47]
  s_add_u32 m0, s45, 12288
  s_add_u32 s46, s22, 315392
  buffer_load_dwordx4 v1, s[24:27], s46 offen lds
  v_mfma_f32_32x32x16_bf16 v[48:63], v[84:87], v[144:147], v[48:63]
  s_add_u32 m0, s45, 13312
  s_add_u32 s46, s22, 322560
  buffer_load_dwordx4 v1, s[24:27], s46 offen lds
  v_mfma_f32_32x32x16_bf16 v[64:79], v[84:87], v[148:151], v[64:79]
  s_add_u32 s46, s19, 22528
  buffer_load_dwordx4 v[144:147], v2, s[28:31], s46 offen
  s_add_u32 s46, s44, 22528
  buffer_load_dwordx4 v[148:151], v2, s[28:31], s46 offen
  s_waitcnt vmcnt(25)
  ds_read_b64_tr_b16 v[80:81], v8 offset:0
  ds_read_b64_tr_b16 v[82:83], v8 offset:1024
  ds_read_b64_tr_b16 v[84:85], v9 offset:0
  ds_read_b64_tr_b16 v[86:87], v9 offset:1024
  s_waitcnt lgkmcnt(4)
  v_mfma_f32_32x32x16_bf16 v[16:31], v[88:91], v[152:155], v[16:31]
  v_mfma_f32_32x32x16_bf16 v[32:47], v[88:91], v[156:159], v[32:47]
  s_add_u32 m0, s45, 14336
  s_add_u32 s46, s22, 329728
  buffer_load_dwordx4 v1, s[24:27], s46 offen lds
  v_mfma_f32_32x32x16_bf16 v[48:63], v[92:95], v[152:155], v[48:63]
  s_add_u32 m0, s45, 15360
  s_add_u32 s46, s22, 336896
  buffer_load_dwordx4 v1, s[24:27], s46 offen lds
  v_mfma_f32_32x32x16_bf16 v[64:79], v[92:95], v[156:159], v[64:79]
  s_add_u32 s46, s19, 23552
  buffer_load_dwordx4 v[152:155], v2, s[28:31], s46 offen
  s_add_u32 s46, s44, 23552
  buffer_load_dwordx4 v[156:159], v2, s[28:31], s46 offen
  s_waitcnt vmcnt(25)
  ds_read_b64_tr_b16 v[88:89], v8 offset:2048
  ds_read_b64_tr_b16 v[90:91], v8 offset:3072
  ds_read_b64_tr_b16 v[92:93], v9 offset:2048
  ds_read_b64_tr_b16 v[94:95], v9 offset:3072
  s_waitcnt lgkmcnt(4)
  v_mfma_f32_32x32x16_bf16 v[16:31], v[80:83], v[96:99], v[16:31]
  v_mfma_f32_32x32x16_bf16 v[32:47], v[80:83], v[100:103], v[32:47]
  s_add_u32 m0, s45, 0
  s_add_u32 s46, s22, 344064
  buffer_load_dwordx4 v1, s[24:27], s46 offen lds
  v_mfma_f32_32x32x16_bf16 v[48:63], v[84:87], v[96:99], v[48:63]
  s_add_u32 m0, s45, 1024
  s_add_u32 s46, s22, 351232
  buffer_load_dwordx4 v1, s[24:27], s46 offen lds
  v_mfma_f32_32x32x16_bf16 v[64:79], v[84:87], v[100:103], v[64:79]
  s_add_u32 s46, s19, 24576
  buffer_load_dwordx4 v[96:99], v2, s[28:31], s46 offen
  s_add_u32 s46, s44, 24576
  buffer_load_dwordx4 v[100:103], v2, s[28:31], s46 offen
  s_waitcnt vmcnt(25)
  ds_read_b64_tr_b16 v[80:81], v8 offset:4096
  ds_read_b64_tr_b16 v[82:83], v8 offset:5120
  ds_read_b64_tr_b16 v[84:85], v9 offset:4096
  ds_read_b64_tr_b16 v[86:87], v9 offset:5120
  s_waitcnt lgkmcnt(4)
  v_mfma_f32_32x32x16_bf16 v[16:31], v[88:91], v[104:107], v[16:31]
  v_mfma_f32_32x32x16_bf16 v[32:47], v[88:91], v[108:111], v[32:47]
  s_add_u32 m0, s45, 2048
  s_add_u32 s46, s22, 358400
  buffer_load_dwordx4 v1, s[24:27], s46 offen lds
  v_mfma_f32_32x32x16_bf16 v[48:63], v[92:95], v[104:107], v[48:63]
  s_add_u32 m0, s45, 3072
  s_add_u32 s46, s22, 365568
  buffer_load_dwordx4 v1, s[24:27], s46 offen lds
  v_mfma_f32_32x32x16_bf16 v[64:79], v[92:95], v[108:111], v[64:79]
  s_add_u32 s46, s19, 25600
  buffer_load_dwordx4 v[104:107], v2, s[28:31], s46 offen
  s_add_u32 s46, s44, 25600
  buffer_load_dwordx4 v[108:111], v2, s[28:31], s46 offen
  s_waitcnt vmcnt(25)
  ds_read_b64_tr_b16 v[88:89], v8 offset:6144
  ds_read_b64_tr_b16 v[90:91], v8 offset:7168
  ds_read_b64_tr_b16 v[92:93], v9 offset:6144
  ds_read_b64_tr_b16 v[94:95], v9 offset:7168
  s_waitcnt lgkmcnt(4)
  v_mfma_f32_32x32x16_bf16 v[16:31], v[80:83], v[112:115], v[16:31]
  v_mfma_f32_32x32x16_bf16 v[32:47], v[80:83], v[116:119], v[32:47]
  s_add_u32 m0, s45, 4096
  s_add_u32 s46, s22, 372736
  buffer_load_dwordx4 v1, s[24:27], s46 offen lds
  v_mfma_f32_32x32x16_bf16 v[48:63], v[84:87], v[112:115], v[48:63]
  s_add_u32 m0, s45, 5120
  s_add_u32 s46, s22, 379904
  buffer_load_dwordx4 v1, s[24:27], s46 offen lds
  v_mfma_f32_32x32x16_bf16 v[64:79], v[84:87], v[116:119], v[64:79]
  s_add_u32 s46, s19, 26624
  buffer_load_dwordx4 v[112:115], v2, s[28:31], s46 offen
  s_add_u32 s46, s44, 26624
  buffer_load_dwordx4 v[116:119], v2, s[28:31], s46 offen
  s_waitcnt vmcnt(25)
  ds_read_b64_tr_b16 v[80:81], v8 offset:8192
  ds_read_b64_tr_b16 v[82:83], v8 offset:9216
  ds_read_b64_tr_b16 v[84:85], v9 offset:8192
  ds_read_b64_tr_b16 v[86:87], v9 offset:9216
  s_waitcnt lgkmcnt(4)
  v_mfma_f32_32x32x16_bf16 v[16:31], v[88:91], v[120:123], v[16:31]
  v_mfma_f32_32x32x16_bf16 v[32:47], v[88:91], v[124:127], v[32:47]
  s_add_u32 m0, s45, 6144
  s_add_u32 s46, s22, 387072
  buffer_load_dwordx4 v1, s[24:27], s46 offen lds
  v_mfma_f32_32x32x16_bf16 v[48:63], v[92:95], v[120:123], v[48:63]
  s_add_u32 m0, s45, 7168
  s_add_u32 s46, s22, 394240
  buffer_load_dwordx4 v1, s[24:27], s46 offen lds
  v_mfma_f32_32x32x16_bf16 v[64:79], v[92:95], v[124:127], v[64:79]
  s_add_u32 s46, s19, 27648
  buffer_load_dwordx4 v[120:123], v2, s[28:31], s46 offen
  s_add_u32 s46, s44, 27648
  buffer_load_dwordx4 v[124:127], v2, s[28:31], s46 offen
  s_waitcnt vmcnt(24)
  ds_read_b64_tr_b16 v[88:89], v8 offset:10240
  ds_read_b64_tr_b16 v[90:91], v8 offset:11264
  ds_read_b64_tr_b16 v[92:93], v9 offset:10240
  ds_read_b64_tr_b16 v[94:95], v9 offset:11264
  s_waitcnt lgkmcnt(4)
  v_mfma_f32_32x32x16_bf16 v[16:31], v[80:83], v[128:131], v[16:31]
  v_mfma_f32_32x32x16_bf16 v[32:47], v[80:83], v[132:135], v[32:47]
  s_waitcnt vmcnt(28)
g2_chk:
  v_cmp_ne_u32 vcc, v15, v240
  s_cbranch_vccz g2_ok
  s_sleep 4
  buffer_load_dword v15, v241, s[32:35], 0 offen sc0 sc1
  s_waitcnt vmcnt(0)
  s_branch g2_chk
g2_ok:
  s_add_u32 m0, s45, 8192
  s_add_u32 s46, s60, 0
  buffer_load_dwordx4 v11, s[48:51], s46 offen lds
  v_mfma_f32_32x32x16_bf16 v[48:63], v[84:87], v[128:131], v[48:63]
  s_add_u32 m0, s45, 9216
  s_add_u32 s46, s60, 32768
  buffer_load_dwordx4 v11, s[48:51], s46 offen lds
  v_mfma_f32_32x32x16_bf16 v[64:79], v[84:87], v[132:135], v[64:79]
  s_add_u32 s46, s61, 0
  buffer_load_dwordx4 v[128:131], v2, s[52:55], s46 offen
  s_add_u32 s46, s62, 0
  buffer_load_dwordx4 v[132:135], v2, s[52:55], s46 offen
  s_waitcnt vmcnt(24)
  ds_read_b64_tr_b16 v[80:81], v8 offset:12288
  ds_read_b64_tr_b16 v[82:83], v8 offset:13312
  ds_read_b64_tr_b16 v[84:85], v9 offset:12288
  ds_read_b64_tr_b16 v[86:87], v9 offset:13312
  s_waitcnt lgkmcnt(4)
  v_mfma_f32_32x32x16_bf16 v[16:31], v[88:91], v[136:139], v[16:31]
  v_mfma_f32_32x32x16_bf16 v[32:47], v[88:91], v[140:143], v[32:47]
  s_add_u32 m0, s45, 10240
  s_add_u32 s46, s60, 65536
  buffer_load_dwordx4 v11, s[48:51], s46 offen lds
  v_mfma_f32_32x32x16_bf16 v[48:63], v[92:95], v[136:139], v[48:63]
  s_add_u32 m0, s45, 11264
  s_add_u32 s46, s60, 98304
  buffer_load_dwordx4 v11, s[48:51], s46 offen lds
  v_mfma_f32_32x32x16_bf16 v[64:79], v[92:95], v[140:143], v[64:79]
  s_add_u32 s46, s61, 1024
  buffer_load_dwordx4 v[136:139], v2, s[52:55], s46 offen
  s_add_u32 s46, s62, 1024
  buffer_load_dwordx4 v[140:143], v2, s[52:55], s46 offen
  s_waitcnt vmcnt(24)
  ds_read_b64_tr_b16 v[88:89], v8 offset:14336
  ds_read_b64_tr_b16 v[90:91], v8 offset:15360
  ds_read_b64_tr_b16 v[92:93], v9 offset:14336
  ds_read_b64_tr_b16 v[94:95], v9 offset:15360
  s_waitcnt lgkmcnt(4)
  v_mfma_f32_32x32x16_bf16 v[16:31], v[80:83], v[144:147], v[16:31]
  v_mfma_f32_32x32x16_bf16 v[32:47], v[80:83], v[148:151], v[32:47]
  s_add_u32 m0, s45, 12288
  s_add_u32 s46, s60, 131072
  buffer_load_dwordx4 v11, s[48:51], s46 offen lds
  v_mfma_f32_32x32x16_bf16 v[48:63], v[84:87], v[144:147], v[48:63]
  s_add_u32 m0, s45, 13312
  s_add_u32 s46, s60, 163840
  buffer_load_dwordx4 v11, s[48:51], s46 offen lds
  v_mfma_f32_32x32x16_bf16 v[64:79], v[84:87], v[148:151], v[64:79]
  s_add_u32 s46, s61, 2048
  buffer_load_dwordx4 v[144:147], v2, s[52:55], s46 offen
  s_add_u32 s46, s62, 2048
  buffer_load_dwordx4 v[148:151], v2, s[52:55], s46 offen
  s_waitcnt vmcnt(24)
  ds_read_b64_tr_b16 v[80:81], v8 offset:0
  ds_read_b64_tr_b16 v[82:83], v8 offset:1024
  ds_read_b64_tr_b16 v[84:85], v9 offset:0
  ds_read_b64_tr_b16 v[86:87], v9 offset:1024
  s_waitcnt lgkmcnt(4)
  v_mfma_f32_32x32x16_bf16 v[16:31], v[88:91], v[152:155], v[16:31]
  v_mfma_f32_32x32x16_bf16 v[32:47], v[88:91], v[156:159], v[32:47]
  s_add_u32 m0, s45, 14336
  s_add_u32 s46, s60, 196608
  buffer_load_dwordx4 v11, s[48:51], s46 offen lds
  v_mfma_f32_32x32x16_bf16 v[48:63], v[92:95], v[152:155], v[48:63]
  s_add_u32 m0, s45, 15360
  s_add_u32 s46, s60, 229376
  buffer_load_dwordx4 v11, s[48:51], s46 offen lds
  v_mfma_f32_32x32x16_bf16 v[64:79], v[92:95], v[156:159], v[64:79]
  s_add_u32 s46, s61, 3072
  buffer_load_dwordx4 v[152:155], v2, s[52:55], s46 offen
  s_add_u32 s46, s62, 3072
  buffer_load_dwordx4 v[156:159], v2, s[52:55], s46 offen
  s_waitcnt vmcnt(24)
  ds_read_b64_tr_b16 v[88:89], v8 offset:2048
  ds_read_b64_tr_b16 v[90:91], v8 offset:3072
  ds_read_b64_tr_b16 v[92:93], v9 offset:2048
  ds_read_b64_tr_b16 v[94:95], v9 offset:3072
  s_waitcnt lgkmcnt(4)
  v_mfma_f32_32x32x16_bf16 v[16:31], v[80:83], v[96:99], v[16:31]
  v_mfma_f32_32x32x16_bf16 v[32:47], v[80:83], v[100:103], v[32:47]
  s_add_u32 m0, s45, 0
  s_add_u32 s46, s60, 262144
  buffer_load_dwordx4 v11, s[48:51], s46 offen lds
  v_mfma_f32_32x32x16_bf16 v[48:63], v[84:87], v[96:99], v[48:63]
  s_add_u32 m0, s45, 1024
  s_add_u32 s46, s60, 294912
  buffer_load_dwordx4 v11, s[48:51], s46 offen lds
  v_mfma_f32_32x32x16_bf16 v[64:79], v[84:87], v[100:103], v[64:79]
  s_add_u32 s46, s61, 4096
  buffer_load_dwordx4 v[96:99], v2, s[52:55], s46 offen
  s_add_u32 s46, s62, 4096
  buffer_load_dwordx4 v[100:103], v2, s[52:55], s46 offen
  s_waitcnt vmcnt(24)
  ds_read_b64_tr_b16 v[80:81], v8 offset:4096
  ds_read_b64_tr_b16 v[82:83], v8 offset:5120
  ds_read_b64_tr_b16 v[84:85], v9 offset:4096
  ds_read_b64_tr_b16 v[86:87], v9 offset:5120
  s_waitcnt lgkmcnt(4)
  v_mfma_f32_32x32x16_bf16 v[16:31], v[88:91], v[104:107], v[16:31]
  v_mfma_f32_32x32x16_bf16 v[32:47], v[88:91], v[108:111], v[32:47]
  s_add_u32 m0, s45, 2048
  s_add_u32 s46, s60, 327680
  buffer_load_dwordx4 v11, s[48:51], s46 offen lds
  v_mfma_f32_32x32x16_bf16 v[48:63], v[92:95], v[104:107], v[48:63]
  s_add_u32 m0, s45, 3072
  s_add_u32 s46, s60, 360448
  buffer_load_dwordx4 v11, s[48:51], s46 offen lds
  v_mfma_f32_32x32x16_bf16 v[64:79], v[92:95], v[108:111], v[64:79]
  s_add_u32 s46, s61, 5120
  buffer_load_dwordx4 v[104:107], v2, s[52:55], s46 offen
  s_add_u32 s46, s62, 5120
  buffer_load_dwordx4 v[108:111], v2, s[52:55], s46 offen
  s_waitcnt vmcnt(24)
  ds_read_b64_tr_b16 v[88:89], v8 offset:6144
  ds_read_b64_tr_b16 v[90:91], v8 offset:7168
  ds_read_b64_tr_b16 v[92:93], v9 offset:6144
  ds_read_b64_tr_b16 v[94:95], v9 offset:7168
  s_waitcnt lgkmcnt(4)
  v_mfma_f32_32x32x16_bf16 v[16:31], v[80:83], v[112:115], v[16:31]
  v_mfma_f32_32x32x16_bf16 v[32:47], v[80:83], v[116:119], v[32:47]
  s_add_u32 m0, s45, 4096
  s_add_u32 s46, s60, 393216
  buffer_load_dwordx4 v11, s[48:51], s46 offen lds
  v_mfma_f32_32x32x16_bf16 v[48:63], v[84:87], v[112:115], v[48:63]
  s_add_u32 m0, s45, 5120
  s_add_u32 s46, s60, 425984
  buffer_load_dwordx4 v11, s[48:51], s46 offen lds
  v_mfma_f32_32x32x16_bf16 v[64:79], v[84:87], v[116:119], v[64:79]
  s_add_u32 s46, s61, 6144
  buffer_load_dwordx4 v[112:115], v2, s[52:55], s46 offen
  s_add_u32 s46, s62, 6144
  buffer_load_dwordx4 v[116:119], v2, s[52:55], s46 offen
  s_waitcnt vmcnt(24)
  ds_read_b64_tr_b16 v[80:81], v242 offset:8192
  ds_read_b64_tr_b16 v[82:83], v242 offset:9216
  ds_read_b64_tr_b16 v[84:85], v243 offset:8192
  ds_read_b64_tr_b16 v[86:87], v243 offset:9216
  s_waitcnt lgkmcnt(4)
  v_mfma_f32_32x32x16_bf16 v[16:31], v[88:91], v[120:123], v[16:31]
  v_mfma_f32_32x32x16_bf16 v[32:47], v[88:91], v[124:127], v[32:47]
  buffer_load_dword v14, v13, s[36:39], 0 offen
  v_mfma_f32_32x32x16_bf16 v[48:63], v[92:95], v[120:123], v[48:63]
  buffer_load_dwordx4 v[224:227], v3, s[56:59], 0 offen
  v_mfma_f32_32x32x16_bf16 v[64:79], v[92:95], v[124:127], v[64:79]
  buffer_load_dwordx4 v[228:231], v3, s[56:59], 0 offen offset:32
  s_waitcnt vmcnt(23)
  ds_read_b64_tr_b16 v[88:89], v242 offset:10240
  ds_read_b64_tr_b16 v[90:91], v242 offset:11264
  ds_read_b64_tr_b16 v[92:93], v243 offset:10240
  ds_read_b64_tr_b16 v[94:95], v243 offset:11264
  s_waitcnt lgkmcnt(4)
  v_mfma_f32_32x32x16_bf16 v[160:175], v[128:131], v[80:83], 0
  v_mfma_f32_32x32x16_bf16 v[176:191], v[128:131], v[84:87], 0
  v_mfma_f32_32x32x16_bf16 v[192:207], v[132:135], v[80:83], 0
  v_mfma_f32_32x32x16_bf16 v[208:223], v[132:135], v[84:87], 0
  s_waitcnt vmcnt(19)
  ds_read_b64_tr_b16 v[80:81], v242 offset:12288
  ds_read_b64_tr_b16 v[82:83], v242 offset:13312
  ds_read_b64_tr_b16 v[84:85], v243 offset:12288
  ds_read_b64_tr_b16 v[86:87], v243 offset:13312
  s_waitcnt lgkmcnt(4)
  v_mfma_f32_32x32x16_bf16 v[160:175], v[136:139], v[88:91], v[160:175]
  v_mfma_f32_32x32x16_bf16 v[176:191], v[136:139], v[92:95], v[176:191]
  v_mfma_f32_32x32x16_bf16 v[192:207], v[140:143], v[88:91], v[192:207]
  v_mfma_f32_32x32x16_bf16 v[208:223], v[140:143], v[92:95], v[208:223]
  s_waitcnt vmcnt(15)
  ds_read_b64_tr_b16 v[88:89], v242 offset:14336
  ds_read_b64_tr_b16 v[90:91], v242 offset:15360
  ds_read_b64_tr_b16 v[92:93], v243 offset:14336
  ds_read_b64_tr_b16 v[94:95], v243 offset:15360
  s_waitcnt lgkmcnt(4)
  v_mfma_f32_32x32x16_bf16 v[160:175], v[144:147], v[80:83], v[160:175]
  v_mfma_f32_32x32x16_bf16 v[176:191], v[144:147], v[84:87], v[176:191]
  v_mfma_f32_32x32x16_bf16 v[192:207], v[148:151], v[80:83], v[192:207]
  v_mfma_f32_32x32x16_bf16 v[208:223], v[148:151], v[84:87], v[208:223]
  s_waitcnt vmcnt(11)
  ds_read_b64_tr_b16 v[80:81], v242 offset:0
  ds_read_b64_tr_b16 v[82:83], v242 offset:1024
  ds_read_b64_tr_b16 v[84:85], v243 offset:0
  ds_read_b64_tr_b16 v[86:87], v243 offset:1024
  s_waitcnt lgkmcnt(4)
  v_mfma_f32_32x32x16_bf16 v[160:175], v[152:155], v[88:91], v[160:175]
  v_mfma_f32_32x32x16_bf16 v[176:191], v[152:155], v[92:95], v[176:191]
  v_mfma_f32_32x32x16_bf16 v[192:207], v[156:159], v[88:91], v[192:207]
  v_mfma_f32_32x32x16_bf16 v[208:223], v[156:159], v[92:95], v[208:223]
  s_waitcnt vmcnt(7)
  ds_read_b64_tr_b16 v[88:89], v242 offset:2048
  ds_read_b64_tr_b16 v[90:91], v242 offset:3072
  ds_read_b64_tr_b16 v[92:93], v243 offset:2048
  ds_read_b64_tr_b16 v[94:95], v243 offset:3072
  s_waitcnt lgkmcnt(4)
  v_mfma_f32_32x32x16_bf16 v[160:175], v[96:99], v[80:83], v[160:175]
  v_mfma_f32_32x32x16_bf16 v[176:191], v[96:99], v[84:87], v[176:191]
  v_mfma_f32_32x32x16_bf16 v[192:207], v[100:103], v[80:83], v[192:207]
  v_mfma_f32_32x32x16_bf16 v[208:223], v[100:103], v[84:87], v[208:223]
  s_waitcnt vmcnt(3)
  ds_read_b64_tr_b16 v[80:81], v242 offset:4096
  ds_read_b64_tr_b16 v[82:83], v242 offset:5120
  ds_read_b64_tr_b16 v[84:85], v243 offset:4096
  ds_read_b64_tr_b16 v[86:87], v243 offset:5120
  s_waitcnt lgkmcnt(4)
  v_mfma_f32_32x32x16_bf16 v[160:175], v[104:107], v[88:91], v[160:175]
  v_mfma_f32_32x32x16_bf16 v[176:191], v[104:107], v[92:95], v[176:191]
  v_mfma_f32_32x32x16_bf16 v[192:207], v[108:111], v[88:91], v[192:207]
  v_mfma_f32_32x32x16_bf16 v[208:223], v[108:111], v[92:95], v[208:223]
  s_waitcnt lgkmcnt(0)
  v_mfma_f32_32x32x16_bf16 v[160:175], v[112:115], v[80:83], v[160:175]
  v_mfma_f32_32x32x16_bf16 v[176:191], v[112:115], v[84:87], v[176:191]
  v_mfma_f32_32x32x16_bf16 v[192:207], v[116:119], v[80:83], v[192:207]
  v_mfma_f32_32x32x16_bf16 v[208:223], v[116:119], v[84:87], v[208:223]
  ds_write_b128 v10, v[48:51] offset:0
  ds_write_b128 v10, v[52:55] offset:1024
  ds_write_b128 v10, v[56:59] offset:2048
  ds_write_b128 v10, v[60:63] offset:3072
  ds_write_b128 v10, v[64:67] offset:4096
  ds_write_b128 v10, v[68:71] offset:5120
  ds_write_b128 v10, v[72:75] offset:6144
  ds_write_b128 v10, v[76:79] offset:7168
  s_nop 7
  ds_write_b128 v10, v[192:195] offset:8192
  ds_write_b128 v10, v[196:199] offset:9216
  ds_write_b128 v10, v[200:203] offset:10240
  ds_write_b128 v10, v[204:207] offset:11264
  ds_write_b128 v10, v[208:211] offset:12288
  ds_write_b128 v10, v[212:215] offset:13312
  ds_write_b128 v10, v[216:219] offset:14336
  ds_write_b128 v10, v[220:223] offset:15360
  s_waitcnt vmcnt(0)
  v_permlane32_swap_b32 v224, v226
  v_permlane32_swap_b32 v225, v227
  v_permlane32_swap_b32 v228, v230
  v_permlane32_swap_b32 v229, v231
  s_waitcnt lgkmcnt(0)
  s_barrier
  ds_read_b128 v[96:99], v12 offset:4096
  ds_read_b128 v[100:103], v12 offset:5120
  ds_read_b128 v[104:107], v12 offset:6144
  ds_read_b128 v[108:111], v12 offset:7168
  ds_read_b128 v[128:131], v12 offset:12288
  ds_read_b128 v[132:135], v12 offset:13312
  ds_read_b128 v[136:139], v12 offset:14336
  ds_read_b128 v[140:143], v12 offset:15360
  ds_read_b128 v[80:83], v12 offset:0
  ds_read_b128 v[84:87], v12 offset:1024
  ds_read_b128 v[88:91], v12 offset:2048
  ds_read_b128 v[92:95], v12 offset:3072
  ds_read_b128 v[112:115], v12 offset:8192
  ds_read_b128 v[116:119], v12 offset:9216
  ds_read_b128 v[120:123], v12 offset:10240
  ds_read_b128 v[124:127], v12 offset:11264
  v_lshlrev_b32 v144, 16, v224
  v_and_b32 v145, 0xffff0000, v224
  v_lshlrev_b32 v146, 16, v225
  v_and_b32 v147, 0xffff0000, v225
  v_lshlrev_b32 v148, 16, v226
  v_and_b32 v149, 0xffff0000, v226
  v_lshlrev_b32 v150, 16, v227
  v_and_b32 v151, 0xffff0000, v227
  v_lshlrev_b32 v152, 16, v228
  v_and_b32 v153, 0xffff0000, v228
  v_lshlrev_b32 v154, 16, v229
  v_and_b32 v155, 0xffff0000, v229
  v_lshlrev_b32 v156, 16, v230
  v_and_b32 v157, 0xffff0000, v230
  v_lshlrev_b32 v158, 16, v231
  v_and_b32 v159, 0xffff0000, v231
  s_waitcnt lgkmcnt(12)
  v_pk_add_f32 v[32:33], v[32:33], v[96:97]
  v_pk_add_f32 v[34:35], v[34:35], v[98:99]
  v_pk_add_f32 v[36:37], v[36:37], v[100:101]
  v_pk_add_f32 v[38:39], v[38:39], v[102:103]
  v_pk_add_f32 v[40:41], v[40:41], v[104:105]
  v_pk_add_f32 v[42:43], v[42:43], v[106:107]
  v_pk_add_f32 v[44:45], v[44:45], v[108:109]
  v_pk_add_f32 v[46:47], v[46:47], v[110:111]
  s_waitcnt lgkmcnt(8)
  v_pk_add_f32 v[176:177], v[176:177], v[128:129]
  v_pk_add_f32 v[178:179], v[178:179], v[130:131]
  v_pk_add_f32 v[180:181], v[180:181], v[132:133]
  v_pk_add_f32 v[182:183], v[182:183], v[134:135]
  v_pk_add_f32 v[184:185], v[184:185], v[136:137]
  v_pk_add_f32 v[186:187], v[186:187], v[138:139]
  v_pk_add_f32 v[188:189], v[188:189], v[140:141]
  v_pk_add_f32 v[190:191], v[190:191], v[142:143]
  s_waitcnt lgkmcnt(0)
  ds_write_b128 v12, v[32:35] offset:0
  ds_write_b128 v12, v[36:39] offset:1024
  ds_write_b128 v12, v[40:43] offset:2048
  ds_write_b128 v12, v[44:47] offset:3072
  ds_write_b128 v12, v[176:179] offset:4096
  ds_write_b128 v12, v[180:183] offset:5120
  ds_write_b128 v12, v[184:187] offset:6144
  ds_write_b128 v12, v[188:191] offset:7168
  v_pk_add_f32 v[16:17], v[16:17], v[80:81]
  v_pk_add_f32 v[18:19], v[18:19], v[82:83]
  v_pk_add_f32 v[20:21], v[20:21], v[84:85]
  v_pk_add_f32 v[22:23], v[22:23], v[86:87]
  v_pk_add_f32 v[24:25], v[24:25], v[88:89]
  v_pk_add_f32 v[26:27], v[26:27], v[90:91]
  v_pk_add_f32 v[28:29], v[28:29], v[92:93]
  v_pk_add_f32 v[30:31], v[30:31], v[94:95]
  v_pk_add_f32 v[160:161], v[160:161], v[112:113]
  v_pk_add_f32 v[162:163], v[162:163], v[114:115]
  v_pk_add_f32 v[164:165], v[164:165], v[116:117]
  v_pk_add_f32 v[166:167], v[166:167], v[118:119]
  v_pk_add_f32 v[168:169], v[168:169], v[120:121]
  v_pk_add_f32 v[170:171], v[170:171], v[122:123]
  v_pk_add_f32 v[172:173], v[172:173], v[124:125]
  v_pk_add_f32 v[174:175], v[174:175], v[126:127]
  s_waitcnt lgkmcnt(0)
  s_barrier
  ds_read_b128 v[80:83], v244 offset:0
  ds_read_b128 v[84:87], v244 offset:1024
  ds_read_b128 v[88:91], v244 offset:2048
  ds_read_b128 v[92:95], v244 offset:3072
  ds_read_b128 v[96:99], v244 offset:4096
  ds_read_b128 v[100:103], v244 offset:5120
  ds_read_b128 v[104:107], v244 offset:6144
  ds_read_b128 v[108:111], v244 offset:7168
  s_waitcnt lgkmcnt(4)
  v_pk_add_f32 v[16:17], v[16:17], v[80:81]
  v_pk_add_f32 v[18:19], v[18:19], v[82:83]
  v_pk_add_f32 v[20:21], v[20:21], v[84:85]
  v_pk_add_f32 v[22:23], v[22:23], v[86:87]
  v_pk_add_f32 v[24:25], v[24:25], v[88:89]
  v_pk_add_f32 v[26:27], v[26:27], v[90:91]
  v_pk_add_f32 v[28:29], v[28:29], v[92:93]
  v_pk_add_f32 v[30:31], v[30:31], v[94:95]
  v_pk_mul_f32 v[16:17], v[16:17], v[14:15] op_sel_hi:[1,0]
  v_pk_mul_f32 v[18:19], v[18:19], v[14:15] op_sel_hi:[1,0]
  v_pk_mul_f32 v[20:21], v[20:21], v[14:15] op_sel_hi:[1,0]
  v_pk_mul_f32 v[22:23], v[22:23], v[14:15] op_sel_hi:[1,0]
  v_pk_mul_f32 v[24:25], v[24:25], v[14:15] op_sel_hi:[1,0]
  v_pk_mul_f32 v[26:27], v[26:27], v[14:15] op_sel_hi:[1,0]
  v_pk_mul_f32 v[28:29], v[28:29], v[14:15] op_sel_hi:[1,0]
  v_pk_mul_f32 v[30:31], v[30:31], v[14:15] op_sel_hi:[1,0]
  v_mul_f32 v48, 0xbfb8aa3b, v16
  v_mul_f32 v49, 0xbfb8aa3b, v17
  v_mul_f32 v50, 0xbfb8aa3b, v18
  v_mul_f32 v51, 0xbfb8aa3b, v19
  v_mul_f32 v52, 0xbfb8aa3b, v20
  v_mul_f32 v53, 0xbfb8aa3b, v21
  v_mul_f32 v54, 0xbfb8aa3b, v22
  v_mul_f32 v55, 0xbfb8aa3b, v23
  v_mul_f32 v56, 0xbfb8aa3b, v24
  v_mul_f32 v57, 0xbfb8aa3b, v25
  v_mul_f32 v58, 0xbfb8aa3b, v26
  v_mul_f32 v59, 0xbfb8aa3b, v27
  v_mul_f32 v60, 0xbfb8aa3b, v28
  v_mul_f32 v61, 0xbfb8aa3b, v29
  v_mul_f32 v62, 0xbfb8aa3b, v30
  v_mul_f32 v63, 0xbfb8aa3b, v31
  v_exp_f32 v48, v48
  v_exp_f32 v49, v49
  v_exp_f32 v50, v50
  v_exp_f32 v51, v51
  v_exp_f32 v52, v52
  v_exp_f32 v53, v53
  v_exp_f32 v54, v54
  v_exp_f32 v55, v55
  v_exp_f32 v56, v56
  v_exp_f32 v57, v57
  v_exp_f32 v58, v58
  v_exp_f32 v59, v59
  v_exp_f32 v60, v60
  v_exp_f32 v61, v61
  v_exp_f32 v62, v62
  v_exp_f32 v63, v63
  s_waitcnt lgkmcnt(0)
  v_pk_add_f32 v[160:161], v[160:161], v[96:97]
  v_pk_add_f32 v[162:163], v[162:163], v[98:99]
  v_pk_add_f32 v[164:165], v[164:165], v[100:101]
  v_pk_add_f32 v[166:167], v[166:167], v[102:103]
  v_pk_add_f32 v[168:169], v[168:169], v[104:105]
  v_pk_add_f32 v[170:171], v[170:171], v[106:107]
  v_pk_add_f32 v[172:173], v[172:173], v[108:109]
  v_pk_add_f32 v[174:175], v[174:175], v[110:111]
  v_pk_add_f32 v[48:49], v[48:49], 1.0 op_sel_hi:[1,0]
  v_pk_add_f32 v[50:51], v[50:51], 1.0 op_sel_hi:[1,0]
  v_pk_add_f32 v[52:53], v[52:53], 1.0 op_sel_hi:[1,0]
  v_pk_add_f32 v[54:55], v[54:55], 1.0 op_sel_hi:[1,0]
  v_pk_add_f32 v[56:57], v[56:57], 1.0 op_sel_hi:[1,0]
  v_pk_add_f32 v[58:59], v[58:59], 1.0 op_sel_hi:[1,0]
  v_pk_add_f32 v[60:61], v[60:61], 1.0 op_sel_hi:[1,0]
  v_pk_add_f32 v[62:63], v[62:63], 1.0 op_sel_hi:[1,0]
  v_rcp_f32 v48, v48
  v_rcp_f32 v49, v49
  v_rcp_f32 v50, v50
  v_rcp_f32 v51, v51
  v_rcp_f32 v52, v52
  v_rcp_f32 v53, v53
  v_rcp_f32 v54, v54
  v_rcp_f32 v55, v55
  v_rcp_f32 v56, v56
  v_rcp_f32 v57, v57
  v_rcp_f32 v58, v58
  v_rcp_f32 v59, v59
  v_rcp_f32 v60, v60
  v_rcp_f32 v61, v61
  v_rcp_f32 v62, v62
  v_rcp_f32 v63, v63
  v_pk_mul_f32 v[16:17], v[16:17], v[160:161]
  v_pk_mul_f32 v[18:19], v[18:19], v[162:163]
  v_pk_mul_f32 v[20:21], v[20:21], v[164:165]
  v_pk_mul_f32 v[22:23], v[22:23], v[166:167]
  v_pk_mul_f32 v[24:25], v[24:25], v[168:169]
  v_pk_mul_f32 v[26:27], v[26:27], v[170:171]
  v_pk_mul_f32 v[28:29], v[28:29], v[172:173]
  v_pk_mul_f32 v[30:31], v[30:31], v[174:175]
  v_pk_fma_f32 v[16:17], v[16:17], v[48:49], v[144:145]
  v_pk_fma_f32 v[18:19], v[18:19], v[50:51], v[146:147]
  v_pk_fma_f32 v[20:21], v[20:21], v[52:53], v[148:149]
  v_pk_fma_f32 v[22:23], v[22:23], v[54:55], v[150:151]
  v_pk_fma_f32 v[24:25], v[24:25], v[56:57], v[152:153]
  v_pk_fma_f32 v[26:27], v[26:27], v[58:59], v[154:155]
  v_pk_fma_f32 v[28:29], v[28:29], v[60:61], v[156:157]
  v_pk_fma_f32 v[30:31], v[30:31], v[62:63], v[158:159]
  v_cvt_pk_bf16_f32 v32, v16, v17
  v_cvt_pk_bf16_f32 v33, v18, v19
  v_cvt_pk_bf16_f32 v34, v20, v21
  v_cvt_pk_bf16_f32 v35, v22, v23
  v_cvt_pk_bf16_f32 v36, v24, v25
  v_cvt_pk_bf16_f32 v37, v26, v27
  v_cvt_pk_bf16_f32 v38, v28, v29
  v_cvt_pk_bf16_f32 v39, v30, v31
  s_nop 1
  v_permlane32_swap_b32 v32, v34
  v_permlane32_swap_b32 v33, v35
  v_permlane32_swap_b32 v36, v38
  v_permlane32_swap_b32 v37, v39
  s_nop 0
  buffer_store_dwordx4 v[32:35], v3, s[40:43], 0 offen
  buffer_store_dwordx4 v[36:39], v3, s[40:43], 0 offen offset:32
  s_endpgm
k2_fft:
  s_setprio 3
  s_sub_u32 s14, s2, 224
  s_waitcnt lgkmcnt(0)
  s_add_u32 s40, s12, 0xff0000
  s_addc_u32 s41, s13, 0
  s_mov_b32 s42, 0x4000
  s_mov_b32 s43, 0x20000
  s_mov_b32 s24, s12
  s_mov_b32 s25, s13
  s_mov_b32 s26, 0x1c0000
  s_mov_b32 s27, 0x20000
  s_add_u32 s28, s12, 0xa00000
  s_addc_u32 s29, s13, 0
  s_mov_b32 s30, 0x1c2000
  s_mov_b32 s31, 0x20000
  s_add_u32 s36, s12, 0xc00000
  s_addc_u32 s37, s13, 0
  s_mov_b32 s38, 0x1c0000
  s_mov_b32 s39, 0x20000
  s_getpc_b64 s[20:21]
  s_add_u32 s20, s20, tabS@rel32@lo+4
  s_addc_u32 s21, s21, tabS@rel32@hi+12
  s_mov_b32 s32, s20
  s_mov_b32 s33, s21
  s_mov_b32 s34, 0x6000
  s_mov_b32 s35, 0x20000
  s_cmp_eq_u32 s14, 224
  s_cselect_b32 s15, 0, s14
  s_lshl_b32 s15, s15, 13
  s_lshl_b32 s16, s3, 11
  s_add_u32 s15, s15, s16
  v_lshrrev_b32 v4, 3, v0
  v_lshrrev_b32 v5, 3, v0
  v_and_b32 v5, 2, v5
  v_and_b32 v6, 7, v0
  v_xor_b32 v5, v5, v6
  v_lshlrev_b32 v4, 7, v4
  v_lshl_add_u32 v1, v5, 4, v4
  v_xor_b32 v2, 64, v1
  s_mov_b32 m0, s16
  s_add_u32 s17, s15, 1024
  buffer_load_dwordx4 v1, s[24:27], s15 offen lds
  s_add_u32 m0, s16, 1024
  v_lshlrev_b32 v3, 4, v0
  buffer_load_dwordx4 v2, s[24:27], s17 offen lds
  s_lshl_b32 s17, s3, 12
  buffer_load_dwordx4 v[16:19], v3, s[32:35], s17 offen offset:0
  buffer_load_dwordx4 v[20:23], v3, s[32:35], s17 offen offset:1024
  buffer_load_dwordx4 v[24:27], v3, s[32:35], s17 offen offset:2048
  buffer_load_dwordx4 v[28:31], v3, s[32:35], s17 offen offset:3072
  s_movk_i32 s17, 0x4000
  s_movk_i32 s18, 0x5000
  buffer_load_dwordx4 v[40:43], v3, s[32:35], s17 offen offset:0
  buffer_load_dwordx4 v[44:47], v3, s[32:35], s17 offen offset:1024
  buffer_load_dwordx4 v[48:51], v3, s[32:35], s17 offen offset:2048
  buffer_load_dwordx4 v[52:55], v3, s[32:35], s17 offen offset:3072
  v_and_b32 v4, 15, v0
  v_lshrrev_b32 v5, 4, v0
  s_lshl_b32 s19, s3, 4
  v_add_u32 v6, s19, v4
  v_lshlrev_b32 v7, 2, v6
  v_lshl_add_u32 v7, v5, 10, v7
  s_lshl_b32 s22, s14, 13
  s_add_u32 s23, s22, 4096
  buffer_load_dword v88, v7, s[28:31], s22 offen offset:0
  buffer_load_dword v89, v7, s[28:31], s22 offen offset:256
  buffer_load_dword v90, v7, s[28:31], s22 offen offset:512
  buffer_load_dword v91, v7, s[28:31], s22 offen offset:768
  buffer_load_dword v92, v7, s[28:31], s23 offen offset:0
  buffer_load_dword v93, v7, s[28:31], s23 offen offset:256
  buffer_load_dword v94, v7, s[28:31], s23 offen offset:512
  buffer_load_dword v95, v7, s[28:31], s23 offen offset:768
  buffer_load_dwordx4 v[64:67], v3, s[32:35], s18 offen offset:0
  buffer_load_dwordx4 v[68:71], v3, s[32:35], s18 offen offset:1024
  buffer_load_dwordx4 v[72:75], v3, s[32:35], s18 offen offset:2048
  buffer_load_dwordx4 v[76:79], v3, s[32:35], s18 offen offset:3072
  v_lshlrev_b32 v8, 1, v5
  v_lshl_add_u32 v9, v5, 2, s19
  v_add_u32 v10, 0, v8
  v_mul_u32_u24 v10, v10, v6
  v_cvt_f32_u32 v10, v10
  v_mul_f32 v10, 0x3a000000, v10
  v_cos_f32 v96, v10
  v_sin_f32 v97, v10
  v_add_u32 v10, 1, v8
  v_mul_u32_u24 v10, v10, v6
  v_cvt_f32_u32 v10, v10
  v_mul_f32 v10, 0x3a000000, v10
  v_cos_f32 v98, v10
  v_sin_f32 v99, v10
  v_add_u32 v10, 8, v8
  v_mul_u32_u24 v10, v10, v6
  v_cvt_f32_u32 v10, v10
  v_mul_f32 v10, 0x3a000000, v10
  v_cos_f32 v100, v10
  v_sin_f32 v101, v10
  v_add_u32 v10, 9, v8
  v_mul_u32_u24 v10, v10, v6
  v_cvt_f32_u32 v10, v10
  v_mul_f32 v10, 0x3a000000, v10
  v_cos_f32 v102, v10
  v_sin_f32 v103, v10
  v_add_u32 v10, 16, v8
  v_mul_u32_u24 v10, v10, v6
  v_cvt_f32_u32 v10, v10
  v_mul_f32 v10, 0x3a000000, v10
  v_cos_f32 v104, v10
  v_sin_f32 v105, v10
  v_add_u32 v10, 17, v8
  v_mul_u32_u24 v10, v10, v6
  v_cvt_f32_u32 v10, v10
  v_mul_f32 v10, 0x3a000000, v10
  v_cos_f32 v106, v10
  v_sin_f32 v107, v10
  v_add_u32 v10, 24, v8
  v_mul_u32_u24 v10, v10, v6
  v_cvt_f32_u32 v10, v10
  v_mul_f32 v10, 0x3a000000, v10
  v_cos_f32 v108, v10
  v_sin_f32 v109, v10
  v_add_u32 v10, 25, v8
  v_mul_u32_u24 v10, v10, v6
  v_cvt_f32_u32 v10, v10
  v_mul_f32 v10, 0x3a000000, v10
  v_cos_f32 v110, v10
  v_sin_f32 v111, v10
  s_cmp_eq_u32 s14, 0
  s_cselect_b32 s46, 1, 0
  s_cmp_eq_u32 s14, 224
  s_cselect_b32 s46, 1, s46
  s_cmp_eq_u32 s46, 1
  s_mov_b32 s47, 0x36124925
  s_cselect_b32 s47, 0x35924925, s47
  v_add_u32 v10, 0, v9
  v_add_u32 v11, 0, v4
  v_mul_u32_u24 v10, v10, v11
  v_cvt_f32_u32 v10, v10
  v_mul_f32 v10, 0x3a000000, v10
  v_cos_f32 v12, v10
  v_sin_f32 v13, v10
  s_nop 0
  v_mul_f32 v112, s47, v12
  v_mul_f32 v113, s47, v13
  v_add_u32 v10, 1, v9
  v_add_u32 v11, 0, v4
  v_mul_u32_u24 v10, v10, v11
  v_cvt_f32_u32 v10, v10
  v_mul_f32 v10, 0x3a000000, v10
  v_cos_f32 v12, v10
  v_sin_f32 v13, v10
  s_nop 0
  v_mul_f32 v114, s47, v12
  v_mul_f32 v115, s47, v13
  v_add_u32 v10, 2, v9
  v_add_u32 v11, 0, v4
  v_mul_u32_u24 v10, v10, v11
  v_cvt_f32_u32 v10, v10
  v_mul_f32 v10, 0x3a000000, v10
  v_cos_f32 v12, v10
  v_sin_f32 v13, v10
  s_nop 0
  v_mul_f32 v116, s47, v12
  v_mul_f32 v117, s47, v13
  v_add_u32 v10, 3, v9
  v_add_u32 v11, 0, v4
  v_mul_u32_u24 v10, v10, v11
  v_cvt_f32_u32 v10, v10
  v_mul_f32 v10, 0x3a000000, v10
  v_cos_f32 v12, v10
  v_sin_f32 v13, v10
  s_nop 0
  v_mul_f32 v118, s47, v12
  v_mul_f32 v119, s47, v13
  v_add_u32 v10, 0, v9
  v_add_u32 v11, 16, v4
  v_mul_u32_u24 v10, v10, v11
  v_cvt_f32_u32 v10, v10
  v_mul_f32 v10, 0x3a000000, v10
  v_cos_f32 v12, v10
  v_sin_f32 v13, v10
  s_nop 0
  v_mul_f32 v120, s47, v12
  v_mul_f32 v121, s47, v13
  v_add_u32 v10, 1, v9
  v_add_u32 v11, 16, v4
  v_mul_u32_u24 v10, v10, v11
  v_cvt_f32_u32 v10, v10
  v_mul_f32 v10, 0x3a000000, v10
  v_cos_f32 v12, v10
  v_sin_f32 v13, v10
  s_nop 0
  v_mul_f32 v122, s47, v12
  v_mul_f32 v123, s47, v13
  v_add_u32 v10, 2, v9
  v_add_u32 v11, 16, v4
  v_mul_u32_u24 v10, v10, v11
  v_cvt_f32_u32 v10, v10
  v_mul_f32 v10, 0x3a000000, v10
  v_cos_f32 v12, v10
  v_sin_f32 v13, v10
  s_nop 0
  v_mul_f32 v124, s47, v12
  v_mul_f32 v125, s47, v13
  v_add_u32 v10, 3, v9
  v_add_u32 v11, 16, v4
  v_mul_u32_u24 v10, v10, v11
  v_cvt_f32_u32 v10, v10
  v_mul_f32 v10, 0x3a000000, v10
  v_cos_f32 v12, v10
  v_sin_f32 v13, v10
  s_nop 0
  v_mul_f32 v126, s47, v12
  v_mul_f32 v127, s47, v13
  v_lshrrev_b32 v10, 2, v4
  v_lshl_add_u32 v11, v5, 3, v10
  v_lshlrev_b32 v11, 7, v11
  v_lshrrev_b32 v10, 1, v10
  v_and_b32 v12, 1, v5
  v_lshl_add_u32 v10, v12, 1, v10
  v_lshl_add_u32 v11, v10, 5, v11
  v_and_b32 v10, 3, v0
  v_lshl_add_u32 v12, v10, 3, v11
  v_xor_b32 v13, 32, v12
  v_xor_b32 v14, 64, v12
  v_xor_b32 v15, 96, v12
  s_waitcnt vmcnt(20)
  s_barrier
  s_cmp_eq_u32 s46, 0
  s_cbranch_scc1 fft_n
  s_lshl_b32 s17, s3, 10
  v_add_u32 v10, s17, v3
  ds_read_b128 v[128:131], v10
  ds_read_b128 v[132:135], v10 offset:4096
  s_cmp_eq_u32 s14, 224
  s_cselect_b32 s17, 16, 0
  s_waitcnt lgkmcnt(0)
  v_lshrrev_b32 v128, s17, v128
  v_and_b32 v128, 0xffff, v128
  v_lshrrev_b32 v129, s17, v129
  v_and_b32 v129, 0xffff, v129
  v_lshrrev_b32 v130, s17, v130
  v_and_b32 v130, 0xffff, v130
  v_lshrrev_b32 v131, s17, v131
  v_and_b32 v131, 0xffff, v131
  v_lshrrev_b32 v132, s17, v132
  v_and_b32 v132, 0xffff, v132
  v_lshrrev_b32 v133, s17, v133
  v_and_b32 v133, 0xffff, v133
  v_lshrrev_b32 v134, s17, v134
  v_and_b32 v134, 0xffff, v134
  v_lshrrev_b32 v135, s17, v135
  v_and_b32 v135, 0xffff, v135
  ds_write_b128 v10, v[128:131]
  ds_write_b128 v10, v[132:135] offset:4096
  s_waitcnt lgkmcnt(0)
  s_barrier
fft_n:
  ds_read_b64_tr_b16 v[128:129], v12 offset:0
  ds_read_b64_tr_b16 v[130:131], v12 offset:512
  ds_read_b64_tr_b16 v[132:133], v12 offset:4096
  ds_read_b64_tr_b16 v[134:135], v12 offset:4608
  ds_read_b64_tr_b16 v[136:137], v13 offset:0
  ds_read_b64_tr_b16 v[138:139], v13 offset:512
  ds_read_b64_tr_b16 v[140:141], v13 offset:4096
  ds_read_b64_tr_b16 v[142:143], v13 offset:4608
  ds_read_b64_tr_b16 v[144:145], v14 offset:0
  ds_read_b64_tr_b16 v[146:147], v14 offset:512
  ds_read_b64_tr_b16 v[148:149], v14 offset:4096
  ds_read_b64_tr_b16 v[150:151], v14 offset:4608
  ds_read_b64_tr_b16 v[152:153], v15 offset:0
  ds_read_b64_tr_b16 v[154:155], v15 offset:512
  ds_read_b64_tr_b16 v[156:157], v15 offset:4096
  ds_read_b64_tr_b16 v[158:159], v15 offset:4608
  s_waitcnt vmcnt(16)
  v_xor_b32 v32, 0x80008000, v24
  v_xor_b32 v33, 0x80008000, v25
  v_xor_b32 v34, 0x80008000, v26
  v_xor_b32 v35, 0x80008000, v27
  v_xor_b32 v36, 0x80008000, v28
  v_xor_b32 v37, 0x80008000, v29
  v_xor_b32 v38, 0x80008000, v30
  v_xor_b32 v39, 0x80008000, v31
  s_waitcnt lgkmcnt(12)
  v_mfma_f32_16x16x32_bf16 v[160:163], v[128:131], v[16:19], 0
  v_mfma_f32_16x16x32_bf16 v[164:167], v[128:131], v[24:27], 0
  v_mfma_f32_16x16x32_bf16 v[160:163], v[132:135], v[20:23], v[160:163]
  v_mfma_f32_16x16x32_bf16 v[164:167], v[132:135], v[28:31], v[164:167]
  s_waitcnt lgkmcnt(8)
  v_mfma_f32_16x16x32_bf16 v[168:171], v[136:139], v[16:19], 0
  v_mfma_f32_16x16x32_bf16 v[172:175], v[136:139], v[24:27], 0
  v_mfma_f32_16x16x32_bf16 v[168:171], v[140:143], v[20:23], v[168:171]
  v_mfma_f32_16x16x32_bf16 v[172:175], v[140:143], v[28:31], v[172:175]
  s_waitcnt lgkmcnt(4)
  v_mfma_f32_16x16x32_bf16 v[176:179], v[144:147], v[16:19], 0
  v_mfma_f32_16x16x32_bf16 v[180:183], v[144:147], v[24:27], 0
  v_mfma_f32_16x16x32_bf16 v[176:179], v[148:151], v[20:23], v[176:179]
  v_mfma_f32_16x16x32_bf16 v[180:183], v[148:151], v[28:31], v[180:183]
  s_waitcnt lgkmcnt(0)
  v_mfma_f32_16x16x32_bf16 v[184:187], v[152:155], v[16:19], 0
  v_mfma_f32_16x16x32_bf16 v[188:191], v[152:155], v[24:27], 0
  v_mfma_f32_16x16x32_bf16 v[184:187], v[156:159], v[20:23], v[184:187]
  v_mfma_f32_16x16x32_bf16 v[188:191], v[156:159], v[28:31], v[188:191]
  s_waitcnt vmcnt(12)
  v_xor_b32 v56, 0x80008000, v48
  v_xor_b32 v57, 0x80008000, v49
  v_xor_b32 v58, 0x80008000, v50
  v_xor_b32 v59, 0x80008000, v51
  v_xor_b32 v60, 0x80008000, v52
  v_xor_b32 v61, 0x80008000, v53
  v_xor_b32 v62, 0x80008000, v54
  v_xor_b32 v63, 0x80008000, v55
  v_add_f32 v160, v160, v165
  v_sub_f32 v161, v161, v164
  v_mul_f32 v200, v160, v96
  v_mul_f32 v202, v161, v96
  v_fma_f32 v200, v161, v97, v200
  v_fma_f32 v202, -v160, v97, v202
  v_add_f32 v162, v162, v167
  v_sub_f32 v163, v163, v166
  v_mul_f32 v201, v162, v98
  v_mul_f32 v203, v163, v98
  v_fma_f32 v201, v163, v99, v201
  v_fma_f32 v203, -v162, v99, v203
  v_cvt_pk_bf16_f32 v192, v200, v201
  v_cvt_pk_bf16_f32 v196, v202, v203
  v_add_f32 v168, v168, v173
  v_sub_f32 v169, v169, v172
  v_mul_f32 v200, v168, v100
  v_mul_f32 v202, v169, v100
  v_fma_f32 v200, v169, v101, v200
  v_fma_f32 v202, -v168, v101, v202
  v_add_f32 v170, v170, v175
  v_sub_f32 v171, v171, v174
  v_mul_f32 v201, v170, v102
  v_mul_f32 v203, v171, v102
  v_fma_f32 v201, v171, v103, v201
  v_fma_f32 v203, -v170, v103, v203
  v_cvt_pk_bf16_f32 v193, v200, v201
  v_cvt_pk_bf16_f32 v197, v202, v203
  v_add_f32 v176, v176, v181
  v_sub_f32 v177, v177, v180
  v_mul_f32 v200, v176, v104
  v_mul_f32 v202, v177, v104
  v_fma_f32 v200, v177, v105, v200
  v_fma_f32 v202, -v176, v105, v202
  v_add_f32 v178, v178, v183
  v_sub_f32 v179, v179, v182
  v_mul_f32 v201, v178, v106
  v_mul_f32 v203, v179, v106
  v_fma_f32 v201, v179, v107, v201
  v_fma_f32 v203, -v178, v107, v203
  v_cvt_pk_bf16_f32 v194, v200, v201
  v_cvt_pk_bf16_f32 v198, v202, v203
  v_add_f32 v184, v184, v189
  v_sub_f32 v185, v185, v188
  v_mul_f32 v200, v184, v108
  v_mul_f32 v202, v185, v108
  v_fma_f32 v200, v185, v109, v200
  v_fma_f32 v202, -v184, v109, v202
  v_add_f32 v186, v186, v191
  v_sub_f32 v187, v187, v190
  v_mul_f32 v201, v186, v110
  v_mul_f32 v203, v187, v110
  v_fma_f32 v201, v187, v111, v201
  v_fma_f32 v203, -v186, v111, v203
  v_cvt_pk_bf16_f32 v195, v200, v201
  v_cvt_pk_bf16_f32 v199, v202, v203
  s_nop 1
  v_mfma_f32_16x16x32_bf16 v[128:131], v[40:43], v[192:195], 0
  v_mfma_f32_16x16x32_bf16 v[136:139], v[40:43], v[196:199], 0
  v_mfma_f32_16x16x32_bf16 v[132:135], v[44:47], v[192:195], 0
  v_mfma_f32_16x16x32_bf16 v[140:143], v[44:47], v[196:199], 0
  v_mfma_f32_16x16x32_bf16 v[128:131], v[48:51], v[196:199], v[128:131]
  v_mfma_f32_16x16x32_bf16 v[136:139], v[56:59], v[192:195], v[136:139]
  v_mfma_f32_16x16x32_bf16 v[132:135], v[52:55], v[196:199], v[132:135]
  v_mfma_f32_16x16x32_bf16 v[140:143], v[60:63], v[192:195], v[140:143]
  s_waitcnt vmcnt(0)
  v_xor_b32 v80, 0x80008000, v72
  v_xor_b32 v81, 0x80008000, v73
  v_xor_b32 v82, 0x80008000, v74
  v_xor_b32 v83, 0x80008000, v75
  v_xor_b32 v84, 0x80008000, v76
  v_xor_b32 v85, 0x80008000, v77
  v_xor_b32 v86, 0x80008000, v78
  v_xor_b32 v87, 0x80008000, v79
  v_lshlrev_b32 v160, 16, v88
  v_and_b32 v168, 0xffff0000, v88
  v_lshlrev_b32 v161, 16, v89
  v_and_b32 v169, 0xffff0000, v89
  v_lshlrev_b32 v162, 16, v90
  v_and_b32 v170, 0xffff0000, v90
  v_lshlrev_b32 v163, 16, v91
  v_and_b32 v171, 0xffff0000, v91
  v_lshlrev_b32 v164, 16, v92
  v_and_b32 v172, 0xffff0000, v92
  v_lshlrev_b32 v165, 16, v93
  v_and_b32 v173, 0xffff0000, v93
  v_lshlrev_b32 v166, 16, v94
  v_and_b32 v174, 0xffff0000, v94
  v_lshlrev_b32 v167, 16, v95
  v_and_b32 v175, 0xffff0000, v95
  v_mul_f32 v176, v128, v160
  v_mul_f32 v184, v128, v168
  v_fma_f32 v176, -v136, v168, v176
  v_fma_f32 v184, v136, v160, v184
  v_mul_f32 v177, v129, v161
  v_mul_f32 v185, v129, v169
  v_fma_f32 v177, -v137, v169, v177
  v_fma_f32 v185, v137, v161, v185
  v_mul_f32 v178, v130, v162
  v_mul_f32 v186, v130, v170
  v_fma_f32 v178, -v138, v170, v178
  v_fma_f32 v186, v138, v162, v186
  v_mul_f32 v179, v131, v163
  v_mul_f32 v187, v131, v171
  v_fma_f32 v179, -v139, v171, v179
  v_fma_f32 v187, v139, v163, v187
  v_mul_f32 v180, v132, v164
  v_mul_f32 v188, v132, v172
  v_fma_f32 v180, -v140, v172, v180
  v_fma_f32 v188, v140, v164, v188
  v_mul_f32 v181, v133, v165
  v_mul_f32 v189, v133, v173
  v_fma_f32 v181, -v141, v173, v181
  v_fma_f32 v189, v141, v165, v189
  v_mul_f32 v182, v134, v166
  v_mul_f32 v190, v134, v174
  v_fma_f32 v182, -v142, v174, v182
  v_fma_f32 v190, v142, v166, v190
  v_mul_f32 v183, v135, v167
  v_mul_f32 v191, v135, v175
  v_fma_f32 v183, -v143, v175, v183
  v_fma_f32 v191, v143, v167, v191
  v_cvt_pk_bf16_f32 v192, v176, v177
  v_cvt_pk_bf16_f32 v196, v184, v185
  v_cvt_pk_bf16_f32 v193, v178, v179
  v_cvt_pk_bf16_f32 v197, v186, v187
  v_cvt_pk_bf16_f32 v194, v180, v181
  v_cvt_pk_bf16_f32 v198, v188, v189
  v_cvt_pk_bf16_f32 v195, v182, v183
  v_cvt_pk_bf16_f32 v199, v190, v191
  s_nop 1
  v_mfma_f32_16x16x32_bf16 v[144:147], v[192:195], v[64:67], 0
  v_mfma_f32_16x16x32_bf16 v[152:155], v[192:195], v[72:75], 0
  v_mfma_f32_16x16x32_bf16 v[148:151], v[192:195], v[68:71], 0
  v_mfma_f32_16x16x32_bf16 v[156:159], v[192:195], v[76:79], 0
  v_mfma_f32_16x16x32_bf16 v[144:147], v[196:199], v[80:83], v[144:147]
  v_mfma_f32_16x16x32_bf16 v[152:155], v[196:199], v[64:67], v[152:155]
  v_mfma_f32_16x16x32_bf16 v[148:151], v[196:199], v[84:87], v[148:151]
  v_mfma_f32_16x16x32_bf16 v[156:159], v[196:199], v[68:71], v[156:159]
  v_lshrrev_b32 v10, 1, v4
  v_lshrrev_b32 v11, 1, v5
  s_lshl_b32 s17, s3, 1
  v_add_u32 v11, s17, v11
  v_xor_b32 v11, v11, v10
  v_lshlrev_b32 v12, 7, v4
  v_add_u32 v12, 8192, v12
  v_lshl_add_u32 v11, v11, 4, v12
  v_and_b32 v13, 1, v5
  v_lshl_add_u32 v14, v13, 3, v11
  v_xor_b32 v10, v10, v5
  v_lshl_add_u32 v11, v10, 4, v12
  v_xor_b32 v12, 64, v11
  v_lshlrev_b32 v13, 6, v6
  v_lshl_add_u32 v13, v5, 3, v13
  v_mul_f32 v176, v144, v112
  v_mul_f32 v184, v144, v113
  v_fma_f32 v176, -v152, v113, v176
  v_fma_f32 v184, v152, v112, v184
  v_mul_f32 v177, v145, v114
  v_mul_f32 v185, v145, v115
  v_fma_f32 v177, -v153, v115, v177
  v_fma_f32 v185, v153, v114, v185
  v_mul_f32 v178, v146, v116
  v_mul_f32 v186, v146, v117
  v_fma_f32 v178, -v154, v117, v178
  v_fma_f32 v186, v154, v116, v186
  v_mul_f32 v179, v147, v118
  v_mul_f32 v187, v147, v119
  v_fma_f32 v179, -v155, v119, v179
  v_fma_f32 v187, v155, v118, v187
  v_mul_f32 v180, v148, v120
  v_mul_f32 v188, v148, v121
  v_fma_f32 v180, -v156, v121, v180
  v_fma_f32 v188, v156, v120, v188
  v_mul_f32 v181, v149, v122
  v_mul_f32 v189, v149, v123
  v_fma_f32 v181, -v157, v123, v181
  v_fma_f32 v189, v157, v122, v189
  v_mul_f32 v182, v150, v124
  v_mul_f32 v190, v150, v125
  v_fma_f32 v182, -v158, v125, v182
  v_fma_f32 v190, v158, v124, v190
  v_mul_f32 v183, v151, v126
  v_mul_f32 v191, v151, v127
  v_fma_f32 v183, -v159, v127, v183
  v_fma_f32 v191, v159, v126, v191
  v_cvt_pk_bf16_f32 v192, v176, v177
  v_cvt_pk_bf16_f32 v196, v184, v185
  v_cvt_pk_bf16_f32 v193, v178, v179
  v_cvt_pk_bf16_f32 v197, v186, v187
  v_cvt_pk_bf16_f32 v194, v180, v181
  v_cvt_pk_bf16_f32 v198, v188, v189
  v_cvt_pk_bf16_f32 v195, v182, v183
  v_cvt_pk_bf16_f32 v199, v190, v191
  ds_write_b64 v14, v[192:193] offset:0
  ds_write_b64 v14, v[196:197] offset:4096
  ds_write_b64 v14, v[194:195] offset:2048
  ds_write_b64 v14, v[198:199] offset:6144
  s_waitcnt lgkmcnt(0)
  s_barrier
  ds_read_b128 v[128:131], v11 offset:0
  ds_read_b128 v[132:135], v12 offset:0
  ds_read_b128 v[136:139], v11 offset:4096
  ds_read_b128 v[140:143], v12 offset:4096
  ds_read_b128 v[144:147], v11 offset:2048
  ds_read_b128 v[148:151], v12 offset:2048
  ds_read_b128 v[152:155], v11 offset:6144
  ds_read_b128 v[156:159], v12 offset:6144
  s_lshl_b32 s17, s14, 13
  s_cmp_eq_u32 s14, 224
  s_cselect_b32 s17, 4096, s17
  s_add_u32 s18, s17, 4096
  s_waitcnt lgkmcnt(4)
  v_mfma_f32_16x16x32_bf16 v[160:163], v[128:131], v[16:19], 0
  v_mfma_f32_16x16x32_bf16 v[168:171], v[128:131], v[24:27], 0
  v_mfma_f32_16x16x32_bf16 v[160:163], v[132:135], v[20:23], v[160:163]
  v_mfma_f32_16x16x32_bf16 v[168:171], v[132:135], v[28:31], v[168:171]
  v_mfma_f32_16x16x32_bf16 v[160:163], v[136:139], v[32:35], v[160:163]
  v_mfma_f32_16x16x32_bf16 v[168:171], v[136:139], v[16:19], v[168:171]
  v_mfma_f32_16x16x32_bf16 v[160:163], v[140:143], v[36:39], v[160:163]
  v_mfma_f32_16x16x32_bf16 v[168:171], v[140:143], v[20:23], v[168:171]
  s_waitcnt lgkmcnt(0)
  v_mfma_f32_16x16x32_bf16 v[164:167], v[144:147], v[16:19], 0
  v_mfma_f32_16x16x32_bf16 v[172:175], v[144:147], v[24:27], 0
  v_mfma_f32_16x16x32_bf16 v[164:167], v[148:151], v[20:23], v[164:167]
  v_mfma_f32_16x16x32_bf16 v[172:175], v[148:151], v[28:31], v[172:175]
  v_mfma_f32_16x16x32_bf16 v[164:167], v[152:155], v[32:35], v[164:167]
  v_mfma_f32_16x16x32_bf16 v[172:175], v[152:155], v[16:19], v[172:175]
  v_mfma_f32_16x16x32_bf16 v[164:167], v[156:159], v[36:39], v[164:167]
  v_mfma_f32_16x16x32_bf16 v[172:175], v[156:159], v[20:23], v[172:175]
  s_nop 7
  v_cvt_pk_bf16_f32 v192, v160, v161
  v_cvt_pk_bf16_f32 v193, v162, v163
  v_cvt_pk_bf16_f32 v194, v164, v165
  v_cvt_pk_bf16_f32 v195, v166, v167
  v_cvt_pk_bf16_f32 v196, v168, v169
  v_cvt_pk_bf16_f32 v197, v170, v171
  v_cvt_pk_bf16_f32 v198, v172, v173
  v_cvt_pk_bf16_f32 v199, v174, v175
  s_lshl_b32 s19, s3, 10
  v_add_u32 v10, 16384, v13
  v_add_u32 v11, s19, v3
  v_add_u32 v12, 16384, v11
  ds_write_b64 v10, v[192:193] offset:0
  ds_write_b64 v10, v[196:197] offset:4096
  ds_write_b64 v10, v[194:195] offset:32
  ds_write_b64 v10, v[198:199] offset:4128
  s_waitcnt lgkmcnt(0)
  ds_read_b128 v[128:131], v12
  ds_read_b128 v[132:135], v12 offset:4096
  s_waitcnt lgkmcnt(1)
  buffer_store_dwordx4 v[128:131], v11, s[36:39], s17 offen sc0 sc1
  s_cmp_eq_u32 s46, 1
  s_cbranch_scc1 fft_e
  s_waitcnt lgkmcnt(0)
  buffer_store_dwordx4 v[132:135], v11, s[36:39], s18 offen sc0 sc1
fft_e:
  s_waitcnt vmcnt(0)
  s_barrier
  s_cmp_lg_u32 s3, 0
  s_cbranch_scc1 fft_x
  s_lshl_b32 s15, s14, 6
  v_mov_b32 v1, s15
  v_mov_b32 v2, 1
  s_mov_b64 exec, 1
  buffer_store_dword v2, v1, s[40:43], 0 offen sc0 sc1
  s_waitcnt vmcnt(0)
  s_mov_b64 exec, -1
fft_x:
  s_endpgm
k2_end:
  s_endpgm
.section .rodata,"a"
.p2align 6
.amdhsa_kernel k1_kernel
  .amdhsa_next_free_vgpr 256
  .amdhsa_next_free_sgpr 64
  .amdhsa_accum_offset 256
  .amdhsa_group_segment_fixed_size 0
  .amdhsa_kernarg_size 72
  .amdhsa_user_sgpr_count 2
  .amdhsa_user_sgpr_kernarg_segment_ptr 1
  .amdhsa_system_sgpr_workgroup_id_x 1
.end_amdhsa_kernel
.p2align 6
.amdhsa_kernel k2_kernel
  .amdhsa_next_free_vgpr 248
  .amdhsa_next_free_sgpr 64
  .amdhsa_accum_offset 248
  .amdhsa_group_segment_fixed_size 0
  .amdhsa_kernarg_size 72
  .amdhsa_user_sgpr_count 2
  .amdhsa_user_sgpr_kernarg_segment_ptr 1
  .amdhsa_system_sgpr_workgroup_id_x 1
.end_amdhsa_kernel
.p2align 8
tabS:
.long 0x3f803f80,0x3f803f80,0x3f803f80,0x3f803f80,0x3f7f3f80,0x3f753f7b,0x3f623f6d,0x3f463f55
.long 0x3f7b3f80,0x3f553f6d,0x3f0e3f35,0x3e483ec4,0x3f753f80,0x3f223f55,0x3dc93ec4,0xbef1be48
.long 0x3f6d3f80,0x3ec43f35,0xbec40000,0xbf6dbf35,0x3f623f80,0x3dc93f0e,0xbf46bec4,0xbf75bf7b
.long 0x3f553f80,0xbe483ec4,0xbf7bbf35,0xbf0ebf6d,0x3f463f80,0xbef13e48,0xbf75bf6d,0x3dc9bf0e
.long 0x3f353f80,0xbf350000,0xbf35bf80,0x3f350000,0x3f223f80,0xbf62be48,0xbe95bf6d,0x3f7f3f0e
.long 0x3f0e3f80,0xbf7bbec4,0x3e48bf35,0x3f553f6d,0x3ef13f80,0xbf7fbf0e,0x3f22bec4,0x3e953f7b
.long 0x3ec43f80,0xbf6dbf35,0x3f6d0000,0xbec43f35,0x3e953f80,0xbf46bf55,0x3f7f3ec4,0xbf623e48
.long 0x3e483f80,0xbf0ebf6d,0x3f553f35,0xbf7bbec4,0x3dc93f80,0xbe95bf7b,0x3ef13f6d,0xbf22bf55
.long 0x3f803f80,0x3f803f80,0x3f803f80,0x3f803f80,0x3f223f35,0x3ef13f0e,0x3e953ec4,0x3dc93e48
.long 0xbe480000,0xbf0ebec4,0xbf55bf35,0xbf7bbf6d,0xbf62bf35,0xbf7fbf7b,0xbf46bf6d,0xbe95bf0e
.long 0xbf6dbf80,0xbec4bf35,0x3ec40000,0x3f6d3f35,0xbe95bf35,0x3f223e48,0x3f7f3f6d,0x3ef13f55
.long 0x3f0e0000,0x3f7b3f6d,0x3e483f35,0xbf55bec4,0x3f7f3f35,0x3e953f55,0xbf62bec4,0xbf22bf7b
.long 0x3f353f80,0xbf350000,0xbf35bf80,0x3f350000,0xbdc93f35,0xbf75bf55,0x3ef1bec4,0x3f463f7b
.long 0xbf550000,0xbe48bf6d,0x3f7b3f35,0xbf0e3ec4,0xbf75bf35,0x3f46be48,0x3dc93f6d,0xbf62bf55
.long 0xbec4bf80,0x3f6d3f35,0xbf6d0000,0x3ec4bf35,0x3ef1bf35,0x3dc93f7b,0xbf22bf6d,0x3f753f0e
.long 0x3f7b0000,0xbf553ec4,0x3f0ebf35,0xbe483f6d,0x3f463f35,0xbf62bf0e,0x3f753ec4,0xbf7fbe48
.long 0x3f803f80,0x3f803f80,0x3f803f80,0x3f803f80,0xbdc90000,0xbe95be48,0xbef1bec4,0xbf22bf0e
.long 0xbf7bbf80,0xbf55bf6d,0xbf0ebf35,0xbe48bec4,0x3e950000,0x3f463f0e,0x3f7f3f6d,0x3f623f7b
.long 0x3f6d3f80,0x3ec43f35,0xbec40000,0xbf6dbf35,0xbef10000,0xbf7fbf55,0xbf22bf6d,0x3e95be48
.long 0xbf55bf80,0x3e48bec4,0x3f7b3f35,0x3f0e3f6d,0x3f220000,0x3f623f7b,0xbe953ec4,0xbf7fbf55
.long 0x3f353f80,0xbf350000,0xbf35bf80,0x3f350000,0xbf460000,0xbef1bf7b,0x3f753ec4,0x3dc93f55
.long 0xbf0ebf80,0x3f7b3ec4,0xbe483f35,0xbf55bf6d,0x3f620000,0xbdc93f55,0xbf46bf6d,0x3f753e48
.long 0x3ec43f80,0xbf6dbf35,0x3f6d0000,0xbec43f35,0xbf750000,0x3f22bf0e,0xbdc93f6d,0xbef1bf7b
.long 0xbe48bf80,0x3f0e3f6d,0xbf55bf35,0x3f7b3ec4,0x3f7f0000,0xbf753e48,0x3f62bec4,0xbf463f0e
.long 0x3f803f80,0x3f803f80,0x3f803f80,0x3f803f80,0xbf46bf35,0xbf62bf55,0xbf75bf6d,0xbf7fbf7b
.long 0x3e480000,0x3f0e3ec4,0x3f553f35,0x3f7b3f6d,0x3ef13f35,0xbdc93e48,0xbf22bec4,0xbf75bf55
.long 0xbf6dbf80,0xbec4bf35,0x3ec40000,0x3f6d3f35,0x3f753f35,0x3f463f7b,0xbdc93ec4,0xbf62bf0e
.long 0xbf0e0000,0xbf7bbf6d,0xbe48bf35,0x3f553ec4,0xbdc9bf35,0x3f753f0e,0x3ef13f6d,0xbf46be48
.long 0x3f353f80,0xbf350000,0xbf35bf80,0x3f350000,0xbf7fbf35,0x3e95bf0e,0x3f623f6d,0xbf223e48
.long 0x3f550000,0x3e483f6d,0xbf7bbf35,0x3f0ebec4,0xbe953f35,0xbf22bf7b,0x3f7f3ec4,0xbef13f0e
.long 0xbec4bf80,0x3f6d3f35,0xbf6d0000,0x3ec4bf35,0x3f623f35,0xbf7fbe48,0x3f46bec4,0xbe953f55
.long 0xbf7b0000,0x3f55bec4,0xbf0e3f35,0x3e48bf6d,0x3f22bf35,0xbef13f55,0x3e95bf6d,0xbdc93f7b
.long 0x3f803f80,0x3f803f80,0x3f803f80,0x3f803f80,0xbf7fbf80,0xbf75bf7b,0xbf62bf6d,0xbf46bf55
.long 0x3f7b3f80,0x3f553f6d,0x3f0e3f35,0x3e483ec4,0xbf75bf80,0xbf22bf55,0xbdc9bec4,0x3ef13e48
.long 0x3f6d3f80,0x3ec43f35,0xbec40000,0xbf6dbf35,0xbf62bf80,0xbdc9bf0e,0x3f463ec4,0x3f753f7b
.long 0x3f553f80,0xbe483ec4,0xbf7bbf35,0xbf0ebf6d,0xbf46bf80,0x3ef1be48,0x3f753f6d,0xbdc93f0e
.long 0x3f353f80,0xbf350000,0xbf35bf80,0x3f350000,0xbf22bf80,0x3f623e48,0x3e953f6d,0xbf7fbf0e
.long 0x3f0e3f80,0xbf7bbec4,0x3e48bf35,0x3f553f6d,0xbef1bf80,0x3f7f3f0e,0xbf223ec4,0xbe95bf7b
.long 0x3ec43f80,0xbf6dbf35,0x3f6d0000,0xbec43f35,0xbe95bf80,0x3f463f55,0xbf7fbec4,0x3f62be48
.long 0x3e483f80,0xbf0ebf6d,0x3f553f35,0xbf7bbec4,0xbdc9bf80,0x3e953f7b,0xbef1bf6d,0x3f223f55
.long 0x3f803f80,0x3f803f80,0x3f803f80,0x3f803f80,0xbf22bf35,0xbef1bf0e,0xbe95bec4,0xbdc9be48
.long 0xbe480000,0xbf0ebec4,0xbf55bf35,0xbf7bbf6d,0x3f623f35,0x3f7f3f7b,0x3f463f6d,0x3e953f0e
.long 0xbf6dbf80,0xbec4bf35,0x3ec40000,0x3f6d3f35,0x3e953f35,0xbf22be48,0xbf7fbf6d,0xbef1bf55
.long 0x3f0e0000,0x3f7b3f6d,0x3e483f35,0xbf55bec4,0xbf7fbf35,0xbe95bf55,0x3f623ec4,0x3f223f7b
.long 0x3f353f80,0xbf350000,0xbf35bf80,0x3f350000,0x3dc9bf35,0x3f753f55,0xbef13ec4,0xbf46bf7b
.long 0xbf550000,0xbe48bf6d,0x3f7b3f35,0xbf0e3ec4,0x3f753f35,0xbf463e48,0xbdc9bf6d,0x3f623f55
.long 0xbec4bf80,0x3f6d3f35,0xbf6d0000,0x3ec4bf35,0xbef13f35,0xbdc9bf7b,0x3f223f6d,0xbf75bf0e
.long 0x3f7b0000,0xbf553ec4,0x3f0ebf35,0xbe483f6d,0xbf46bf35,0x3f623f0e,0xbf75bec4,0x3f7f3e48
.long 0x3f803f80,0x3f803f80,0x3f803f80,0x3f803f80,0x3dc90000,0x3e953e48,0x3ef13ec4,0x3f223f0e
.long 0xbf7bbf80,0xbf55bf6d,0xbf0ebf35,0xbe48bec4,0xbe950000,0xbf46bf0e,0xbf7fbf6d,0xbf62bf7b
.long 0x3f6d3f80,0x3ec43f35,0xbec40000,0xbf6dbf35,0x3ef10000,0x3f7f3f55,0x3f223f6d,0xbe953e48
.long 0xbf55bf80,0x3e48bec4,0x3f7b3f35,0x3f0e3f6d,0xbf220000,0xbf62bf7b,0x3e95bec4,0x3f7f3f55
.long 0x3f353f80,0xbf350000,0xbf35bf80,0x3f350000,0x3f460000,0x3ef13f7b,0xbf75bec4,0xbdc9bf55
.long 0xbf0ebf80,0x3f7b3ec4,0xbe483f35,0xbf55bf6d,0xbf620000,0x3dc9bf55,0x3f463f6d,0xbf75be48
.long 0x3ec43f80,0xbf6dbf35,0x3f6d0000,0xbec43f35,0x3f750000,0xbf223f0e,0x3dc9bf6d,0x3ef13f7b
.long 0xbe48bf80,0x3f0e3f6d,0xbf55bf35,0x3f7b3ec4,0xbf7f0000,0x3f75be48,0xbf623ec4,0x3f46bf0e
.long 0x3f803f80,0x3f803f80,0x3f803f80,0x3f803f80,0x3f463f35,0x3f623f55,0x3f753f6d,0x3f7f3f7b
.long 0x3e480000,0x3f0e3ec4,0x3f553f35,0x3f7b3f6d,0xbef1bf35,0x3dc9be48,0x3f223ec4,0x3f753f55
.long 0xbf6dbf80,0xbec4bf35,0x3ec40000,0x3f6d3f35,0xbf75bf35,0xbf46bf7b,0x3dc9bec4,0x3f623f0e
.long 0xbf0e0000,0xbf7bbf6d,0xbe48bf35,0x3f553ec4,0x3dc93f35,0xbf75bf0e,0xbef1bf6d,0x3f463e48
.long 0x3f353f80,0xbf350000,0xbf35bf80,0x3f350000,0x3f7f3f35,0xbe953f0e,0xbf62bf6d,0x3f22be48
.long 0x3f550000,0x3e483f6d,0xbf7bbf35,0x3f0ebec4,0x3e95bf35,0x3f223f7b,0xbf7fbec4,0x3ef1bf0e
.long 0xbec4bf80,0x3f6d3f35,0xbf6d0000,0x3ec4bf35,0xbf62bf35,0x3f7f3e48,0xbf463ec4,0x3e95bf55
.long 0xbf7b0000,0x3f55bec4,0xbf0e3f35,0x3e48bf6d,0xbf223f35,0x3ef1bf55,0xbe953f6d,0x3dc9bf7b
.long 0x0,0x0,0x0,0x0,0x3dc90000,0x3e953e48,0x3ef13ec4,0x3f223f0e
.long 0x3e480000,0x3f0e3ec4,0x3f553f35,0x3f7b3f6d,0x3e950000,0x3f463f0e,0x3f7f3f6d,0x3f623f7b
.long 0x3ec40000,0x3f6d3f35,0x3f6d3f80,0x3ec43f35,0x3ef10000,0x3f7f3f55,0x3f223f6d,0xbe953e48
.long 0x3f0e0000,0x3f7b3f6d,0x3e483f35,0xbf55bec4,0x3f220000,0x3f623f7b,0xbe953ec4,0xbf7fbf55
.long 0x3f350000,0x3f353f80,0xbf350000,0xbf35bf80,0x3f460000,0x3ef13f7b,0xbf75bec4,0xbdc9bf55
.long 0x3f550000,0x3e483f6d,0xbf7bbf35,0x3f0ebec4,0x3f620000,0xbdc93f55,0xbf46bf6d,0x3f753e48
.long 0x3f6d0000,0xbec43f35,0xbec4bf80,0x3f6d3f35,0x3f750000,0xbf223f0e,0x3dc9bf6d,0x3ef13f7b
.long 0x3f7b0000,0xbf553ec4,0x3f0ebf35,0xbe483f6d,0x3f7f0000,0xbf753e48,0x3f62bec4,0xbf463f0e
.long 0x0,0x0,0x0,0x0,0x3f463f35,0x3f623f55,0x3f753f6d,0x3f7f3f7b
.long 0x3f7b3f80,0x3f553f6d,0x3f0e3f35,0x3e483ec4,0x3ef13f35,0xbdc93e48,0xbf22bec4,0xbf75bf55
.long 0xbec40000,0xbf6dbf35,0xbf6dbf80,0xbec4bf35,0xbf75bf35,0xbf46bf7b,0x3dc9bec4,0x3f623f0e
.long 0xbf55bf80,0x3e48bec4,0x3f7b3f35,0x3f0e3f6d,0xbdc9bf35,0x3f753f0e,0x3ef13f6d,0xbf46be48
.long 0x3f350000,0x3f353f80,0xbf350000,0xbf35bf80,0x3f7f3f35,0xbe953f0e,0xbf62bf6d,0x3f22be48
.long 0x3f0e3f80,0xbf7bbec4,0x3e48bf35,0x3f553f6d,0xbe953f35,0xbf22bf7b,0x3f7f3ec4,0xbef13f0e
.long 0xbf6d0000,0x3ec4bf35,0x3ec43f80,0xbf6dbf35,0xbf62bf35,0x3f7f3e48,0xbf463ec4,0x3e95bf55
.long 0xbe48bf80,0x3f0e3f6d,0xbf55bf35,0x3f7b3ec4,0x3f22bf35,0xbef13f55,0x3e95bf6d,0xbdc93f7b
.long 0x0,0x0,0x0,0x0,0x3f7f3f80,0x3f753f7b,0x3f623f6d,0x3f463f55
.long 0xbe480000,0xbf0ebec4,0xbf55bf35,0xbf7bbf6d,0xbf75bf80,0xbf22bf55,0xbdc9bec4,0x3ef13e48
.long 0x3ec40000,0x3f6d3f35,0x3f6d3f80,0x3ec43f35,0x3f623f80,0x3dc93f0e,0xbf46bec4,0xbf75bf7b
.long 0xbf0e0000,0xbf7bbf6d,0xbe48bf35,0x3f553ec4,0xbf46bf80,0x3ef1be48,0x3f753f6d,0xbdc93f0e
.long 0x3f350000,0x3f353f80,0xbf350000,0xbf35bf80,0x3f223f80,0xbf62be48,0xbe95bf6d,0x3f7f3f0e
.long 0xbf550000,0xbe48bf6d,0x3f7b3f35,0xbf0e3ec4,0xbef1bf80,0x3f7f3f0e,0xbf223ec4,0xbe95bf7b
.long 0x3f6d0000,0xbec43f35,0xbec4bf80,0x3f6d3f35,0x3e953f80,0xbf46bf55,0x3f7f3ec4,0xbf623e48
.long 0xbf7b0000,0x3f55bec4,0xbf0e3f35,0x3e48bf6d,0xbdc9bf80,0x3e953f7b,0xbef1bf6d,0x3f223f55
.long 0x0,0x0,0x0,0x0,0x3f223f35,0x3ef13f0e,0x3e953ec4,0x3dc93e48
.long 0xbf7bbf80,0xbf55bf6d,0xbf0ebf35,0xbe48bec4,0x3f623f35,0x3f7f3f7b,0x3f463f6d,0x3e953f0e
.long 0xbec40000,0xbf6dbf35,0xbf6dbf80,0xbec4bf35,0xbe95bf35,0x3f223e48,0x3f7f3f6d,0x3ef13f55
.long 0x3f553f80,0xbe483ec4,0xbf7bbf35,0xbf0ebf6d,0xbf7fbf35,0xbe95bf55,0x3f623ec4,0x3f223f7b
.long 0x3f350000,0x3f353f80,0xbf350000,0xbf35bf80,0xbdc93f35,0xbf75bf55,0x3ef1bec4,0x3f463f7b
.long 0xbf0ebf80,0x3f7b3ec4,0xbe483f35,0xbf55bf6d,0x3f753f35,0xbf463e48,0xbdc9bf6d,0x3f623f55
.long 0xbf6d0000,0x3ec4bf35,0x3ec43f80,0xbf6dbf35,0x3ef1bf35,0x3dc93f7b,0xbf22bf6d,0x3f753f0e
.long 0x3e483f80,0xbf0ebf6d,0x3f553f35,0xbf7bbec4,0xbf46bf35,0x3f623f0e,0xbf75bec4,0x3f7f3e48
.long 0x0,0x0,0x0,0x0,0xbdc90000,0xbe95be48,0xbef1bec4,0xbf22bf0e
.long 0x3e480000,0x3f0e3ec4,0x3f553f35,0x3f7b3f6d,0xbe950000,0xbf46bf0e,0xbf7fbf6d,0xbf62bf7b
.long 0x3ec40000,0x3f6d3f35,0x3f6d3f80,0x3ec43f35,0xbef10000,0xbf7fbf55,0xbf22bf6d,0x3e95be48
.long 0x3f0e0000,0x3f7b3f6d,0x3e483f35,0xbf55bec4,0xbf220000,0xbf62bf7b,0x3e95bec4,0x3f7f3f55
.long 0x3f350000,0x3f353f80,0xbf350000,0xbf35bf80,0xbf460000,0xbef1bf7b,0x3f753ec4,0x3dc93f55
.long 0x3f550000,0x3e483f6d,0xbf7bbf35,0x3f0ebec4,0xbf620000,0x3dc9bf55,0x3f463f6d,0xbf75be48
.long 0x3f6d0000,0xbec43f35,0xbec4bf80,0x3f6d3f35,0xbf750000,0x3f22bf0e,0xbdc93f6d,0xbef1bf7b
.long 0x3f7b0000,0xbf553ec4,0x3f0ebf35,0xbe483f6d,0xbf7f0000,0x3f75be48,0xbf623ec4,0x3f46bf0e
.long 0x0,0x0,0x0,0x0,0xbf46bf35,0xbf62bf55,0xbf75bf6d,0xbf7fbf7b
.long 0x3f7b3f80,0x3f553f6d,0x3f0e3f35,0x3e483ec4,0xbef1bf35,0x3dc9be48,0x3f223ec4,0x3f753f55
.long 0xbec40000,0xbf6dbf35,0xbf6dbf80,0xbec4bf35,0x3f753f35,0x3f463f7b,0xbdc93ec4,0xbf62bf0e
.long 0xbf55bf80,0x3e48bec4,0x3f7b3f35,0x3f0e3f6d,0x3dc93f35,0xbf75bf0e,0xbef1bf6d,0x3f463e48
.long 0x3f350000,0x3f353f80,0xbf350000,0xbf35bf80,0xbf7fbf35,0x3e95bf0e,0x3f623f6d,0xbf223e48
.long 0x3f0e3f80,0xbf7bbec4,0x3e48bf35,0x3f553f6d,0x3e95bf35,0x3f223f7b,0xbf7fbec4,0x3ef1bf0e
.long 0xbf6d0000,0x3ec4bf35,0x3ec43f80,0xbf6dbf35,0x3f623f35,0xbf7fbe48,0x3f46bec4,0xbe953f55
.long 0xbe48bf80,0x3f0e3f6d,0xbf55bf35,0x3f7b3ec4,0xbf223f35,0x3ef1bf55,0xbe953f6d,0x3dc9bf7b
.long 0x0,0x0,0x0,0x0,0xbf7fbf80,0xbf75bf7b,0xbf62bf6d,0xbf46bf55
.long 0xbe480000,0xbf0ebec4,0xbf55bf35,0xbf7bbf6d,0x3f753f80,0x3f223f55,0x3dc93ec4,0xbef1be48
.long 0x3ec40000,0x3f6d3f35,0x3f6d3f80,0x3ec43f35,0xbf62bf80,0xbdc9bf0e,0x3f463ec4,0x3f753f7b
.long 0xbf0e0000,0xbf7bbf6d,0xbe48bf35,0x3f553ec4,0x3f463f80,0xbef13e48,0xbf75bf6d,0x3dc9bf0e
.long 0x3f350000,0x3f353f80,0xbf350000,0xbf35bf80,0xbf22bf80,0x3f623e48,0x3e953f6d,0xbf7fbf0e
.long 0xbf550000,0xbe48bf6d,0x3f7b3f35,0xbf0e3ec4,0x3ef13f80,0xbf7fbf0e,0x3f22bec4,0x3e953f7b
.long 0x3f6d0000,0xbec43f35,0xbec4bf80,0x3f6d3f35,0xbe95bf80,0x3f463f55,0xbf7fbec4,0x3f62be48
.long 0xbf7b0000,0x3f55bec4,0xbf0e3f35,0x3e48bf6d,0x3dc93f80,0xbe95bf7b,0x3ef13f6d,0xbf22bf55
.long 0x0,0x0,0x0,0x0,0xbf22bf35,0xbef1bf0e,0xbe95bec4,0xbdc9be48
.long 0xbf7bbf80,0xbf55bf6d,0xbf0ebf35,0xbe48bec4,0xbf62bf35,0xbf7fbf7b,0xbf46bf6d,0xbe95bf0e
.long 0xbec40000,0xbf6dbf35,0xbf6dbf80,0xbec4bf35,0x3e953f35,0xbf22be48,0xbf7fbf6d,0xbef1bf55
.long 0x3f553f80,0xbe483ec4,0xbf7bbf35,0xbf0ebf6d,0x3f7f3f35,0x3e953f55,0xbf62bec4,0xbf22bf7b
.long 0x3f350000,0x3f353f80,0xbf350000,0xbf35bf80,0x3dc9bf35,0x3f753f55,0xbef13ec4,0xbf46bf7b
.long 0xbf0ebf80,0x3f7b3ec4,0xbe483f35,0xbf55bf6d,0xbf75bf35,0x3f46be48,0x3dc93f6d,0xbf62bf55
.long 0xbf6d0000,0x3ec4bf35,0x3ec43f80,0xbf6dbf35,0xbef13f35,0xbdc9bf7b,0x3f223f6d,0xbf75bf0e
.long 0x3e483f80,0xbf0ebf6d,0x3f553f35,0xbf7bbec4,0x3f463f35,0xbf62bf0e,0x3f753ec4,0xbf7fbe48
.long 0x3f80,0xbf80,0x3f80,0xbf80,0xbdc93f80,0x3e95bf7b,0xbef13f6d,0x3f22bf55
.long 0xbe483f80,0x3f0ebf6d,0xbf553f35,0x3f7bbec4,0xbe953f80,0x3f46bf55,0xbf7f3ec4,0x3f623e48
.long 0xbec43f80,0x3f6dbf35,0xbf6d0000,0x3ec43f35,0xbef13f80,0x3f7fbf0e,0xbf22bec4,0xbe953f7b
.long 0xbf0e3f80,0x3f7bbec4,0xbe48bf35,0xbf553f6d,0xbf223f80,0x3f62be48,0x3e95bf6d,0xbf7f3f0e
.long 0xbf353f80,0x3f350000,0x3f35bf80,0xbf350000,0xbf463f80,0x3ef13e48,0x3f75bf6d,0xbdc9bf0e
.long 0xbf553f80,0x3e483ec4,0x3f7bbf35,0x3f0ebf6d,0xbf623f80,0xbdc93f0e,0x3f46bec4,0x3f75bf7b
.long 0xbf6d3f80,0xbec43f35,0x3ec40000,0x3f6dbf35,0xbf753f80,0xbf223f55,0xbdc93ec4,0x3ef1be48
.long 0xbf7b3f80,0xbf553f6d,0xbf0e3f35,0xbe483ec4,0xbf7f3f80,0xbf753f7b,0xbf623f6d,0xbf463f55
.long 0x3f80,0xbf80,0x3f80,0xbf80,0xbf463f35,0x3f62bf0e,0xbf753ec4,0x3f7fbe48
.long 0xbf7b0000,0x3f553ec4,0xbf0ebf35,0x3e483f6d,0xbef1bf35,0xbdc93f7b,0x3f22bf6d,0xbf753f0e
.long 0x3ec4bf80,0xbf6d3f35,0x3f6d0000,0xbec4bf35,0x3f75bf35,0xbf46be48,0xbdc93f6d,0x3f62bf55
.long 0x3f550000,0x3e48bf6d,0xbf7b3f35,0x3f0e3ec4,0x3dc93f35,0x3f75bf55,0xbef1bec4,0xbf463f7b
.long 0xbf353f80,0x3f350000,0x3f35bf80,0xbf350000,0xbf7f3f35,0xbe953f55,0x3f62bec4,0x3f22bf7b
.long 0xbf0e0000,0xbf7b3f6d,0xbe483f35,0x3f55bec4,0x3e95bf35,0xbf223e48,0xbf7f3f6d,0xbef13f55
.long 0x3f6dbf80,0x3ec4bf35,0xbec40000,0xbf6d3f35,0x3f62bf35,0x3f7fbf7b,0x3f46bf6d,0x3e95bf0e
.long 0x3e480000,0x3f0ebec4,0x3f55bf35,0x3f7bbf6d,0xbf223f35,0xbef13f0e,0xbe953ec4,0xbdc93e48
.long 0x3f80,0xbf80,0x3f80,0xbf80,0xbf7f0000,0x3f753e48,0xbf62bec4,0x3f463f0e
.long 0x3e48bf80,0xbf0e3f6d,0x3f55bf35,0xbf7b3ec4,0x3f750000,0xbf22bf0e,0x3dc93f6d,0x3ef1bf7b
.long 0xbec43f80,0x3f6dbf35,0xbf6d0000,0x3ec43f35,0xbf620000,0x3dc93f55,0x3f46bf6d,0xbf753e48
.long 0x3f0ebf80,0xbf7b3ec4,0x3e483f35,0x3f55bf6d,0x3f460000,0x3ef1bf7b,0xbf753ec4,0xbdc93f55
.long 0xbf353f80,0x3f350000,0x3f35bf80,0xbf350000,0xbf220000,0xbf623f7b,0x3e953ec4,0x3f7fbf55
.long 0x3f55bf80,0xbe48bec4,0xbf7b3f35,0xbf0e3f6d,0x3ef10000,0x3f7fbf55,0x3f22bf6d,0xbe95be48
.long 0xbf6d3f80,0xbec43f35,0x3ec40000,0x3f6dbf35,0xbe950000,0xbf463f0e,0xbf7f3f6d,0xbf623f7b
.long 0x3f7bbf80,0x3f55bf6d,0x3f0ebf35,0x3e48bec4,0x3dc90000,0x3e95be48,0x3ef1bec4,0x3f22bf0e
.long 0x3f80,0xbf80,0x3f80,0xbf80,0xbf22bf35,0x3ef13f55,0xbe95bf6d,0x3dc93f7b
.long 0x3f7b0000,0xbf55bec4,0x3f0e3f35,0xbe48bf6d,0xbf623f35,0x3f7fbe48,0xbf46bec4,0x3e953f55
.long 0x3ec4bf80,0xbf6d3f35,0x3f6d0000,0xbec4bf35,0x3e953f35,0x3f22bf7b,0xbf7f3ec4,0x3ef13f0e
.long 0xbf550000,0xbe483f6d,0x3f7bbf35,0xbf0ebec4,0x3f7fbf35,0xbe95bf0e,0xbf623f6d,0x3f223e48
.long 0xbf353f80,0x3f350000,0x3f35bf80,0xbf350000,0x3dc9bf35,0xbf753f0e,0xbef13f6d,0x3f46be48
.long 0x3f0e0000,0x3f7bbf6d,0x3e48bf35,0xbf553ec4,0xbf753f35,0xbf463f7b,0x3dc93ec4,0x3f62bf0e
.long 0x3f6dbf80,0x3ec4bf35,0xbec40000,0xbf6d3f35,0xbef13f35,0x3dc93e48,0x3f22bec4,0x3f75bf55
.long 0xbe480000,0xbf0e3ec4,0xbf553f35,0xbf7b3f6d,0x3f46bf35,0x3f62bf55,0x3f75bf6d,0x3f7fbf7b
.long 0x3f80,0xbf80,0x3f80,0xbf80,0x3dc9bf80,0xbe953f7b,0x3ef1bf6d,0xbf223f55
.long 0xbe483f80,0x3f0ebf6d,0xbf553f35,0x3f7bbec4,0x3e95bf80,0xbf463f55,0x3f7fbec4,0xbf62be48
.long 0xbec43f80,0x3f6dbf35,0xbf6d0000,0x3ec43f35,0x3ef1bf80,0xbf7f3f0e,0x3f223ec4,0x3e95bf7b
.long 0xbf0e3f80,0x3f7bbec4,0xbe48bf35,0xbf553f6d,0x3f22bf80,0xbf623e48,0xbe953f6d,0x3f7fbf0e
.long 0xbf353f80,0x3f350000,0x3f35bf80,0xbf350000,0x3f46bf80,0xbef1be48,0xbf753f6d,0x3dc93f0e
.long 0xbf553f80,0x3e483ec4,0x3f7bbf35,0x3f0ebf6d,0x3f62bf80,0x3dc9bf0e,0xbf463ec4,0xbf753f7b
.long 0xbf6d3f80,0xbec43f35,0x3ec40000,0x3f6dbf35,0x3f75bf80,0x3f22bf55,0x3dc9bec4,0xbef13e48
.long 0xbf7b3f80,0xbf553f6d,0xbf0e3f35,0xbe483ec4,0x3f7fbf80,0x3f75bf7b,0x3f62bf6d,0x3f46bf55
.long 0x3f80,0xbf80,0x3f80,0xbf80,0x3f46bf35,0xbf623f0e,0x3f75bec4,0xbf7f3e48
.long 0xbf7b0000,0x3f553ec4,0xbf0ebf35,0x3e483f6d,0x3ef13f35,0x3dc9bf7b,0xbf223f6d,0x3f75bf0e
.long 0x3ec4bf80,0xbf6d3f35,0x3f6d0000,0xbec4bf35,0xbf753f35,0x3f463e48,0x3dc9bf6d,0xbf623f55
.long 0x3f550000,0x3e48bf6d,0xbf7b3f35,0x3f0e3ec4,0xbdc9bf35,0xbf753f55,0x3ef13ec4,0x3f46bf7b
.long 0xbf353f80,0x3f350000,0x3f35bf80,0xbf350000,0x3f7fbf35,0x3e95bf55,0xbf623ec4,0xbf223f7b
.long 0xbf0e0000,0xbf7b3f6d,0xbe483f35,0x3f55bec4,0xbe953f35,0x3f22be48,0x3f7fbf6d,0x3ef1bf55
.long 0x3f6dbf80,0x3ec4bf35,0xbec40000,0xbf6d3f35,0xbf623f35,0xbf7f3f7b,0xbf463f6d,0xbe953f0e
.long 0x3e480000,0x3f0ebec4,0x3f55bf35,0x3f7bbf6d,0x3f22bf35,0x3ef1bf0e,0x3e95bec4,0x3dc9be48
.long 0x3f80,0xbf80,0x3f80,0xbf80,0x3f7f0000,0xbf75be48,0x3f623ec4,0xbf46bf0e
.long 0x3e48bf80,0xbf0e3f6d,0x3f55bf35,0xbf7b3ec4,0xbf750000,0x3f223f0e,0xbdc9bf6d,0xbef13f7b
.long 0xbec43f80,0x3f6dbf35,0xbf6d0000,0x3ec43f35,0x3f620000,0xbdc9bf55,0xbf463f6d,0x3f75be48
.long 0x3f0ebf80,0xbf7b3ec4,0x3e483f35,0x3f55bf6d,0xbf460000,0xbef13f7b,0x3f75bec4,0x3dc9bf55
.long 0xbf353f80,0x3f350000,0x3f35bf80,0xbf350000,0x3f220000,0x3f62bf7b,0xbe95bec4,0xbf7f3f55
.long 0x3f55bf80,0xbe48bec4,0xbf7b3f35,0xbf0e3f6d,0xbef10000,0xbf7f3f55,0xbf223f6d,0x3e953e48
.long 0xbf6d3f80,0xbec43f35,0x3ec40000,0x3f6dbf35,0x3e950000,0x3f46bf0e,0x3f7fbf6d,0x3f62bf7b
.long 0x3f7bbf80,0x3f55bf6d,0x3f0ebf35,0x3e48bec4,0xbdc90000,0xbe953e48,0xbef13ec4,0xbf223f0e
.long 0x3f80,0xbf80,0x3f80,0xbf80,0x3f223f35,0xbef1bf55,0x3e953f6d,0xbdc9bf7b
.long 0x3f7b0000,0xbf55bec4,0x3f0e3f35,0xbe48bf6d,0x3f62bf35,0xbf7f3e48,0x3f463ec4,0xbe95bf55
.long 0x3ec4bf80,0xbf6d3f35,0x3f6d0000,0xbec4bf35,0xbe95bf35,0xbf223f7b,0x3f7fbec4,0xbef1bf0e
.long 0xbf550000,0xbe483f6d,0x3f7bbf35,0xbf0ebec4,0xbf7f3f35,0x3e953f0e,0x3f62bf6d,0xbf22be48
.long 0xbf353f80,0x3f350000,0x3f35bf80,0xbf350000,0xbdc93f35,0x3f75bf0e,0x3ef1bf6d,0xbf463e48
.long 0x3f0e0000,0x3f7bbf6d,0x3e48bf35,0xbf553ec4,0x3f75bf35,0x3f46bf7b,0xbdc9bec4,0xbf623f0e
.long 0x3f6dbf80,0x3ec4bf35,0xbec40000,0xbf6d3f35,0x3ef1bf35,0xbdc9be48,0xbf223ec4,0xbf753f55
.long 0xbe480000,0xbf0e3ec4,0xbf553f35,0xbf7b3f6d,0xbf463f35,0xbf623f55,0xbf753f6d,0xbf7f3f7b
.long 0x3f800000,0xbf800000,0x3f800000,0xbf800000,0x3f7f0000,0xbf75be48,0x3f623ec4,0xbf46bf0e
.long 0x3f7b0000,0xbf55bec4,0x3f0e3f35,0xbe48bf6d,0x3f750000,0xbf22bf0e,0x3dc93f6d,0x3ef1bf7b
.long 0x3f6d0000,0xbec4bf35,0xbec43f80,0x3f6dbf35,0x3f620000,0xbdc9bf55,0xbf463f6d,0x3f75be48
.long 0x3f550000,0x3e48bf6d,0xbf7b3f35,0x3f0e3ec4,0x3f460000,0x3ef1bf7b,0xbf753ec4,0xbdc93f55
.long 0x3f350000,0x3f35bf80,0xbf350000,0xbf353f80,0x3f220000,0x3f62bf7b,0xbe95bec4,0xbf7f3f55
.long 0x3f0e0000,0x3f7bbf6d,0x3e48bf35,0xbf553ec4,0x3ef10000,0x3f7fbf55,0x3f22bf6d,0xbe95be48
.long 0x3ec40000,0x3f6dbf35,0x3f6dbf80,0x3ec4bf35,0x3e950000,0x3f46bf0e,0x3f7fbf6d,0x3f62bf7b
.long 0x3e480000,0x3f0ebec4,0x3f55bf35,0x3f7bbf6d,0x3dc90000,0x3e95be48,0x3ef1bec4,0x3f22bf0e
.long 0x3f800000,0xbf800000,0x3f800000,0xbf800000,0x3f223f35,0xbef1bf55,0x3e953f6d,0xbdc9bf7b
.long 0xbe483f80,0x3f0ebf6d,0xbf553f35,0x3f7bbec4,0xbf623f35,0x3f7fbe48,0xbf46bec4,0x3e953f55
.long 0xbf6d0000,0x3ec43f35,0x3ec4bf80,0xbf6d3f35,0xbe95bf35,0xbf223f7b,0x3f7fbec4,0xbef1bf0e
.long 0x3f0ebf80,0xbf7b3ec4,0x3e483f35,0x3f55bf6d,0x3f7fbf35,0xbe95bf0e,0xbf623f6d,0x3f223e48
.long 0x3f350000,0x3f35bf80,0xbf350000,0xbf353f80,0xbdc93f35,0x3f75bf0e,0x3ef1bf6d,0xbf463e48
.long 0xbf553f80,0x3e483ec4,0x3f7bbf35,0x3f0ebf6d,0xbf753f35,0xbf463f7b,0x3dc93ec4,0x3f62bf0e
.long 0xbec40000,0xbf6d3f35,0xbf6d3f80,0xbec43f35,0x3ef1bf35,0xbdc9be48,0xbf223ec4,0xbf753f55
.long 0x3f7bbf80,0x3f55bf6d,0x3f0ebf35,0x3e48bec4,0x3f46bf35,0x3f62bf55,0x3f75bf6d,0x3f7fbf7b
.long 0x3f800000,0xbf800000,0x3f800000,0xbf800000,0xbdc93f80,0x3e95bf7b,0xbef13f6d,0x3f22bf55
.long 0xbf7b0000,0x3f553ec4,0xbf0ebf35,0x3e483f6d,0x3e95bf80,0xbf463f55,0x3f7fbec4,0xbf62be48
.long 0x3f6d0000,0xbec4bf35,0xbec43f80,0x3f6dbf35,0xbef13f80,0x3f7fbf0e,0xbf22bec4,0xbe953f7b
.long 0xbf550000,0xbe483f6d,0x3f7bbf35,0xbf0ebec4,0x3f22bf80,0xbf623e48,0xbe953f6d,0x3f7fbf0e
.long 0x3f350000,0x3f35bf80,0xbf350000,0xbf353f80,0xbf463f80,0x3ef13e48,0x3f75bf6d,0xbdc9bf0e
.long 0xbf0e0000,0xbf7b3f6d,0xbe483f35,0x3f55bec4,0x3f62bf80,0x3dc9bf0e,0xbf463ec4,0xbf753f7b
.long 0x3ec40000,0x3f6dbf35,0x3f6dbf80,0x3ec4bf35,0xbf753f80,0xbf223f55,0xbdc93ec4,0x3ef1be48
.long 0xbe480000,0xbf0e3ec4,0xbf553f35,0xbf7b3f6d,0x3f7fbf80,0x3f75bf7b,0x3f62bf6d,0x3f46bf55
.long 0x3f800000,0xbf800000,0x3f800000,0xbf800000,0xbf463f35,0x3f62bf0e,0xbf753ec4,0x3f7fbe48
.long 0x3e48bf80,0xbf0e3f6d,0x3f55bf35,0xbf7b3ec4,0x3ef13f35,0x3dc9bf7b,0xbf223f6d,0x3f75bf0e
.long 0xbf6d0000,0x3ec43f35,0x3ec4bf80,0xbf6d3f35,0x3f75bf35,0xbf46be48,0xbdc93f6d,0x3f62bf55
.long 0xbf0e3f80,0x3f7bbec4,0xbe48bf35,0xbf553f6d,0xbdc9bf35,0xbf753f55,0x3ef13ec4,0x3f46bf7b
.long 0x3f350000,0x3f35bf80,0xbf350000,0xbf353f80,0xbf7f3f35,0xbe953f55,0x3f62bec4,0x3f22bf7b
.long 0x3f55bf80,0xbe48bec4,0xbf7b3f35,0xbf0e3f6d,0xbe953f35,0x3f22be48,0x3f7fbf6d,0x3ef1bf55
.long 0xbec40000,0xbf6d3f35,0xbf6d3f80,0xbec43f35,0x3f62bf35,0x3f7fbf7b,0x3f46bf6d,0x3e95bf0e
.long 0xbf7b3f80,0xbf553f6d,0xbf0e3f35,0xbe483ec4,0x3f22bf35,0x3ef1bf0e,0x3e95bec4,0x3dc9be48
.long 0x3f800000,0xbf800000,0x3f800000,0xbf800000,0xbf7f0000,0x3f753e48,0xbf62bec4,0x3f463f0e
.long 0x3f7b0000,0xbf55bec4,0x3f0e3f35,0xbe48bf6d,0xbf750000,0x3f223f0e,0xbdc9bf6d,0xbef13f7b
.long 0x3f6d0000,0xbec4bf35,0xbec43f80,0x3f6dbf35,0xbf620000,0x3dc93f55,0x3f46bf6d,0xbf753e48
.long 0x3f550000,0x3e48bf6d,0xbf7b3f35,0x3f0e3ec4,0xbf460000,0xbef13f7b,0x3f75bec4,0x3dc9bf55
.long 0x3f350000,0x3f35bf80,0xbf350000,0xbf353f80,0xbf220000,0xbf623f7b,0x3e953ec4,0x3f7fbf55
.long 0x3f0e0000,0x3f7bbf6d,0x3e48bf35,0xbf553ec4,0xbef10000,0xbf7f3f55,0xbf223f6d,0x3e953e48
.long 0x3ec40000,0x3f6dbf35,0x3f6dbf80,0x3ec4bf35,0xbe950000,0xbf463f0e,0xbf7f3f6d,0xbf623f7b
.long 0x3e480000,0x3f0ebec4,0x3f55bf35,0x3f7bbf6d,0xbdc90000,0xbe953e48,0xbef13ec4,0xbf223f0e
.long 0x3f800000,0xbf800000,0x3f800000,0xbf800000,0xbf22bf35,0x3ef13f55,0xbe95bf6d,0x3dc93f7b
.long 0xbe483f80,0x3f0ebf6d,0xbf553f35,0x3f7bbec4,0x3f62bf35,0xbf7f3e48,0x3f463ec4,0xbe95bf55
.long 0xbf6d0000,0x3ec43f35,0x3ec4bf80,0xbf6d3f35,0x3e953f35,0x3f22bf7b,0xbf7f3ec4,0x3ef13f0e
.long 0x3f0ebf80,0xbf7b3ec4,0x3e483f35,0x3f55bf6d,0xbf7f3f35,0x3e953f0e,0x3f62bf6d,0xbf22be48
.long 0x3f350000,0x3f35bf80,0xbf350000,0xbf353f80,0x3dc9bf35,0xbf753f0e,0xbef13f6d,0x3f46be48
.long 0xbf553f80,0x3e483ec4,0x3f7bbf35,0x3f0ebf6d,0x3f75bf35,0x3f46bf7b,0xbdc9bec4,0xbf623f0e
.long 0xbec40000,0xbf6d3f35,0xbf6d3f80,0xbec43f35,0xbef13f35,0x3dc93e48,0x3f22bec4,0x3f75bf55
.long 0x3f7bbf80,0x3f55bf6d,0x3f0ebf35,0x3e48bec4,0xbf463f35,0xbf623f55,0xbf753f6d,0xbf7f3f7b
.long 0x3f800000,0xbf800000,0x3f800000,0xbf800000,0x3dc9bf80,0xbe953f7b,0x3ef1bf6d,0xbf223f55
.long 0xbf7b0000,0x3f553ec4,0xbf0ebf35,0x3e483f6d,0xbe953f80,0x3f46bf55,0xbf7f3ec4,0x3f623e48
.long 0x3f6d0000,0xbec4bf35,0xbec43f80,0x3f6dbf35,0x3ef1bf80,0xbf7f3f0e,0x3f223ec4,0x3e95bf7b
.long 0xbf550000,0xbe483f6d,0x3f7bbf35,0xbf0ebec4,0xbf223f80,0x3f62be48,0x3e95bf6d,0xbf7f3f0e
.long 0x3f350000,0x3f35bf80,0xbf350000,0xbf353f80,0x3f46bf80,0xbef1be48,0xbf753f6d,0x3dc93f0e
.long 0xbf0e0000,0xbf7b3f6d,0xbe483f35,0x3f55bec4,0xbf623f80,0xbdc93f0e,0x3f46bec4,0x3f75bf7b
.long 0x3ec40000,0x3f6dbf35,0x3f6dbf80,0x3ec4bf35,0x3f75bf80,0x3f22bf55,0x3dc9bec4,0xbef13e48
.long 0xbe480000,0xbf0e3ec4,0xbf553f35,0xbf7b3f6d,0xbf7f3f80,0xbf753f7b,0xbf623f6d,0xbf463f55
.long 0x3f800000,0xbf800000,0x3f800000,0xbf800000,0x3f46bf35,0xbf623f0e,0x3f75bec4,0xbf7f3e48
.long 0x3e48bf80,0xbf0e3f6d,0x3f55bf35,0xbf7b3ec4,0xbef1bf35,0xbdc93f7b,0x3f22bf6d,0xbf753f0e
.long 0xbf6d0000,0x3ec43f35,0x3ec4bf80,0xbf6d3f35,0xbf753f35,0x3f463e48,0x3dc9bf6d,0xbf623f55
.long 0xbf0e3f80,0x3f7bbec4,0xbe48bf35,0xbf553f6d,0x3dc93f35,0x3f75bf55,0xbef1bec4,0xbf463f7b
.long 0x3f350000,0x3f35bf80,0xbf350000,0xbf353f80,0x3f7fbf35,0x3e95bf55,0xbf623ec4,0xbf223f7b
.long 0x3f55bf80,0xbe48bec4,0xbf7b3f35,0xbf0e3f6d,0x3e95bf35,0xbf223e48,0xbf7f3f6d,0xbef13f55
.long 0xbec40000,0xbf6d3f35,0xbf6d3f80,0xbec43f35,0xbf623f35,0xbf7f3f7b,0xbf463f6d,0xbe953f0e
.long 0xbf7b3f80,0xbf553f6d,0xbf0e3f35,0xbe483ec4,0xbf223f35,0xbef13f0e,0xbe953ec4,0xbdc93e48
.long 0xbf803f80,0xbf803f80,0xbf803f80,0xbf803f80,0xbf7f3f80,0xbf753f7b,0xbf623f6d,0xbf463f55
.long 0xbf7b3f80,0xbf553f6d,0xbf0e3f35,0xbe483ec4,0xbf753f80,0xbf223f55,0xbdc93ec4,0x3ef1be48
.long 0xbf6d3f80,0xbec43f35,0x3ec40000,0x3f6dbf35,0xbf623f80,0xbdc93f0e,0x3f46bec4,0x3f75bf7b
.long 0xbf553f80,0x3e483ec4,0x3f7bbf35,0x3f0ebf6d,0xbf463f80,0x3ef13e48,0x3f75bf6d,0xbdc9bf0e
.long 0xbf353f80,0x3f350000,0x3f35bf80,0xbf350000,0xbf223f80,0x3f62be48,0x3e95bf6d,0xbf7f3f0e
.long 0xbf0e3f80,0x3f7bbec4,0xbe48bf35,0xbf553f6d,0xbef13f80,0x3f7fbf0e,0xbf22bec4,0xbe953f7b
.long 0xbec43f80,0x3f6dbf35,0xbf6d0000,0x3ec43f35,0xbe953f80,0x3f46bf55,0xbf7f3ec4,0x3f623e48
.long 0xbe483f80,0x3f0ebf6d,0xbf553f35,0x3f7bbec4,0xbdc93f80,0x3e95bf7b,0xbef13f6d,0x3f22bf55
.long 0xbf803f80,0xbf803f80,0xbf803f80,0xbf803f80,0xbf223f35,0xbef13f0e,0xbe953ec4,0xbdc93e48
.long 0x3e480000,0x3f0ebec4,0x3f55bf35,0x3f7bbf6d,0x3f62bf35,0x3f7fbf7b,0x3f46bf6d,0x3e95bf0e
.long 0x3f6dbf80,0x3ec4bf35,0xbec40000,0xbf6d3f35,0x3e95bf35,0xbf223e48,0xbf7f3f6d,0xbef13f55
.long 0xbf0e0000,0xbf7b3f6d,0xbe483f35,0x3f55bec4,0xbf7f3f35,0xbe953f55,0x3f62bec4,0x3f22bf7b
.long 0xbf353f80,0x3f350000,0x3f35bf80,0xbf350000,0x3dc93f35,0x3f75bf55,0xbef1bec4,0xbf463f7b
.long 0x3f550000,0x3e48bf6d,0xbf7b3f35,0x3f0e3ec4,0x3f75bf35,0xbf46be48,0xbdc93f6d,0x3f62bf55
.long 0x3ec4bf80,0xbf6d3f35,0x3f6d0000,0xbec4bf35,0xbef1bf35,0xbdc93f7b,0x3f22bf6d,0xbf753f0e
.long 0xbf7b0000,0x3f553ec4,0xbf0ebf35,0x3e483f6d,0xbf463f35,0x3f62bf0e,0xbf753ec4,0x3f7fbe48
.long 0xbf803f80,0xbf803f80,0xbf803f80,0xbf803f80,0x3dc90000,0x3e95be48,0x3ef1bec4,0x3f22bf0e
.long 0x3f7bbf80,0x3f55bf6d,0x3f0ebf35,0x3e48bec4,0xbe950000,0xbf463f0e,0xbf7f3f6d,0xbf623f7b
.long 0xbf6d3f80,0xbec43f35,0x3ec40000,0x3f6dbf35,0x3ef10000,0x3f7fbf55,0x3f22bf6d,0xbe95be48
.long 0x3f55bf80,0xbe48bec4,0xbf7b3f35,0xbf0e3f6d,0xbf220000,0xbf623f7b,0x3e953ec4,0x3f7fbf55
.long 0xbf353f80,0x3f350000,0x3f35bf80,0xbf350000,0x3f460000,0x3ef1bf7b,0xbf753ec4,0xbdc93f55
.long 0x3f0ebf80,0xbf7b3ec4,0x3e483f35,0x3f55bf6d,0xbf620000,0x3dc93f55,0x3f46bf6d,0xbf753e48
.long 0xbec43f80,0x3f6dbf35,0xbf6d0000,0x3ec43f35,0x3f750000,0xbf22bf0e,0x3dc93f6d,0x3ef1bf7b
.long 0x3e48bf80,0xbf0e3f6d,0x3f55bf35,0xbf7b3ec4,0xbf7f0000,0x3f753e48,0xbf62bec4,0x3f463f0e
.long 0xbf803f80,0xbf803f80,0xbf803f80,0xbf803f80,0x3f46bf35,0x3f62bf55,0x3f75bf6d,0x3f7fbf7b
.long 0xbe480000,0xbf0e3ec4,0xbf553f35,0xbf7b3f6d,0xbef13f35,0x3dc93e48,0x3f22bec4,0x3f75bf55
.long 0x3f6dbf80,0x3ec4bf35,0xbec40000,0xbf6d3f35,0xbf753f35,0xbf463f7b,0x3dc93ec4,0x3f62bf0e
.long 0x3f0e0000,0x3f7bbf6d,0x3e48bf35,0xbf553ec4,0x3dc9bf35,0xbf753f0e,0xbef13f6d,0x3f46be48
.long 0xbf353f80,0x3f350000,0x3f35bf80,0xbf350000,0x3f7fbf35,0xbe95bf0e,0xbf623f6d,0x3f223e48
.long 0xbf550000,0xbe483f6d,0x3f7bbf35,0xbf0ebec4,0x3e953f35,0x3f22bf7b,0xbf7f3ec4,0x3ef13f0e
.long 0x3ec4bf80,0xbf6d3f35,0x3f6d0000,0xbec4bf35,0xbf623f35,0x3f7fbe48,0xbf46bec4,0x3e953f55
.long 0x3f7b0000,0xbf55bec4,0x3f0e3f35,0xbe48bf6d,0xbf22bf35,0x3ef13f55,0xbe95bf6d,0x3dc93f7b
.long 0xbf803f80,0xbf803f80,0xbf803f80,0xbf803f80,0x3f7fbf80,0x3f75bf7b,0x3f62bf6d,0x3f46bf55
.long 0xbf7b3f80,0xbf553f6d,0xbf0e3f35,0xbe483ec4,0x3f75bf80,0x3f22bf55,0x3dc9bec4,0xbef13e48
.long 0xbf6d3f80,0xbec43f35,0x3ec40000,0x3f6dbf35,0x3f62bf80,0x3dc9bf0e,0xbf463ec4,0xbf753f7b
.long 0xbf553f80,0x3e483ec4,0x3f7bbf35,0x3f0ebf6d,0x3f46bf80,0xbef1be48,0xbf753f6d,0x3dc93f0e
.long 0xbf353f80,0x3f350000,0x3f35bf80,0xbf350000,0x3f22bf80,0xbf623e48,0xbe953f6d,0x3f7fbf0e
.long 0xbf0e3f80,0x3f7bbec4,0xbe48bf35,0xbf553f6d,0x3ef1bf80,0xbf7f3f0e,0x3f223ec4,0x3e95bf7b
.long 0xbec43f80,0x3f6dbf35,0xbf6d0000,0x3ec43f35,0x3e95bf80,0xbf463f55,0x3f7fbec4,0xbf62be48
.long 0xbe483f80,0x3f0ebf6d,0xbf553f35,0x3f7bbec4,0x3dc9bf80,0xbe953f7b,0x3ef1bf6d,0xbf223f55
.long 0xbf803f80,0xbf803f80,0xbf803f80,0xbf803f80,0x3f22bf35,0x3ef1bf0e,0x3e95bec4,0x3dc9be48
.long 0x3e480000,0x3f0ebec4,0x3f55bf35,0x3f7bbf6d,0xbf623f35,0xbf7f3f7b,0xbf463f6d,0xbe953f0e
.long 0x3f6dbf80,0x3ec4bf35,0xbec40000,0xbf6d3f35,0xbe953f35,0x3f22be48,0x3f7fbf6d,0x3ef1bf55
.long 0xbf0e0000,0xbf7b3f6d,0xbe483f35,0x3f55bec4,0x3f7fbf35,0x3e95bf55,0xbf623ec4,0xbf223f7b
.long 0xbf353f80,0x3f350000,0x3f35bf80,0xbf350000,0xbdc9bf35,0xbf753f55,0x3ef13ec4,0x3f46bf7b
.long 0x3f550000,0x3e48bf6d,0xbf7b3f35,0x3f0e3ec4,0xbf753f35,0x3f463e48,0x3dc9bf6d,0xbf623f55
.long 0x3ec4bf80,0xbf6d3f35,0x3f6d0000,0xbec4bf35,0x3ef13f35,0x3dc9bf7b,0xbf223f6d,0x3f75bf0e
.long 0xbf7b0000,0x3f553ec4,0xbf0ebf35,0x3e483f6d,0x3f46bf35,0xbf623f0e,0x3f75bec4,0xbf7f3e48
.long 0xbf803f80,0xbf803f80,0xbf803f80,0xbf803f80,0xbdc90000,0xbe953e48,0xbef13ec4,0xbf223f0e
.long 0x3f7bbf80,0x3f55bf6d,0x3f0ebf35,0x3e48bec4,0x3e950000,0x3f46bf0e,0x3f7fbf6d,0x3f62bf7b
.long 0xbf6d3f80,0xbec43f35,0x3ec40000,0x3f6dbf35,0xbef10000,0xbf7f3f55,0xbf223f6d,0x3e953e48
.long 0x3f55bf80,0xbe48bec4,0xbf7b3f35,0xbf0e3f6d,0x3f220000,0x3f62bf7b,0xbe95bec4,0xbf7f3f55
.long 0xbf353f80,0x3f350000,0x3f35bf80,0xbf350000,0xbf460000,0xbef13f7b,0x3f75bec4,0x3dc9bf55
.long 0x3f0ebf80,0xbf7b3ec4,0x3e483f35,0x3f55bf6d,0x3f620000,0xbdc9bf55,0xbf463f6d,0x3f75be48
.long 0xbec43f80,0x3f6dbf35,0xbf6d0000,0x3ec43f35,0xbf750000,0x3f223f0e,0xbdc9bf6d,0xbef13f7b
.long 0x3e48bf80,0xbf0e3f6d,0x3f55bf35,0xbf7b3ec4,0x3f7f0000,0xbf75be48,0x3f623ec4,0xbf46bf0e
.long 0xbf803f80,0xbf803f80,0xbf803f80,0xbf803f80,0xbf463f35,0xbf623f55,0xbf753f6d,0xbf7f3f7b
.long 0xbe480000,0xbf0e3ec4,0xbf553f35,0xbf7b3f6d,0x3ef1bf35,0xbdc9be48,0xbf223ec4,0xbf753f55
.long 0x3f6dbf80,0x3ec4bf35,0xbec40000,0xbf6d3f35,0x3f75bf35,0x3f46bf7b,0xbdc9bec4,0xbf623f0e
.long 0x3f0e0000,0x3f7bbf6d,0x3e48bf35,0xbf553ec4,0xbdc93f35,0x3f75bf0e,0x3ef1bf6d,0xbf463e48
.long 0xbf353f80,0x3f350000,0x3f35bf80,0xbf350000,0xbf7f3f35,0x3e953f0e,0x3f62bf6d,0xbf22be48
.long 0xbf550000,0xbe483f6d,0x3f7bbf35,0xbf0ebec4,0xbe95bf35,0xbf223f7b,0x3f7fbec4,0xbef1bf0e
.long 0x3ec4bf80,0xbf6d3f35,0x3f6d0000,0xbec4bf35,0x3f62bf35,0xbf7f3e48,0x3f463ec4,0xbe95bf55
.long 0x3f7b0000,0xbf55bec4,0x3f0e3f35,0xbe48bf6d,0x3f223f35,0xbef1bf55,0x3e953f6d,0xbdc9bf7b
.long 0x0,0x0,0x0,0x0,0xbdc90000,0xbe953e48,0xbef13ec4,0xbf223f0e
.long 0xbe480000,0xbf0e3ec4,0xbf553f35,0xbf7b3f6d,0xbe950000,0xbf463f0e,0xbf7f3f6d,0xbf623f7b
.long 0xbec40000,0xbf6d3f35,0xbf6d3f80,0xbec43f35,0xbef10000,0xbf7f3f55,0xbf223f6d,0x3e953e48
.long 0xbf0e0000,0xbf7b3f6d,0xbe483f35,0x3f55bec4,0xbf220000,0xbf623f7b,0x3e953ec4,0x3f7fbf55
.long 0xbf350000,0xbf353f80,0x3f350000,0x3f35bf80,0xbf460000,0xbef13f7b,0x3f75bec4,0x3dc9bf55
.long 0xbf550000,0xbe483f6d,0x3f7bbf35,0xbf0ebec4,0xbf620000,0x3dc93f55,0x3f46bf6d,0xbf753e48
.long 0xbf6d0000,0x3ec43f35,0x3ec4bf80,0xbf6d3f35,0xbf750000,0x3f223f0e,0xbdc9bf6d,0xbef13f7b
.long 0xbf7b0000,0x3f553ec4,0xbf0ebf35,0x3e483f6d,0xbf7f0000,0x3f753e48,0xbf62bec4,0x3f463f0e
.long 0x0,0x0,0x0,0x0,0xbf463f35,0xbf623f55,0xbf753f6d,0xbf7f3f7b
.long 0xbf7b3f80,0xbf553f6d,0xbf0e3f35,0xbe483ec4,0xbef13f35,0x3dc93e48,0x3f22bec4,0x3f75bf55
.long 0x3ec40000,0x3f6dbf35,0x3f6dbf80,0x3ec4bf35,0x3f75bf35,0x3f46bf7b,0xbdc9bec4,0xbf623f0e
.long 0x3f55bf80,0xbe48bec4,0xbf7b3f35,0xbf0e3f6d,0x3dc9bf35,0xbf753f0e,0xbef13f6d,0x3f46be48
.long 0xbf350000,0xbf353f80,0x3f350000,0x3f35bf80,0xbf7f3f35,0x3e953f0e,0x3f62bf6d,0xbf22be48
.long 0xbf0e3f80,0x3f7bbec4,0xbe48bf35,0xbf553f6d,0x3e953f35,0x3f22bf7b,0xbf7f3ec4,0x3ef13f0e
.long 0x3f6d0000,0xbec4bf35,0xbec43f80,0x3f6dbf35,0x3f62bf35,0xbf7f3e48,0x3f463ec4,0xbe95bf55
.long 0x3e48bf80,0xbf0e3f6d,0x3f55bf35,0xbf7b3ec4,0xbf22bf35,0x3ef13f55,0xbe95bf6d,0x3dc93f7b
.long 0x0,0x0,0x0,0x0,0xbf7f3f80,0xbf753f7b,0xbf623f6d,0xbf463f55
.long 0x3e480000,0x3f0ebec4,0x3f55bf35,0x3f7bbf6d,0x3f75bf80,0x3f22bf55,0x3dc9bec4,0xbef13e48
.long 0xbec40000,0xbf6d3f35,0xbf6d3f80,0xbec43f35,0xbf623f80,0xbdc93f0e,0x3f46bec4,0x3f75bf7b
.long 0x3f0e0000,0x3f7bbf6d,0x3e48bf35,0xbf553ec4,0x3f46bf80,0xbef1be48,0xbf753f6d,0x3dc93f0e
.long 0xbf350000,0xbf353f80,0x3f350000,0x3f35bf80,0xbf223f80,0x3f62be48,0x3e95bf6d,0xbf7f3f0e
.long 0x3f550000,0x3e48bf6d,0xbf7b3f35,0x3f0e3ec4,0x3ef1bf80,0xbf7f3f0e,0x3f223ec4,0x3e95bf7b
.long 0xbf6d0000,0x3ec43f35,0x3ec4bf80,0xbf6d3f35,0xbe953f80,0x3f46bf55,0xbf7f3ec4,0x3f623e48
.long 0x3f7b0000,0xbf55bec4,0x3f0e3f35,0xbe48bf6d,0x3dc9bf80,0xbe953f7b,0x3ef1bf6d,0xbf223f55
.long 0x0,0x0,0x0,0x0,0xbf223f35,0xbef13f0e,0xbe953ec4,0xbdc93e48
.long 0x3f7bbf80,0x3f55bf6d,0x3f0ebf35,0x3e48bec4,0xbf623f35,0xbf7f3f7b,0xbf463f6d,0xbe953f0e
.long 0x3ec40000,0x3f6dbf35,0x3f6dbf80,0x3ec4bf35,0x3e95bf35,0xbf223e48,0xbf7f3f6d,0xbef13f55
.long 0xbf553f80,0x3e483ec4,0x3f7bbf35,0x3f0ebf6d,0x3f7fbf35,0x3e95bf55,0xbf623ec4,0xbf223f7b
.long 0xbf350000,0xbf353f80,0x3f350000,0x3f35bf80,0x3dc93f35,0x3f75bf55,0xbef1bec4,0xbf463f7b
.long 0x3f0ebf80,0xbf7b3ec4,0x3e483f35,0x3f55bf6d,0xbf753f35,0x3f463e48,0x3dc9bf6d,0xbf623f55
.long 0x3f6d0000,0xbec4bf35,0xbec43f80,0x3f6dbf35,0xbef1bf35,0xbdc93f7b,0x3f22bf6d,0xbf753f0e
.long 0xbe483f80,0x3f0ebf6d,0xbf553f35,0x3f7bbec4,0x3f46bf35,0xbf623f0e,0x3f75bec4,0xbf7f3e48
.long 0x0,0x0,0x0,0x0,0x3dc90000,0x3e95be48,0x3ef1bec4,0x3f22bf0e
.long 0xbe480000,0xbf0e3ec4,0xbf553f35,0xbf7b3f6d,0x3e950000,0x3f46bf0e,0x3f7fbf6d,0x3f62bf7b
.long 0xbec40000,0xbf6d3f35,0xbf6d3f80,0xbec43f35,0x3ef10000,0x3f7fbf55,0x3f22bf6d,0xbe95be48
.long 0xbf0e0000,0xbf7b3f6d,0xbe483f35,0x3f55bec4,0x3f220000,0x3f62bf7b,0xbe95bec4,0xbf7f3f55
.long 0xbf350000,0xbf353f80,0x3f350000,0x3f35bf80,0x3f460000,0x3ef1bf7b,0xbf753ec4,0xbdc93f55
.long 0xbf550000,0xbe483f6d,0x3f7bbf35,0xbf0ebec4,0x3f620000,0xbdc9bf55,0xbf463f6d,0x3f75be48
.long 0xbf6d0000,0x3ec43f35,0x3ec4bf80,0xbf6d3f35,0x3f750000,0xbf22bf0e,0x3dc93f6d,0x3ef1bf7b
.long 0xbf7b0000,0x3f553ec4,0xbf0ebf35,0x3e483f6d,0x3f7f0000,0xbf75be48,0x3f623ec4,0xbf46bf0e
.long 0x0,0x0,0x0,0x0,0x3f46bf35,0x3f62bf55,0x3f75bf6d,0x3f7fbf7b
.long 0xbf7b3f80,0xbf553f6d,0xbf0e3f35,0xbe483ec4,0x3ef1bf35,0xbdc9be48,0xbf223ec4,0xbf753f55
.long 0x3ec40000,0x3f6dbf35,0x3f6dbf80,0x3ec4bf35,0xbf753f35,0xbf463f7b,0x3dc93ec4,0x3f62bf0e
.long 0x3f55bf80,0xbe48bec4,0xbf7b3f35,0xbf0e3f6d,0xbdc93f35,0x3f75bf0e,0x3ef1bf6d,0xbf463e48
.long 0xbf350000,0xbf353f80,0x3f350000,0x3f35bf80,0x3f7fbf35,0xbe95bf0e,0xbf623f6d,0x3f223e48
.long 0xbf0e3f80,0x3f7bbec4,0xbe48bf35,0xbf553f6d,0xbe95bf35,0xbf223f7b,0x3f7fbec4,0xbef1bf0e
.long 0x3f6d0000,0xbec4bf35,0xbec43f80,0x3f6dbf35,0xbf623f35,0x3f7fbe48,0xbf46bec4,0x3e953f55
.long 0x3e48bf80,0xbf0e3f6d,0x3f55bf35,0xbf7b3ec4,0x3f223f35,0xbef1bf55,0x3e953f6d,0xbdc9bf7b
.long 0x0,0x0,0x0,0x0,0x3f7fbf80,0x3f75bf7b,0x3f62bf6d,0x3f46bf55
.long 0x3e480000,0x3f0ebec4,0x3f55bf35,0x3f7bbf6d,0xbf753f80,0xbf223f55,0xbdc93ec4,0x3ef1be48
.long 0xbec40000,0xbf6d3f35,0xbf6d3f80,0xbec43f35,0x3f62bf80,0x3dc9bf0e,0xbf463ec4,0xbf753f7b
.long 0x3f0e0000,0x3f7bbf6d,0x3e48bf35,0xbf553ec4,0xbf463f80,0x3ef13e48,0x3f75bf6d,0xbdc9bf0e
.long 0xbf350000,0xbf353f80,0x3f350000,0x3f35bf80,0x3f22bf80,0xbf623e48,0xbe953f6d,0x3f7fbf0e
.long 0x3f550000,0x3e48bf6d,0xbf7b3f35,0x3f0e3ec4,0xbef13f80,0x3f7fbf0e,0xbf22bec4,0xbe953f7b
.long 0xbf6d0000,0x3ec43f35,0x3ec4bf80,0xbf6d3f35,0x3e95bf80,0xbf463f55,0x3f7fbec4,0xbf62be48
.long 0x3f7b0000,0xbf55bec4,0x3f0e3f35,0xbe48bf6d,0xbdc93f80,0x3e95bf7b,0xbef13f6d,0x3f22bf55
.long 0x0,0x0,0x0,0x0,0x3f22bf35,0x3ef1bf0e,0x3e95bec4,0x3dc9be48
.long 0x3f7bbf80,0x3f55bf6d,0x3f0ebf35,0x3e48bec4,0x3f62bf35,0x3f7fbf7b,0x3f46bf6d,0x3e95bf0e
.long 0x3ec40000,0x3f6dbf35,0x3f6dbf80,0x3ec4bf35,0xbe953f35,0x3f22be48,0x3f7fbf6d,0x3ef1bf55
.long 0xbf553f80,0x3e483ec4,0x3f7bbf35,0x3f0ebf6d,0xbf7f3f35,0xbe953f55,0x3f62bec4,0x3f22bf7b
.long 0xbf350000,0xbf353f80,0x3f350000,0x3f35bf80,0xbdc9bf35,0xbf753f55,0x3ef13ec4,0x3f46bf7b
.long 0x3f0ebf80,0xbf7b3ec4,0x3e483f35,0x3f55bf6d,0x3f75bf35,0xbf46be48,0xbdc93f6d,0x3f62bf55
.long 0x3f6d0000,0xbec4bf35,0xbec43f80,0x3f6dbf35,0x3ef13f35,0x3dc9bf7b,0xbf223f6d,0x3f75bf0e
.long 0xbe483f80,0x3f0ebf6d,0xbf553f35,0x3f7bbec4,0xbf463f35,0x3f62bf0e,0xbf753ec4,0x3f7fbe48
.long 0x3f80,0xbf80,0x3f80,0xbf80,0x3dc93f80,0xbe95bf7b,0x3ef13f6d,0xbf22bf55
.long 0x3e483f80,0xbf0ebf6d,0x3f553f35,0xbf7bbec4,0x3e953f80,0xbf46bf55,0x3f7f3ec4,0xbf623e48
.long 0x3ec43f80,0xbf6dbf35,0x3f6d0000,0xbec43f35,0x3ef13f80,0xbf7fbf0e,0x3f22bec4,0x3e953f7b
.long 0x3f0e3f80,0xbf7bbec4,0x3e48bf35,0x3f553f6d,0x3f223f80,0xbf62be48,0xbe95bf6d,0x3f7f3f0e
.long 0x3f353f80,0xbf350000,0xbf35bf80,0x3f350000,0x3f463f80,0xbef13e48,0xbf75bf6d,0x3dc9bf0e
.long 0x3f553f80,0xbe483ec4,0xbf7bbf35,0xbf0ebf6d,0x3f623f80,0x3dc93f0e,0xbf46bec4,0xbf75bf7b
.long 0x3f6d3f80,0x3ec43f35,0xbec40000,0xbf6dbf35,0x3f753f80,0x3f223f55,0x3dc93ec4,0xbef1be48
.long 0x3f7b3f80,0x3f553f6d,0x3f0e3f35,0x3e483ec4,0x3f7f3f80,0x3f753f7b,0x3f623f6d,0x3f463f55
.long 0x3f80,0xbf80,0x3f80,0xbf80,0x3f463f35,0xbf62bf0e,0x3f753ec4,0xbf7fbe48
.long 0x3f7b0000,0xbf553ec4,0x3f0ebf35,0xbe483f6d,0x3ef1bf35,0x3dc93f7b,0xbf22bf6d,0x3f753f0e
.long 0xbec4bf80,0x3f6d3f35,0xbf6d0000,0x3ec4bf35,0xbf75bf35,0x3f46be48,0x3dc93f6d,0xbf62bf55
.long 0xbf550000,0xbe48bf6d,0x3f7b3f35,0xbf0e3ec4,0xbdc93f35,0xbf75bf55,0x3ef1bec4,0x3f463f7b
.long 0x3f353f80,0xbf350000,0xbf35bf80,0x3f350000,0x3f7f3f35,0x3e953f55,0xbf62bec4,0xbf22bf7b
.long 0x3f0e0000,0x3f7b3f6d,0x3e483f35,0xbf55bec4,0xbe95bf35,0x3f223e48,0x3f7f3f6d,0x3ef13f55
.long 0xbf6dbf80,0xbec4bf35,0x3ec40000,0x3f6d3f35,0xbf62bf35,0xbf7fbf7b,0xbf46bf6d,0xbe95bf0e
.long 0xbe480000,0xbf0ebec4,0xbf55bf35,0xbf7bbf6d,0x3f223f35,0x3ef13f0e,0x3e953ec4,0x3dc93e48
.long 0x3f80,0xbf80,0x3f80,0xbf80,0x3f7f0000,0xbf753e48,0x3f62bec4,0xbf463f0e
.long 0xbe48bf80,0x3f0e3f6d,0xbf55bf35,0x3f7b3ec4,0xbf750000,0x3f22bf0e,0xbdc93f6d,0xbef1bf7b
.long 0x3ec43f80,0xbf6dbf35,0x3f6d0000,0xbec43f35,0x3f620000,0xbdc93f55,0xbf46bf6d,0x3f753e48
.long 0xbf0ebf80,0x3f7b3ec4,0xbe483f35,0xbf55bf6d,0xbf460000,0xbef1bf7b,0x3f753ec4,0x3dc93f55
.long 0x3f353f80,0xbf350000,0xbf35bf80,0x3f350000,0x3f220000,0x3f623f7b,0xbe953ec4,0xbf7fbf55
.long 0xbf55bf80,0x3e48bec4,0x3f7b3f35,0x3f0e3f6d,0xbef10000,0xbf7fbf55,0xbf22bf6d,0x3e95be48
.long 0x3f6d3f80,0x3ec43f35,0xbec40000,0xbf6dbf35,0x3e950000,0x3f463f0e,0x3f7f3f6d,0x3f623f7b
.long 0xbf7bbf80,0xbf55bf6d,0xbf0ebf35,0xbe48bec4,0xbdc90000,0xbe95be48,0xbef1bec4,0xbf22bf0e
.long 0x3f80,0xbf80,0x3f80,0xbf80,0x3f22bf35,0xbef13f55,0x3e95bf6d,0xbdc93f7b
.long 0xbf7b0000,0x3f55bec4,0xbf0e3f35,0x3e48bf6d,0x3f623f35,0xbf7fbe48,0x3f46bec4,0xbe953f55
.long 0xbec4bf80,0x3f6d3f35,0xbf6d0000,0x3ec4bf35,0xbe953f35,0xbf22bf7b,0x3f7f3ec4,0xbef13f0e
.long 0x3f550000,0x3e483f6d,0xbf7bbf35,0x3f0ebec4,0xbf7fbf35,0x3e95bf0e,0x3f623f6d,0xbf223e48
.long 0x3f353f80,0xbf350000,0xbf35bf80,0x3f350000,0xbdc9bf35,0x3f753f0e,0x3ef13f6d,0xbf46be48
.long 0xbf0e0000,0xbf7bbf6d,0xbe48bf35,0x3f553ec4,0x3f753f35,0x3f463f7b,0xbdc93ec4,0xbf62bf0e
.long 0xbf6dbf80,0xbec4bf35,0x3ec40000,0x3f6d3f35,0x3ef13f35,0xbdc93e48,0xbf22bec4,0xbf75bf55
.long 0x3e480000,0x3f0e3ec4,0x3f553f35,0x3f7b3f6d,0xbf46bf35,0xbf62bf55,0xbf75bf6d,0xbf7fbf7b
.long 0x3f80,0xbf80,0x3f80,0xbf80,0xbdc9bf80,0x3e953f7b,0xbef1bf6d,0x3f223f55
.long 0x3e483f80,0xbf0ebf6d,0x3f553f35,0xbf7bbec4,0xbe95bf80,0x3f463f55,0xbf7fbec4,0x3f62be48
.long 0x3ec43f80,0xbf6dbf35,0x3f6d0000,0xbec43f35,0xbef1bf80,0x3f7f3f0e,0xbf223ec4,0xbe95bf7b
.long 0x3f0e3f80,0xbf7bbec4,0x3e48bf35,0x3f553f6d,0xbf22bf80,0x3f623e48,0x3e953f6d,0xbf7fbf0e
.long 0x3f353f80,0xbf350000,0xbf35bf80,0x3f350000,0xbf46bf80,0x3ef1be48,0x3f753f6d,0xbdc93f0e
.long 0x3f553f80,0xbe483ec4,0xbf7bbf35,0xbf0ebf6d,0xbf62bf80,0xbdc9bf0e,0x3f463ec4,0x3f753f7b
.long 0x3f6d3f80,0x3ec43f35,0xbec40000,0xbf6dbf35,0xbf75bf80,0xbf22bf55,0xbdc9bec4,0x3ef13e48
.long 0x3f7b3f80,0x3f553f6d,0x3f0e3f35,0x3e483ec4,0xbf7fbf80,0xbf75bf7b,0xbf62bf6d,0xbf46bf55
.long 0x3f80,0xbf80,0x3f80,0xbf80,0xbf46bf35,0x3f623f0e,0xbf75bec4,0x3f7f3e48
.long 0x3f7b0000,0xbf553ec4,0x3f0ebf35,0xbe483f6d,0xbef13f35,0xbdc9bf7b,0x3f223f6d,0xbf75bf0e
.long 0xbec4bf80,0x3f6d3f35,0xbf6d0000,0x3ec4bf35,0x3f753f35,0xbf463e48,0xbdc9bf6d,0x3f623f55
.long 0xbf550000,0xbe48bf6d,0x3f7b3f35,0xbf0e3ec4,0x3dc9bf35,0x3f753f55,0xbef13ec4,0xbf46bf7b
.long 0x3f353f80,0xbf350000,0xbf35bf80,0x3f350000,0xbf7fbf35,0xbe95bf55,0x3f623ec4,0x3f223f7b
.long 0x3f0e0000,0x3f7b3f6d,0x3e483f35,0xbf55bec4,0x3e953f35,0xbf22be48,0xbf7fbf6d,0xbef1bf55
.long 0xbf6dbf80,0xbec4bf35,0x3ec40000,0x3f6d3f35,0x3f623f35,0x3f7f3f7b,0x3f463f6d,0x3e953f0e
.long 0xbe480000,0xbf0ebec4,0xbf55bf35,0xbf7bbf6d,0xbf22bf35,0xbef1bf0e,0xbe95bec4,0xbdc9be48
.long 0x3f80,0xbf80,0x3f80,0xbf80,0xbf7f0000,0x3f75be48,0xbf623ec4,0x3f46bf0e
.long 0xbe48bf80,0x3f0e3f6d,0xbf55bf35,0x3f7b3ec4,0x3f750000,0xbf223f0e,0x3dc9bf6d,0x3ef13f7b
.long 0x3ec43f80,0xbf6dbf35,0x3f6d0000,0xbec43f35,0xbf620000,0x3dc9bf55,0x3f463f6d,0xbf75be48
.long 0xbf0ebf80,0x3f7b3ec4,0xbe483f35,0xbf55bf6d,0x3f460000,0x3ef13f7b,0xbf75bec4,0xbdc9bf55
.long 0x3f353f80,0xbf350000,0xbf35bf80,0x3f350000,0xbf220000,0xbf62bf7b,0x3e95bec4,0x3f7f3f55
.long 0xbf55bf80,0x3e48bec4,0x3f7b3f35,0x3f0e3f6d,0x3ef10000,0x3f7f3f55,0x3f223f6d,0xbe953e48
.long 0x3f6d3f80,0x3ec43f35,0xbec40000,0xbf6dbf35,0xbe950000,0xbf46bf0e,0xbf7fbf6d,0xbf62bf7b
.long 0xbf7bbf80,0xbf55bf6d,0xbf0ebf35,0xbe48bec4,0x3dc90000,0x3e953e48,0x3ef13ec4,0x3f223f0e
.long 0x3f80,0xbf80,0x3f80,0xbf80,0xbf223f35,0x3ef1bf55,0xbe953f6d,0x3dc9bf7b
.long 0xbf7b0000,0x3f55bec4,0xbf0e3f35,0x3e48bf6d,0xbf62bf35,0x3f7f3e48,0xbf463ec4,0x3e95bf55
.long 0xbec4bf80,0x3f6d3f35,0xbf6d0000,0x3ec4bf35,0x3e95bf35,0x3f223f7b,0xbf7fbec4,0x3ef1bf0e
.long 0x3f550000,0x3e483f6d,0xbf7bbf35,0x3f0ebec4,0x3f7f3f35,0xbe953f0e,0xbf62bf6d,0x3f22be48
.long 0x3f353f80,0xbf350000,0xbf35bf80,0x3f350000,0x3dc93f35,0xbf75bf0e,0xbef1bf6d,0x3f463e48
.long 0xbf0e0000,0xbf7bbf6d,0xbe48bf35,0x3f553ec4,0xbf75bf35,0xbf46bf7b,0x3dc9bec4,0x3f623f0e
.long 0xbf6dbf80,0xbec4bf35,0x3ec40000,0x3f6d3f35,0xbef1bf35,0x3dc9be48,0x3f223ec4,0x3f753f55
.long 0x3e480000,0x3f0e3ec4,0x3f553f35,0x3f7b3f6d,0x3f463f35,0x3f623f55,0x3f753f6d,0x3f7f3f7b
.long 0xbf800000,0x3f800000,0xbf800000,0x3f800000,0xbf7f0000,0x3f75be48,0xbf623ec4,0x3f46bf0e
.long 0xbf7b0000,0x3f55bec4,0xbf0e3f35,0x3e48bf6d,0xbf750000,0x3f22bf0e,0xbdc93f6d,0xbef1bf7b
.long 0xbf6d0000,0x3ec4bf35,0x3ec43f80,0xbf6dbf35,0xbf620000,0x3dc9bf55,0x3f463f6d,0xbf75be48
.long 0xbf550000,0xbe48bf6d,0x3f7b3f35,0xbf0e3ec4,0xbf460000,0xbef1bf7b,0x3f753ec4,0x3dc93f55
.long 0xbf350000,0xbf35bf80,0x3f350000,0x3f353f80,0xbf220000,0xbf62bf7b,0x3e95bec4,0x3f7f3f55
.long 0xbf0e0000,0xbf7bbf6d,0xbe48bf35,0x3f553ec4,0xbef10000,0xbf7fbf55,0xbf22bf6d,0x3e95be48
.long 0xbec40000,0xbf6dbf35,0xbf6dbf80,0xbec4bf35,0xbe950000,0xbf46bf0e,0xbf7fbf6d,0xbf62bf7b
.long 0xbe480000,0xbf0ebec4,0xbf55bf35,0xbf7bbf6d,0xbdc90000,0xbe95be48,0xbef1bec4,0xbf22bf0e
.long 0xbf800000,0x3f800000,0xbf800000,0x3f800000,0xbf223f35,0x3ef1bf55,0xbe953f6d,0x3dc9bf7b
.long 0x3e483f80,0xbf0ebf6d,0x3f553f35,0xbf7bbec4,0x3f623f35,0xbf7fbe48,0x3f46bec4,0xbe953f55
.long 0x3f6d0000,0xbec43f35,0xbec4bf80,0x3f6d3f35,0x3e95bf35,0x3f223f7b,0xbf7fbec4,0x3ef1bf0e
.long 0xbf0ebf80,0x3f7b3ec4,0xbe483f35,0xbf55bf6d,0xbf7fbf35,0x3e95bf0e,0x3f623f6d,0xbf223e48
.long 0xbf350000,0xbf35bf80,0x3f350000,0x3f353f80,0x3dc93f35,0xbf75bf0e,0xbef1bf6d,0x3f463e48
.long 0x3f553f80,0xbe483ec4,0xbf7bbf35,0xbf0ebf6d,0x3f753f35,0x3f463f7b,0xbdc93ec4,0xbf62bf0e
.long 0x3ec40000,0x3f6d3f35,0x3f6d3f80,0x3ec43f35,0xbef1bf35,0x3dc9be48,0x3f223ec4,0x3f753f55
.long 0xbf7bbf80,0xbf55bf6d,0xbf0ebf35,0xbe48bec4,0xbf46bf35,0xbf62bf55,0xbf75bf6d,0xbf7fbf7b
.long 0xbf800000,0x3f800000,0xbf800000,0x3f800000,0x3dc93f80,0xbe95bf7b,0x3ef13f6d,0xbf22bf55
.long 0x3f7b0000,0xbf553ec4,0x3f0ebf35,0xbe483f6d,0xbe95bf80,0x3f463f55,0xbf7fbec4,0x3f62be48
.long 0xbf6d0000,0x3ec4bf35,0x3ec43f80,0xbf6dbf35,0x3ef13f80,0xbf7fbf0e,0x3f22bec4,0x3e953f7b
.long 0x3f550000,0x3e483f6d,0xbf7bbf35,0x3f0ebec4,0xbf22bf80,0x3f623e48,0x3e953f6d,0xbf7fbf0e
.long 0xbf350000,0xbf35bf80,0x3f350000,0x3f353f80,0x3f463f80,0xbef13e48,0xbf75bf6d,0x3dc9bf0e
.long 0x3f0e0000,0x3f7b3f6d,0x3e483f35,0xbf55bec4,0xbf62bf80,0xbdc9bf0e,0x3f463ec4,0x3f753f7b
.long 0xbec40000,0xbf6dbf35,0xbf6dbf80,0xbec4bf35,0x3f753f80,0x3f223f55,0x3dc93ec4,0xbef1be48
.long 0x3e480000,0x3f0e3ec4,0x3f553f35,0x3f7b3f6d,0xbf7fbf80,0xbf75bf7b,0xbf62bf6d,0xbf46bf55
.long 0xbf800000,0x3f800000,0xbf800000,0x3f800000,0x3f463f35,0xbf62bf0e,0x3f753ec4,0xbf7fbe48
.long 0xbe48bf80,0x3f0e3f6d,0xbf55bf35,0x3f7b3ec4,0xbef13f35,0xbdc9bf7b,0x3f223f6d,0xbf75bf0e
.long 0x3f6d0000,0xbec43f35,0xbec4bf80,0x3f6d3f35,0xbf75bf35,0x3f46be48,0x3dc93f6d,0xbf62bf55
.long 0x3f0e3f80,0xbf7bbec4,0x3e48bf35,0x3f553f6d,0x3dc9bf35,0x3f753f55,0xbef13ec4,0xbf46bf7b
.long 0xbf350000,0xbf35bf80,0x3f350000,0x3f353f80,0x3f7f3f35,0x3e953f55,0xbf62bec4,0xbf22bf7b
.long 0xbf55bf80,0x3e48bec4,0x3f7b3f35,0x3f0e3f6d,0x3e953f35,0xbf22be48,0xbf7fbf6d,0xbef1bf55
.long 0x3ec40000,0x3f6d3f35,0x3f6d3f80,0x3ec43f35,0xbf62bf35,0xbf7fbf7b,0xbf46bf6d,0xbe95bf0e
.long 0x3f7b3f80,0x3f553f6d,0x3f0e3f35,0x3e483ec4,0xbf22bf35,0xbef1bf0e,0xbe95bec4,0xbdc9be48
.long 0xbf800000,0x3f800000,0xbf800000,0x3f800000,0x3f7f0000,0xbf753e48,0x3f62bec4,0xbf463f0e
.long 0xbf7b0000,0x3f55bec4,0xbf0e3f35,0x3e48bf6d,0x3f750000,0xbf223f0e,0x3dc9bf6d,0x3ef13f7b
.long 0xbf6d0000,0x3ec4bf35,0x3ec43f80,0xbf6dbf35,0x3f620000,0xbdc93f55,0xbf46bf6d,0x3f753e48
.long 0xbf550000,0xbe48bf6d,0x3f7b3f35,0xbf0e3ec4,0x3f460000,0x3ef13f7b,0xbf75bec4,0xbdc9bf55
.long 0xbf350000,0xbf35bf80,0x3f350000,0x3f353f80,0x3f220000,0x3f623f7b,0xbe953ec4,0xbf7fbf55
.long 0xbf0e0000,0xbf7bbf6d,0xbe48bf35,0x3f553ec4,0x3ef10000,0x3f7f3f55,0x3f223f6d,0xbe953e48
.long 0xbec40000,0xbf6dbf35,0xbf6dbf80,0xbec4bf35,0x3e950000,0x3f463f0e,0x3f7f3f6d,0x3f623f7b
.long 0xbe480000,0xbf0ebec4,0xbf55bf35,0xbf7bbf6d,0x3dc90000,0x3e953e48,0x3ef13ec4,0x3f223f0e
.long 0xbf800000,0x3f800000,0xbf800000,0x3f800000,0x3f22bf35,0xbef13f55,0x3e95bf6d,0xbdc93f7b
.long 0x3e483f80,0xbf0ebf6d,0x3f553f35,0xbf7bbec4,0xbf62bf35,0x3f7f3e48,0xbf463ec4,0x3e95bf55
.long 0x3f6d0000,0xbec43f35,0xbec4bf80,0x3f6d3f35,0xbe953f35,0xbf22bf7b,0x3f7f3ec4,0xbef13f0e
.long 0xbf0ebf80,0x3f7b3ec4,0xbe483f35,0xbf55bf6d,0x3f7f3f35,0xbe953f0e,0xbf62bf6d,0x3f22be48
.long 0xbf350000,0xbf35bf80,0x3f350000,0x3f353f80,0xbdc9bf35,0x3f753f0e,0x3ef13f6d,0xbf46be48
.long 0x3f553f80,0xbe483ec4,0xbf7bbf35,0xbf0ebf6d,0xbf75bf35,0xbf46bf7b,0x3dc9bec4,0x3f623f0e
.long 0x3ec40000,0x3f6d3f35,0x3f6d3f80,0x3ec43f35,0x3ef13f35,0xbdc93e48,0xbf22bec4,0xbf75bf55
.long 0xbf7bbf80,0xbf55bf6d,0xbf0ebf35,0xbe48bec4,0x3f463f35,0x3f623f55,0x3f753f6d,0x3f7f3f7b
.long 0xbf800000,0x3f800000,0xbf800000,0x3f800000,0xbdc9bf80,0x3e953f7b,0xbef1bf6d,0x3f223f55
.long 0x3f7b0000,0xbf553ec4,0x3f0ebf35,0xbe483f6d,0x3e953f80,0xbf46bf55,0x3f7f3ec4,0xbf623e48
.long 0xbf6d0000,0x3ec4bf35,0x3ec43f80,0xbf6dbf35,0xbef1bf80,0x3f7f3f0e,0xbf223ec4,0xbe95bf7b
.long 0x3f550000,0x3e483f6d,0xbf7bbf35,0x3f0ebec4,0x3f223f80,0xbf62be48,0xbe95bf6d,0x3f7f3f0e
.long 0xbf350000,0xbf35bf80,0x3f350000,0x3f353f80,0xbf46bf80,0x3ef1be48,0x3f753f6d,0xbdc93f0e
.long 0x3f0e0000,0x3f7b3f6d,0x3e483f35,0xbf55bec4,0x3f623f80,0x3dc93f0e,0xbf46bec4,0xbf75bf7b
.long 0xbec40000,0xbf6dbf35,0xbf6dbf80,0xbec4bf35,0xbf75bf80,0xbf22bf55,0xbdc9bec4,0x3ef13e48
.long 0x3e480000,0x3f0e3ec4,0x3f553f35,0x3f7b3f6d,0x3f7f3f80,0x3f753f7b,0x3f623f6d,0x3f463f55
.long 0xbf800000,0x3f800000,0xbf800000,0x3f800000,0xbf46bf35,0x3f623f0e,0xbf75bec4,0x3f7f3e48
.long 0xbe48bf80,0x3f0e3f6d,0xbf55bf35,0x3f7b3ec4,0x3ef1bf35,0x3dc93f7b,0xbf22bf6d,0x3f753f0e
.long 0x3f6d0000,0xbec43f35,0xbec4bf80,0x3f6d3f35,0x3f753f35,0xbf463e48,0xbdc9bf6d,0x3f623f55
.long 0x3f0e3f80,0xbf7bbec4,0x3e48bf35,0x3f553f6d,0xbdc93f35,0xbf75bf55,0x3ef1bec4,0x3f463f7b
.long 0xbf350000,0xbf35bf80,0x3f350000,0x3f353f80,0xbf7fbf35,0xbe95bf55,0x3f623ec4,0x3f223f7b
.long 0xbf55bf80,0x3e48bec4,0x3f7b3f35,0x3f0e3f6d,0xbe95bf35,0x3f223e48,0x3f7f3f6d,0x3ef13f55
.long 0x3ec40000,0x3f6d3f35,0x3f6d3f80,0x3ec43f35,0x3f623f35,0x3f7f3f7b,0x3f463f6d,0x3e953f0e
.long 0x3f7b3f80,0x3f553f6d,0x3f0e3f35,0x3e483ec4,0x3f223f35,0x3ef13f0e,0x3e953ec4,0x3dc93e48
.long 0x3f803f80,0x3f803f80,0x3f803f80,0x3f803f80,0x3f7b3f80,0xbe480000,0xbf7bbf80,0x3e480000
.long 0x3f6d3f80,0xbf6dbf80,0x3f6d3f80,0xbf6dbf80,0x3f553f80,0x3f0e0000,0xbf55bf80,0xbf0e0000
.long 0x3f353f80,0x3f353f80,0x3f353f80,0x3f353f80,0x3f0e3f80,0xbf550000,0xbf0ebf80,0x3f550000
.long 0x3ec43f80,0xbec4bf80,0x3ec43f80,0xbec4bf80,0x3e483f80,0x3f7b0000,0xbe48bf80,0xbf7b0000
.long 0x3f80,0x3f80,0x3f80,0x3f80,0xbe483f80,0xbf7b0000,0x3e48bf80,0x3f7b0000
.long 0xbec43f80,0x3ec4bf80,0xbec43f80,0x3ec4bf80,0xbf0e3f80,0x3f550000,0x3f0ebf80,0xbf550000
.long 0xbf353f80,0xbf353f80,0xbf353f80,0xbf353f80,0xbf553f80,0xbf0e0000,0x3f55bf80,0x3f0e0000
.long 0xbf6d3f80,0x3f6dbf80,0xbf6d3f80,0x3f6dbf80,0xbf7b3f80,0x3e480000,0x3f7bbf80,0xbe480000
.long 0x3f803f80,0x3f803f80,0x3f803f80,0x3f803f80,0x3f553f6d,0xbf0ebec4,0xbf55bf6d,0x3f0e3ec4
.long 0x3ec43f35,0xbec4bf35,0x3ec43f35,0xbec4bf35,0xbe483ec4,0x3f7b3f6d,0x3e48bec4,0xbf7bbf6d
.long 0xbf350000,0xbf350000,0xbf350000,0xbf350000,0xbf7bbec4,0xbe48bf6d,0x3f7b3ec4,0x3e483f6d
.long 0xbf6dbf35,0x3f6d3f35,0xbf6dbf35,0x3f6d3f35,0xbf0ebf6d,0xbf553ec4,0x3f0e3f6d,0x3f55bec4
.long 0xbf80,0xbf80,0xbf80,0xbf80,0x3f0ebf6d,0x3f553ec4,0xbf0e3f6d,0xbf55bec4
.long 0x3f6dbf35,0xbf6d3f35,0x3f6dbf35,0xbf6d3f35,0x3f7bbec4,0x3e48bf6d,0xbf7b3ec4,0xbe483f6d
.long 0x3f350000,0x3f350000,0x3f350000,0x3f350000,0x3e483ec4,0xbf7b3f6d,0xbe48bec4,0x3f7bbf6d
.long 0xbec43f35,0x3ec4bf35,0xbec43f35,0x3ec4bf35,0xbf553f6d,0x3f0ebec4,0x3f55bf6d,0xbf0e3ec4
.long 0x3f803f80,0x3f803f80,0x3f803f80,0x3f803f80,0x3f0e3f35,0xbf55bf35,0xbf0ebf35,0x3f553f35
.long 0xbec40000,0x3ec40000,0xbec40000,0x3ec40000,0xbf7bbf35,0x3e483f35,0x3f7b3f35,0xbe48bf35
.long 0xbf35bf80,0xbf35bf80,0xbf35bf80,0xbf35bf80,0x3e48bf35,0x3f7b3f35,0xbe483f35,0xbf7bbf35
.long 0x3f6d0000,0xbf6d0000,0x3f6d0000,0xbf6d0000,0x3f553f35,0x3f0ebf35,0xbf55bf35,0xbf0e3f35
.long 0x3f80,0x3f80,0x3f80,0x3f80,0xbf553f35,0xbf0ebf35,0x3f55bf35,0x3f0e3f35
.long 0xbf6d0000,0x3f6d0000,0xbf6d0000,0x3f6d0000,0xbe48bf35,0xbf7b3f35,0x3e483f35,0x3f7bbf35
.long 0x3f35bf80,0x3f35bf80,0x3f35bf80,0x3f35bf80,0x3f7bbf35,0xbe483f35,0xbf7b3f35,0x3e48bf35
.long 0x3ec40000,0xbec40000,0x3ec40000,0xbec40000,0xbf0e3f35,0x3f55bf35,0x3f0ebf35,0xbf553f35
.long 0x3f803f80,0x3f803f80,0x3f803f80,0x3f803f80,0x3e483ec4,0xbf7bbf6d,0xbe48bec4,0x3f7b3f6d
.long 0xbf6dbf35,0x3f6d3f35,0xbf6dbf35,0x3f6d3f35,0xbf0ebf6d,0xbf55bec4,0x3f0e3f6d,0x3f553ec4
.long 0x3f350000,0x3f350000,0x3f350000,0x3f350000,0x3f553f6d,0xbf0e3ec4,0xbf55bf6d,0x3f0ebec4
.long 0xbec43f35,0x3ec4bf35,0xbec43f35,0x3ec4bf35,0xbf7bbec4,0xbe483f6d,0x3f7b3ec4,0x3e48bf6d
.long 0xbf80,0xbf80,0xbf80,0xbf80,0x3f7bbec4,0x3e483f6d,0xbf7b3ec4,0xbe48bf6d
.long 0x3ec43f35,0xbec4bf35,0x3ec43f35,0xbec4bf35,0xbf553f6d,0x3f0e3ec4,0x3f55bf6d,0xbf0ebec4
.long 0xbf350000,0xbf350000,0xbf350000,0xbf350000,0x3f0ebf6d,0x3f55bec4,0xbf0e3f6d,0xbf553ec4
.long 0x3f6dbf35,0xbf6d3f35,0x3f6dbf35,0xbf6d3f35,0xbe483ec4,0x3f7bbf6d,0x3e48bec4,0xbf7b3f6d
.long 0xbf803f80,0xbf803f80,0xbf803f80,0xbf803f80,0xbf7b3f80,0x3e480000,0x3f7bbf80,0xbe480000
.long 0xbf6d3f80,0x3f6dbf80,0xbf6d3f80,0x3f6dbf80,0xbf553f80,0xbf0e0000,0x3f55bf80,0x3f0e0000
.long 0xbf353f80,0xbf353f80,0xbf353f80,0xbf353f80,0xbf0e3f80,0x3f550000,0x3f0ebf80,0xbf550000
.long 0xbec43f80,0x3ec4bf80,0xbec43f80,0x3ec4bf80,0xbe483f80,0xbf7b0000,0x3e48bf80,0x3f7b0000
.long 0x3f80,0x3f80,0x3f80,0x3f80,0x3e483f80,0x3f7b0000,0xbe48bf80,0xbf7b0000
.long 0x3ec43f80,0xbec4bf80,0x3ec43f80,0xbec4bf80,0x3f0e3f80,0xbf550000,0xbf0ebf80,0x3f550000
.long 0x3f353f80,0x3f353f80,0x3f353f80,0x3f353f80,0x3f553f80,0x3f0e0000,0xbf55bf80,0xbf0e0000
.long 0x3f6d3f80,0xbf6dbf80,0x3f6d3f80,0xbf6dbf80,0x3f7b3f80,0xbe480000,0xbf7bbf80,0x3e480000
.long 0xbf803f80,0xbf803f80,0xbf803f80,0xbf803f80,0xbf553f6d,0x3f0ebec4,0x3f55bf6d,0xbf0e3ec4
.long 0xbec43f35,0x3ec4bf35,0xbec43f35,0x3ec4bf35,0x3e483ec4,0xbf7b3f6d,0xbe48bec4,0x3f7bbf6d
.long 0x3f350000,0x3f350000,0x3f350000,0x3f350000,0x3f7bbec4,0x3e48bf6d,0xbf7b3ec4,0xbe483f6d
.long 0x3f6dbf35,0xbf6d3f35,0x3f6dbf35,0xbf6d3f35,0x3f0ebf6d,0x3f553ec4,0xbf0e3f6d,0xbf55bec4
.long 0xbf80,0xbf80,0xbf80,0xbf80,0xbf0ebf6d,0xbf553ec4,0x3f0e3f6d,0x3f55bec4
.long 0xbf6dbf35,0x3f6d3f35,0xbf6dbf35,0x3f6d3f35,0xbf7bbec4,0xbe48bf6d,0x3f7b3ec4,0x3e483f6d
.long 0xbf350000,0xbf350000,0xbf350000,0xbf350000,0xbe483ec4,0x3f7b3f6d,0x3e48bec4,0xbf7bbf6d
.long 0x3ec43f35,0xbec4bf35,0x3ec43f35,0xbec4bf35,0x3f553f6d,0xbf0ebec4,0xbf55bf6d,0x3f0e3ec4
.long 0xbf803f80,0xbf803f80,0xbf803f80,0xbf803f80,0xbf0e3f35,0x3f55bf35,0x3f0ebf35,0xbf553f35
.long 0x3ec40000,0xbec40000,0x3ec40000,0xbec40000,0x3f7bbf35,0xbe483f35,0xbf7b3f35,0x3e48bf35
.long 0x3f35bf80,0x3f35bf80,0x3f35bf80,0x3f35bf80,0xbe48bf35,0xbf7b3f35,0x3e483f35,0x3f7bbf35
.long 0xbf6d0000,0x3f6d0000,0xbf6d0000,0x3f6d0000,0xbf553f35,0xbf0ebf35,0x3f55bf35,0x3f0e3f35
.long 0x3f80,0x3f80,0x3f80,0x3f80,0x3f553f35,0x3f0ebf35,0xbf55bf35,0xbf0e3f35
.long 0x3f6d0000,0xbf6d0000,0x3f6d0000,0xbf6d0000,0x3e48bf35,0x3f7b3f35,0xbe483f35,0xbf7bbf35
.long 0xbf35bf80,0xbf35bf80,0xbf35bf80,0xbf35bf80,0xbf7bbf35,0x3e483f35,0x3f7b3f35,0xbe48bf35
.long 0xbec40000,0x3ec40000,0xbec40000,0x3ec40000,0x3f0e3f35,0xbf55bf35,0xbf0ebf35,0x3f553f35
.long 0xbf803f80,0xbf803f80,0xbf803f80,0xbf803f80,0xbe483ec4,0x3f7bbf6d,0x3e48bec4,0xbf7b3f6d
.long 0x3f6dbf35,0xbf6d3f35,0x3f6dbf35,0xbf6d3f35,0x3f0ebf6d,0x3f55bec4,0xbf0e3f6d,0xbf553ec4
.long 0xbf350000,0xbf350000,0xbf350000,0xbf350000,0xbf553f6d,0x3f0e3ec4,0x3f55bf6d,0xbf0ebec4
.long 0x3ec43f35,0xbec4bf35,0x3ec43f35,0xbec4bf35,0x3f7bbec4,0x3e483f6d,0xbf7b3ec4,0xbe48bf6d
.long 0xbf80,0xbf80,0xbf80,0xbf80,0xbf7bbec4,0xbe483f6d,0x3f7b3ec4,0x3e48bf6d
.long 0xbec43f35,0x3ec4bf35,0xbec43f35,0x3ec4bf35,0x3f553f6d,0xbf0e3ec4,0xbf55bf6d,0x3f0ebec4
.long 0x3f350000,0x3f350000,0x3f350000,0x3f350000,0xbf0ebf6d,0xbf55bec4,0x3f0e3f6d,0x3f553ec4
.long 0xbf6dbf35,0x3f6d3f35,0xbf6dbf35,0x3f6d3f35,0x3e483ec4,0xbf7bbf6d,0xbe48bec4,0x3f7b3f6d
.long 0x0,0x0,0x0,0x0,0x3e480000,0x3f7b3f80,0xbe480000,0xbf7bbf80
.long 0x3ec40000,0xbec40000,0x3ec40000,0xbec40000,0x3f0e0000,0xbf55bf80,0xbf0e0000,0x3f553f80
.long 0x3f350000,0x3f350000,0x3f350000,0x3f350000,0x3f550000,0x3f0e3f80,0xbf550000,0xbf0ebf80
.long 0x3f6d0000,0xbf6d0000,0x3f6d0000,0xbf6d0000,0x3f7b0000,0xbe48bf80,0xbf7b0000,0x3e483f80
.long 0x3f800000,0x3f800000,0x3f800000,0x3f800000,0x3f7b0000,0xbe483f80,0xbf7b0000,0x3e48bf80
.long 0x3f6d0000,0xbf6d0000,0x3f6d0000,0xbf6d0000,0x3f550000,0x3f0ebf80,0xbf550000,0xbf0e3f80
.long 0x3f350000,0x3f350000,0x3f350000,0x3f350000,0x3f0e0000,0xbf553f80,0xbf0e0000,0x3f55bf80
.long 0x3ec40000,0xbec40000,0x3ec40000,0xbec40000,0x3e480000,0x3f7bbf80,0xbe480000,0xbf7b3f80
.long 0x0,0x0,0x0,0x0,0x3f0e3ec4,0x3f553f6d,0xbf0ebec4,0xbf55bf6d
.long 0x3f6d3f35,0xbf6dbf35,0x3f6d3f35,0xbf6dbf35,0x3f7b3f6d,0x3e48bec4,0xbf7bbf6d,0xbe483ec4
.long 0x3f353f80,0x3f353f80,0x3f353f80,0x3f353f80,0x3e483f6d,0xbf7bbec4,0xbe48bf6d,0x3f7b3ec4
.long 0xbec43f35,0x3ec4bf35,0xbec43f35,0x3ec4bf35,0xbf553ec4,0x3f0e3f6d,0x3f55bec4,0xbf0ebf6d
.long 0xbf800000,0xbf800000,0xbf800000,0xbf800000,0xbf55bec4,0x3f0ebf6d,0x3f553ec4,0xbf0e3f6d
.long 0xbec4bf35,0x3ec43f35,0xbec4bf35,0x3ec43f35,0x3e48bf6d,0xbf7b3ec4,0xbe483f6d,0x3f7bbec4
.long 0x3f35bf80,0x3f35bf80,0x3f35bf80,0x3f35bf80,0x3f7bbf6d,0x3e483ec4,0xbf7b3f6d,0xbe48bec4
.long 0x3f6dbf35,0xbf6d3f35,0x3f6dbf35,0xbf6d3f35,0x3f0ebec4,0x3f55bf6d,0xbf0e3ec4,0xbf553f6d
.long 0x0,0x0,0x0,0x0,0x3f553f35,0x3f0e3f35,0xbf55bf35,0xbf0ebf35
.long 0x3f6d3f80,0xbf6dbf80,0x3f6d3f80,0xbf6dbf80,0x3e483f35,0x3f7b3f35,0xbe48bf35,0xbf7bbf35
.long 0xbf350000,0xbf350000,0xbf350000,0xbf350000,0xbf7bbf35,0x3e48bf35,0x3f7b3f35,0xbe483f35
.long 0xbec4bf80,0x3ec43f80,0xbec4bf80,0x3ec43f80,0x3f0ebf35,0xbf55bf35,0xbf0e3f35,0x3f553f35
.long 0x3f800000,0x3f800000,0x3f800000,0x3f800000,0x3f0e3f35,0xbf553f35,0xbf0ebf35,0x3f55bf35
.long 0xbec43f80,0x3ec4bf80,0xbec43f80,0x3ec4bf80,0xbf7b3f35,0x3e483f35,0x3f7bbf35,0xbe48bf35
.long 0xbf350000,0xbf350000,0xbf350000,0xbf350000,0x3e48bf35,0x3f7bbf35,0xbe483f35,0xbf7b3f35
.long 0x3f6dbf80,0xbf6d3f80,0x3f6dbf80,0xbf6d3f80,0x3f55bf35,0x3f0ebf35,0xbf553f35,0xbf0e3f35
.long 0x0,0x0,0x0,0x0,0x3f7b3f6d,0x3e483ec4,0xbf7bbf6d,0xbe48bec4
.long 0x3ec43f35,0xbec4bf35,0x3ec43f35,0xbec4bf35,0xbf55bec4,0x3f0e3f6d,0x3f553ec4,0xbf0ebf6d
.long 0xbf35bf80,0xbf35bf80,0xbf35bf80,0xbf35bf80,0x3f0ebec4,0x3f553f6d,0xbf0e3ec4,0xbf55bf6d
.long 0x3f6d3f35,0xbf6dbf35,0x3f6d3f35,0xbf6dbf35,0xbe483f6d,0x3f7b3ec4,0x3e48bf6d,0xbf7bbec4
.long 0xbf800000,0xbf800000,0xbf800000,0xbf800000,0xbe48bf6d,0x3f7bbec4,0x3e483f6d,0xbf7b3ec4
.long 0x3f6dbf35,0xbf6d3f35,0x3f6dbf35,0xbf6d3f35,0x3f0e3ec4,0x3f55bf6d,0xbf0ebec4,0xbf553f6d
.long 0xbf353f80,0xbf353f80,0xbf353f80,0xbf353f80,0xbf553ec4,0x3f0ebf6d,0x3f55bec4,0xbf0e3f6d
.long 0x3ec4bf35,0xbec43f35,0x3ec4bf35,0xbec43f35,0x3f7bbf6d,0x3e48bec4,0xbf7b3f6d,0xbe483ec4
.long 0x0,0x0,0x0,0x0,0xbe480000,0xbf7b3f80,0x3e480000,0x3f7bbf80
.long 0xbec40000,0x3ec40000,0xbec40000,0x3ec40000,0xbf0e0000,0x3f55bf80,0x3f0e0000,0xbf553f80
.long 0xbf350000,0xbf350000,0xbf350000,0xbf350000,0xbf550000,0xbf0e3f80,0x3f550000,0x3f0ebf80
.long 0xbf6d0000,0x3f6d0000,0xbf6d0000,0x3f6d0000,0xbf7b0000,0x3e48bf80,0x3f7b0000,0xbe483f80
.long 0xbf800000,0xbf800000,0xbf800000,0xbf800000,0xbf7b0000,0x3e483f80,0x3f7b0000,0xbe48bf80
.long 0xbf6d0000,0x3f6d0000,0xbf6d0000,0x3f6d0000,0xbf550000,0xbf0ebf80,0x3f550000,0x3f0e3f80
.long 0xbf350000,0xbf350000,0xbf350000,0xbf350000,0xbf0e0000,0x3f553f80,0x3f0e0000,0xbf55bf80
.long 0xbec40000,0x3ec40000,0xbec40000,0x3ec40000,0xbe480000,0xbf7bbf80,0x3e480000,0x3f7b3f80
.long 0x0,0x0,0x0,0x0,0xbf0e3ec4,0xbf553f6d,0x3f0ebec4,0x3f55bf6d
.long 0xbf6d3f35,0x3f6dbf35,0xbf6d3f35,0x3f6dbf35,0xbf7b3f6d,0xbe48bec4,0x3f7bbf6d,0x3e483ec4
.long 0xbf353f80,0xbf353f80,0xbf353f80,0xbf353f80,0xbe483f6d,0x3f7bbec4,0x3e48bf6d,0xbf7b3ec4
.long 0x3ec43f35,0xbec4bf35,0x3ec43f35,0xbec4bf35,0x3f553ec4,0xbf0e3f6d,0xbf55bec4,0x3f0ebf6d
.long 0x3f800000,0x3f800000,0x3f800000,0x3f800000,0x3f55bec4,0xbf0ebf6d,0xbf553ec4,0x3f0e3f6d
.long 0x3ec4bf35,0xbec43f35,0x3ec4bf35,0xbec43f35,0xbe48bf6d,0x3f7b3ec4,0x3e483f6d,0xbf7bbec4
.long 0xbf35bf80,0xbf35bf80,0xbf35bf80,0xbf35bf80,0xbf7bbf6d,0xbe483ec4,0x3f7b3f6d,0x3e48bec4
.long 0xbf6dbf35,0x3f6d3f35,0xbf6dbf35,0x3f6d3f35,0xbf0ebec4,0xbf55bf6d,0x3f0e3ec4,0x3f553f6d
.long 0x0,0x0,0x0,0x0,0xbf553f35,0xbf0e3f35,0x3f55bf35,0x3f0ebf35
.long 0xbf6d3f80,0x3f6dbf80,0xbf6d3f80,0x3f6dbf80,0xbe483f35,0xbf7b3f35,0x3e48bf35,0x3f7bbf35
.long 0x3f350000,0x3f350000,0x3f350000,0x3f350000,0x3f7bbf35,0xbe48bf35,0xbf7b3f35,0x3e483f35
.long 0x3ec4bf80,0xbec43f80,0x3ec4bf80,0xbec43f80,0xbf0ebf35,0x3f55bf35,0x3f0e3f35,0xbf553f35
.long 0xbf800000,0xbf800000,0xbf800000,0xbf800000,0xbf0e3f35,0x3f553f35,0x3f0ebf35,0xbf55bf35
.long 0x3ec43f80,0xbec4bf80,0x3ec43f80,0xbec4bf80,0x3f7b3f35,0xbe483f35,0xbf7bbf35,0x3e48bf35
.long 0x3f350000,0x3f350000,0x3f350000,0x3f350000,0xbe48bf35,0xbf7bbf35,0x3e483f35,0x3f7b3f35
.long 0xbf6dbf80,0x3f6d3f80,0xbf6dbf80,0x3f6d3f80,0xbf55bf35,0xbf0ebf35,0x3f553f35,0x3f0e3f35
.long 0x0,0x0,0x0,0x0,0xbf7b3f6d,0xbe483ec4,0x3f7bbf6d,0x3e48bec4
.long 0xbec43f35,0x3ec4bf35,0xbec43f35,0x3ec4bf35,0x3f55bec4,0xbf0e3f6d,0xbf553ec4,0x3f0ebf6d
.long 0x3f35bf80,0x3f35bf80,0x3f35bf80,0x3f35bf80,0xbf0ebec4,0xbf553f6d,0x3f0e3ec4,0x3f55bf6d
.long 0xbf6d3f35,0x3f6dbf35,0xbf6d3f35,0x3f6dbf35,0x3e483f6d,0xbf7b3ec4,0xbe48bf6d,0x3f7bbec4
.long 0x3f800000,0x3f800000,0x3f800000,0x3f800000,0x3e48bf6d,0xbf7bbec4,0xbe483f6d,0x3f7b3ec4
.long 0xbf6dbf35,0x3f6d3f35,0xbf6dbf35,0x3f6d3f35,0xbf0e3ec4,0xbf55bf6d,0x3f0ebec4,0x3f553f6d
.long 0x3f353f80,0x3f353f80,0x3f353f80,0x3f353f80,0x3f553ec4,0xbf0ebf6d,0xbf55bec4,0x3f0e3f6d
.long 0xbec4bf35,0x3ec43f35,0xbec4bf35,0x3ec43f35,0xbf7bbf6d,0xbe48bec4,0x3f7b3f6d,0x3e483ec4
.long 0x3f803f80,0x3f803f80,0x3f803f80,0x3f803f80,0x3f7b3f80,0x3f553f6d,0xbf7bbf80,0xbf55bf6d
.long 0x3f6d3f80,0x3ec43f35,0x3f6d3f80,0x3ec43f35,0x3f553f80,0xbe483ec4,0xbf55bf80,0x3e48bec4
.long 0x3f353f80,0xbf350000,0x3f353f80,0xbf350000,0x3f0e3f80,0xbf7bbec4,0xbf0ebf80,0x3f7b3ec4
.long 0x3ec43f80,0xbf6dbf35,0x3ec43f80,0xbf6dbf35,0x3e483f80,0xbf0ebf6d,0xbe48bf80,0x3f0e3f6d
.long 0x3f80,0xbf80,0x3f80,0xbf80,0xbe483f80,0x3f0ebf6d,0x3e48bf80,0xbf0e3f6d
.long 0xbec43f80,0x3f6dbf35,0xbec43f80,0x3f6dbf35,0xbf0e3f80,0x3f7bbec4,0x3f0ebf80,0xbf7b3ec4
.long 0xbf353f80,0x3f350000,0xbf353f80,0x3f350000,0xbf553f80,0x3e483ec4,0x3f55bf80,0xbe48bec4
.long 0xbf6d3f80,0xbec43f35,0xbf6d3f80,0xbec43f35,0xbf7b3f80,0xbf553f6d,0x3f7bbf80,0x3f55bf6d
.long 0x3f803f80,0x3f803f80,0x3f803f80,0x3f803f80,0x3f0e3f35,0x3e483ec4,0xbf0ebf35,0xbe48bec4
.long 0xbec40000,0xbf6dbf35,0xbec40000,0xbf6dbf35,0xbf7bbf35,0xbf0ebf6d,0x3f7b3f35,0x3f0e3f6d
.long 0xbf35bf80,0x3f350000,0xbf35bf80,0x3f350000,0x3e48bf35,0x3f553f6d,0xbe483f35,0xbf55bf6d
.long 0x3f6d0000,0xbec43f35,0x3f6d0000,0xbec43f35,0x3f553f35,0xbf7bbec4,0xbf55bf35,0x3f7b3ec4
.long 0x3f80,0xbf80,0x3f80,0xbf80,0xbf553f35,0x3f7bbec4,0x3f55bf35,0xbf7b3ec4
.long 0xbf6d0000,0x3ec43f35,0xbf6d0000,0x3ec43f35,0xbe48bf35,0xbf553f6d,0x3e483f35,0x3f55bf6d
.long 0x3f35bf80,0xbf350000,0x3f35bf80,0xbf350000,0x3f7bbf35,0x3f0ebf6d,0xbf7b3f35,0xbf0e3f6d
.long 0x3ec40000,0x3f6dbf35,0x3ec40000,0x3f6dbf35,0xbf0e3f35,0xbe483ec4,0x3f0ebf35,0x3e48bec4
.long 0x3f803f80,0x3f803f80,0x3f803f80,0x3f803f80,0xbe480000,0xbf0ebec4,0x3e480000,0x3f0e3ec4
.long 0xbf6dbf80,0xbec4bf35,0xbf6dbf80,0xbec4bf35,0x3f0e0000,0x3f7b3f6d,0xbf0e0000,0xbf7bbf6d
.long 0x3f353f80,0xbf350000,0x3f353f80,0xbf350000,0xbf550000,0xbe48bf6d,0x3f550000,0x3e483f6d
.long 0xbec4bf80,0x3f6d3f35,0xbec4bf80,0x3f6d3f35,0x3f7b0000,0xbf553ec4,0xbf7b0000,0x3f55bec4
.long 0x3f80,0xbf80,0x3f80,0xbf80,0xbf7b0000,0x3f553ec4,0x3f7b0000,0xbf55bec4
.long 0x3ec4bf80,0xbf6d3f35,0x3ec4bf80,0xbf6d3f35,0x3f550000,0x3e48bf6d,0xbf550000,0xbe483f6d
.long 0xbf353f80,0x3f350000,0xbf353f80,0x3f350000,0xbf0e0000,0xbf7b3f6d,0x3f0e0000,0x3f7bbf6d
.long 0x3f6dbf80,0x3ec4bf35,0x3f6dbf80,0x3ec4bf35,0x3e480000,0x3f0ebec4,0xbe480000,0xbf0e3ec4
.long 0x3f803f80,0x3f803f80,0x3f803f80,0x3f803f80,0xbf55bf35,0xbf7bbf6d,0x3f553f35,0x3f7b3f6d
.long 0x3ec40000,0x3f6d3f35,0x3ec40000,0x3f6d3f35,0x3e483f35,0xbf55bec4,0xbe48bf35,0x3f553ec4
.long 0xbf35bf80,0x3f350000,0xbf35bf80,0x3f350000,0x3f7b3f35,0xbf0e3ec4,0xbf7bbf35,0x3f0ebec4
.long 0xbf6d0000,0x3ec4bf35,0xbf6d0000,0x3ec4bf35,0x3f0ebf35,0xbe483f6d,0xbf0e3f35,0x3e48bf6d
.long 0x3f80,0xbf80,0x3f80,0xbf80,0xbf0ebf35,0x3e483f6d,0x3f0e3f35,0xbe48bf6d
.long 0x3f6d0000,0xbec4bf35,0x3f6d0000,0xbec4bf35,0xbf7b3f35,0x3f0e3ec4,0x3f7bbf35,0xbf0ebec4
.long 0x3f35bf80,0xbf350000,0x3f35bf80,0xbf350000,0xbe483f35,0x3f55bec4,0x3e48bf35,0xbf553ec4
.long 0xbec40000,0xbf6d3f35,0xbec40000,0xbf6d3f35,0x3f55bf35,0x3f7bbf6d,0xbf553f35,0xbf7b3f6d
.long 0xbf803f80,0xbf803f80,0xbf803f80,0xbf803f80,0xbf7b3f80,0xbf553f6d,0x3f7bbf80,0x3f55bf6d
.long 0xbf6d3f80,0xbec43f35,0xbf6d3f80,0xbec43f35,0xbf553f80,0x3e483ec4,0x3f55bf80,0xbe48bec4
.long 0xbf353f80,0x3f350000,0xbf353f80,0x3f350000,0xbf0e3f80,0x3f7bbec4,0x3f0ebf80,0xbf7b3ec4
.long 0xbec43f80,0x3f6dbf35,0xbec43f80,0x3f6dbf35,0xbe483f80,0x3f0ebf6d,0x3e48bf80,0xbf0e3f6d
.long 0x3f80,0xbf80,0x3f80,0xbf80,0x3e483f80,0xbf0ebf6d,0xbe48bf80,0x3f0e3f6d
.long 0x3ec43f80,0xbf6dbf35,0x3ec43f80,0xbf6dbf35,0x3f0e3f80,0xbf7bbec4,0xbf0ebf80,0x3f7b3ec4
.long 0x3f353f80,0xbf350000,0x3f353f80,0xbf350000,0x3f553f80,0xbe483ec4,0xbf55bf80,0x3e48bec4
.long 0x3f6d3f80,0x3ec43f35,0x3f6d3f80,0x3ec43f35,0x3f7b3f80,0x3f553f6d,0xbf7bbf80,0xbf55bf6d
.long 0xbf803f80,0xbf803f80,0xbf803f80,0xbf803f80,0xbf0e3f35,0xbe483ec4,0x3f0ebf35,0x3e48bec4
.long 0x3ec40000,0x3f6dbf35,0x3ec40000,0x3f6dbf35,0x3f7bbf35,0x3f0ebf6d,0xbf7b3f35,0xbf0e3f6d
.long 0x3f35bf80,0xbf350000,0x3f35bf80,0xbf350000,0xbe48bf35,0xbf553f6d,0x3e483f35,0x3f55bf6d
.long 0xbf6d0000,0x3ec43f35,0xbf6d0000,0x3ec43f35,0xbf553f35,0x3f7bbec4,0x3f55bf35,0xbf7b3ec4
.long 0x3f80,0xbf80,0x3f80,0xbf80,0x3f553f35,0xbf7bbec4,0xbf55bf35,0x3f7b3ec4
.long 0x3f6d0000,0xbec43f35,0x3f6d0000,0xbec43f35,0x3e48bf35,0x3f553f6d,0xbe483f35,0xbf55bf6d
.long 0xbf35bf80,0x3f350000,0xbf35bf80,0x3f350000,0xbf7bbf35,0xbf0ebf6d,0x3f7b3f35,0x3f0e3f6d
.long 0xbec40000,0xbf6dbf35,0xbec40000,0xbf6dbf35,0x3f0e3f35,0x3e483ec4,0xbf0ebf35,0xbe48bec4
.long 0xbf803f80,0xbf803f80,0xbf803f80,0xbf803f80,0x3e480000,0x3f0ebec4,0xbe480000,0xbf0e3ec4
.long 0x3f6dbf80,0x3ec4bf35,0x3f6dbf80,0x3ec4bf35,0xbf0e0000,0xbf7b3f6d,0x3f0e0000,0x3f7bbf6d
.long 0xbf353f80,0x3f350000,0xbf353f80,0x3f350000,0x3f550000,0x3e48bf6d,0xbf550000,0xbe483f6d
.long 0x3ec4bf80,0xbf6d3f35,0x3ec4bf80,0xbf6d3f35,0xbf7b0000,0x3f553ec4,0x3f7b0000,0xbf55bec4
.long 0x3f80,0xbf80,0x3f80,0xbf80,0x3f7b0000,0xbf553ec4,0xbf7b0000,0x3f55bec4
.long 0xbec4bf80,0x3f6d3f35,0xbec4bf80,0x3f6d3f35,0xbf550000,0xbe48bf6d,0x3f550000,0x3e483f6d
.long 0x3f353f80,0xbf350000,0x3f353f80,0xbf350000,0x3f0e0000,0x3f7b3f6d,0xbf0e0000,0xbf7bbf6d
.long 0xbf6dbf80,0xbec4bf35,0xbf6dbf80,0xbec4bf35,0xbe480000,0xbf0ebec4,0x3e480000,0x3f0e3ec4
.long 0xbf803f80,0xbf803f80,0xbf803f80,0xbf803f80,0x3f55bf35,0x3f7bbf6d,0xbf553f35,0xbf7b3f6d
.long 0xbec40000,0xbf6d3f35,0xbec40000,0xbf6d3f35,0xbe483f35,0x3f55bec4,0x3e48bf35,0xbf553ec4
.long 0x3f35bf80,0xbf350000,0x3f35bf80,0xbf350000,0xbf7b3f35,0x3f0e3ec4,0x3f7bbf35,0xbf0ebec4
.long 0x3f6d0000,0xbec4bf35,0x3f6d0000,0xbec4bf35,0xbf0ebf35,0x3e483f6d,0x3f0e3f35,0xbe48bf6d
.long 0x3f80,0xbf80,0x3f80,0xbf80,0x3f0ebf35,0xbe483f6d,0xbf0e3f35,0x3e48bf6d
.long 0xbf6d0000,0x3ec4bf35,0xbf6d0000,0x3ec4bf35,0x3f7b3f35,0xbf0e3ec4,0xbf7bbf35,0x3f0ebec4
.long 0xbf35bf80,0x3f350000,0xbf35bf80,0x3f350000,0x3e483f35,0xbf55bec4,0xbe48bf35,0x3f553ec4
.long 0x3ec40000,0x3f6d3f35,0x3ec40000,0x3f6d3f35,0xbf55bf35,0xbf7bbf6d,0x3f553f35,0x3f7b3f6d
.long 0x0,0x0,0x0,0x0,0x3e480000,0x3f0e3ec4,0xbe480000,0xbf0ebec4
.long 0x3ec40000,0x3f6d3f35,0x3ec40000,0x3f6d3f35,0x3f0e0000,0x3f7b3f6d,0xbf0e0000,0xbf7bbf6d
.long 0x3f350000,0x3f353f80,0x3f350000,0x3f353f80,0x3f550000,0x3e483f6d,0xbf550000,0xbe48bf6d
.long 0x3f6d0000,0xbec43f35,0x3f6d0000,0xbec43f35,0x3f7b0000,0xbf553ec4,0xbf7b0000,0x3f55bec4
.long 0x3f800000,0xbf800000,0x3f800000,0xbf800000,0x3f7b0000,0xbf55bec4,0xbf7b0000,0x3f553ec4
.long 0x3f6d0000,0xbec4bf35,0x3f6d0000,0xbec4bf35,0x3f550000,0x3e48bf6d,0xbf550000,0xbe483f6d
.long 0x3f350000,0x3f35bf80,0x3f350000,0x3f35bf80,0x3f0e0000,0x3f7bbf6d,0xbf0e0000,0xbf7b3f6d
.long 0x3ec40000,0x3f6dbf35,0x3ec40000,0x3f6dbf35,0x3e480000,0x3f0ebec4,0xbe480000,0xbf0e3ec4
.long 0x0,0x0,0x0,0x0,0x3f553f35,0x3f7b3f6d,0xbf55bf35,0xbf7bbf6d
.long 0x3f6d3f80,0x3ec43f35,0x3f6d3f80,0x3ec43f35,0x3e483f35,0xbf55bec4,0xbe48bf35,0x3f553ec4
.long 0xbf350000,0xbf35bf80,0xbf350000,0xbf35bf80,0xbf7bbf35,0x3f0ebec4,0x3f7b3f35,0xbf0e3ec4
.long 0xbec4bf80,0x3f6d3f35,0xbec4bf80,0x3f6d3f35,0x3f0ebf35,0xbe483f6d,0xbf0e3f35,0x3e48bf6d
.long 0x3f800000,0xbf800000,0x3f800000,0xbf800000,0x3f0e3f35,0xbe48bf6d,0xbf0ebf35,0x3e483f6d
.long 0xbec43f80,0x3f6dbf35,0xbec43f80,0x3f6dbf35,0xbf7b3f35,0x3f0e3ec4,0x3f7bbf35,0xbf0ebec4
.long 0xbf350000,0xbf353f80,0xbf350000,0xbf353f80,0x3e48bf35,0xbf553ec4,0xbe483f35,0x3f55bec4
.long 0x3f6dbf80,0x3ec4bf35,0x3f6dbf80,0x3ec4bf35,0x3f55bf35,0x3f7bbf6d,0xbf553f35,0xbf7b3f6d
.long 0x0,0x0,0x0,0x0,0x3f7b3f80,0x3f553f6d,0xbf7bbf80,0xbf55bf6d
.long 0xbec40000,0xbf6dbf35,0xbec40000,0xbf6dbf35,0xbf55bf80,0x3e48bec4,0x3f553f80,0xbe483ec4
.long 0x3f350000,0x3f353f80,0x3f350000,0x3f353f80,0x3f0e3f80,0xbf7bbec4,0xbf0ebf80,0x3f7b3ec4
.long 0xbf6d0000,0x3ec4bf35,0xbf6d0000,0x3ec4bf35,0xbe48bf80,0x3f0e3f6d,0x3e483f80,0xbf0ebf6d
.long 0x3f800000,0xbf800000,0x3f800000,0xbf800000,0xbe483f80,0x3f0ebf6d,0x3e48bf80,0xbf0e3f6d
.long 0xbf6d0000,0x3ec43f35,0xbf6d0000,0x3ec43f35,0x3f0ebf80,0xbf7b3ec4,0xbf0e3f80,0x3f7bbec4
.long 0x3f350000,0x3f35bf80,0x3f350000,0x3f35bf80,0xbf553f80,0x3e483ec4,0x3f55bf80,0xbe48bec4
.long 0xbec40000,0xbf6d3f35,0xbec40000,0xbf6d3f35,0x3f7bbf80,0x3f55bf6d,0xbf7b3f80,0xbf553f6d
.long 0x0,0x0,0x0,0x0,0x3f0e3f35,0x3e483ec4,0xbf0ebf35,0xbe48bec4
.long 0xbf6dbf80,0xbec4bf35,0xbf6dbf80,0xbec4bf35,0x3f7b3f35,0x3f0e3f6d,0xbf7bbf35,0xbf0ebf6d
.long 0xbf350000,0xbf35bf80,0xbf350000,0xbf35bf80,0x3e48bf35,0x3f553f6d,0xbe483f35,0xbf55bf6d
.long 0x3ec43f80,0xbf6dbf35,0x3ec43f80,0xbf6dbf35,0xbf55bf35,0x3f7b3ec4,0x3f553f35,0xbf7bbec4
.long 0x3f800000,0xbf800000,0x3f800000,0xbf800000,0xbf553f35,0x3f7bbec4,0x3f55bf35,0xbf7b3ec4
.long 0x3ec4bf80,0xbf6d3f35,0x3ec4bf80,0xbf6d3f35,0x3e483f35,0x3f55bf6d,0xbe48bf35,0xbf553f6d
.long 0xbf350000,0xbf353f80,0xbf350000,0xbf353f80,0x3f7bbf35,0x3f0ebf6d,0xbf7b3f35,0xbf0e3f6d
.long 0xbf6d3f80,0xbec43f35,0xbf6d3f80,0xbec43f35,0x3f0ebf35,0x3e48bec4,0xbf0e3f35,0xbe483ec4
.long 0x0,0x0,0x0,0x0,0xbe480000,0xbf0e3ec4,0x3e480000,0x3f0ebec4
.long 0xbec40000,0xbf6d3f35,0xbec40000,0xbf6d3f35,0xbf0e0000,0xbf7b3f6d,0x3f0e0000,0x3f7bbf6d
.long 0xbf350000,0xbf353f80,0xbf350000,0xbf353f80,0xbf550000,0xbe483f6d,0x3f550000,0x3e48bf6d
.long 0xbf6d0000,0x3ec43f35,0xbf6d0000,0x3ec43f35,0xbf7b0000,0x3f553ec4,0x3f7b0000,0xbf55bec4
.long 0xbf800000,0x3f800000,0xbf800000,0x3f800000,0xbf7b0000,0x3f55bec4,0x3f7b0000,0xbf553ec4
.long 0xbf6d0000,0x3ec4bf35,0xbf6d0000,0x3ec4bf35,0xbf550000,0xbe48bf6d,0x3f550000,0x3e483f6d
.long 0xbf350000,0xbf35bf80,0xbf350000,0xbf35bf80,0xbf0e0000,0xbf7bbf6d,0x3f0e0000,0x3f7b3f6d
.long 0xbec40000,0xbf6dbf35,0xbec40000,0xbf6dbf35,0xbe480000,0xbf0ebec4,0x3e480000,0x3f0e3ec4
.long 0x0,0x0,0x0,0x0,0xbf553f35,0xbf7b3f6d,0x3f55bf35,0x3f7bbf6d
.long 0xbf6d3f80,0xbec43f35,0xbf6d3f80,0xbec43f35,0xbe483f35,0x3f55bec4,0x3e48bf35,0xbf553ec4
.long 0x3f350000,0x3f35bf80,0x3f350000,0x3f35bf80,0x3f7bbf35,0xbf0ebec4,0xbf7b3f35,0x3f0e3ec4
.long 0x3ec4bf80,0xbf6d3f35,0x3ec4bf80,0xbf6d3f35,0xbf0ebf35,0x3e483f6d,0x3f0e3f35,0xbe48bf6d
.long 0xbf800000,0x3f800000,0xbf800000,0x3f800000,0xbf0e3f35,0x3e48bf6d,0x3f0ebf35,0xbe483f6d
.long 0x3ec43f80,0xbf6dbf35,0x3ec43f80,0xbf6dbf35,0x3f7b3f35,0xbf0e3ec4,0xbf7bbf35,0x3f0ebec4
.long 0x3f350000,0x3f353f80,0x3f350000,0x3f353f80,0xbe48bf35,0x3f553ec4,0x3e483f35,0xbf55bec4
.long 0xbf6dbf80,0xbec4bf35,0xbf6dbf80,0xbec4bf35,0xbf55bf35,0xbf7bbf6d,0x3f553f35,0x3f7b3f6d
.long 0x0,0x0,0x0,0x0,0xbf7b3f80,0xbf553f6d,0x3f7bbf80,0x3f55bf6d
.long 0x3ec40000,0x3f6dbf35,0x3ec40000,0x3f6dbf35,0x3f55bf80,0xbe48bec4,0xbf553f80,0x3e483ec4
.long 0xbf350000,0xbf353f80,0xbf350000,0xbf353f80,0xbf0e3f80,0x3f7bbec4,0x3f0ebf80,0xbf7b3ec4
.long 0x3f6d0000,0xbec4bf35,0x3f6d0000,0xbec4bf35,0x3e48bf80,0xbf0e3f6d,0xbe483f80,0x3f0ebf6d
.long 0xbf800000,0x3f800000,0xbf800000,0x3f800000,0x3e483f80,0xbf0ebf6d,0xbe48bf80,0x3f0e3f6d
.long 0x3f6d0000,0xbec43f35,0x3f6d0000,0xbec43f35,0xbf0ebf80,0x3f7b3ec4,0x3f0e3f80,0xbf7bbec4
.long 0xbf350000,0xbf35bf80,0xbf350000,0xbf35bf80,0x3f553f80,0xbe483ec4,0xbf55bf80,0x3e48bec4
.long 0x3ec40000,0x3f6d3f35,0x3ec40000,0x3f6d3f35,0xbf7bbf80,0xbf55bf6d,0x3f7b3f80,0x3f553f6d
.long 0x0,0x0,0x0,0x0,0xbf0e3f35,0xbe483ec4,0x3f0ebf35,0x3e48bec4
.long 0x3f6dbf80,0x3ec4bf35,0x3f6dbf80,0x3ec4bf35,0xbf7b3f35,0xbf0e3f6d,0x3f7bbf35,0x3f0ebf6d
.long 0x3f350000,0x3f35bf80,0x3f350000,0x3f35bf80,0xbe48bf35,0xbf553f6d,0x3e483f35,0x3f55bf6d
.long 0xbec43f80,0x3f6dbf35,0xbec43f80,0x3f6dbf35,0x3f55bf35,0xbf7b3ec4,0xbf553f35,0x3f7bbec4
.long 0xbf800000,0x3f800000,0xbf800000,0x3f800000,0x3f553f35,0xbf7bbec4,0xbf55bf35,0x3f7b3ec4
.long 0xbec4bf80,0x3f6d3f35,0xbec4bf80,0x3f6d3f35,0xbe483f35,0xbf55bf6d,0x3e48bf35,0x3f553f6d
.long 0x3f350000,0x3f353f80,0x3f350000,0x3f353f80,0xbf7bbf35,0xbf0ebf6d,0x3f7b3f35,0x3f0e3f6d
.long 0x3f6d3f80,0x3ec43f35,0x3f6d3f80,0x3ec43f35,0xbf0ebf35,0xbe48bec4,0x3f0e3f35,0x3e483ec4
.set C0, 0x3f80
.set C1, 0x3f80
.set C2, 0x3f80
.set C3, 0x3f80
.set C4, 0x3f80
.set C5, 0x3f7f
.set C6, 0x3f7f
.set C7, 0x3f7f
.set C8, 0x3f7e
.set C9, 0x3f7e
.set C10, 0x3f7d
.set C11, 0x3f7d
.set C12, 0x3f7c
.set C13, 0x3f7c
.set C14, 0x3f7b
.set C15, 0x3f7a
.set C16, 0x3f7a
.set C17, 0x3f79
.set C18, 0x3f78
.set C19, 0x3f77
.set C20, 0x3f76
.set C21, 0x3f75
.set C22, 0x3f74
.set C23, 0x3f73
.set C24, 0x3f72
.set C25, 0x3f70
.set C26, 0x3f6f
.set C27, 0x3f6e
.set C28, 0x3f6d
.set C29, 0x3f6b
.set C30, 0x3f6a
.set C31, 0x3f68
.set C32, 0x3f67
.set C33, 0x3f65
.set C34, 0x3f63
.set C35, 0x3f62
.set C36, 0x3f60
.set C37, 0x3f5e
.set C38, 0x3f5c
.set C39, 0x3f5b
.set C40, 0x3f59
.set C41, 0x3f57
.set C42, 0x3f55
.set C43, 0x3f53
.set C44, 0x3f51
.set C45, 0x3f4f
.set C46, 0x3f4d
.set C47, 0x3f4a
.set C48, 0x3f48
.set C49, 0x3f46
.set C50, 0x3f44
.set C51, 0x3f41
.set C52, 0x3f3f
.set C53, 0x3f3c
.set C54, 0x3f3a
.set C55, 0x3f38
.set C56, 0x3f35
.set C57, 0x3f32
.set C58, 0x3f30
.set C59, 0x3f2d
.set C60, 0x3f2b
.set C61, 0x3f28
.set C62, 0x3f25
.set C63, 0x3f22
.set C64, 0x3f20
.set C65, 0x3f1d
.set C66, 0x3f1a
.set C67, 0x3f17
.set C68, 0x3f14
.set C69, 0x3f11
.set C70, 0x3f0e
.set C71, 0x3f0b
.set C72, 0x3f08
.set C73, 0x3f05
.set C74, 0x3f02
.set C75, 0x3efe
.set C76, 0x3ef8
.set C77, 0x3ef1
.set C78, 0x3eeb
.set C79, 0x3ee5
.set C80, 0x3ede
.set C81, 0x3ed8
.set C82, 0x3ed1
.set C83, 0x3ecb
.set C84, 0x3ec4
.set C85, 0x3ebd
.set C86, 0x3eb7
.set C87, 0x3eb0
.set C88, 0x3ea9
.set C89, 0x3ea2
.set C90, 0x3e9b
.set C91, 0x3e95
.set C92, 0x3e8e
.set C93, 0x3e87
.set C94, 0x3e80
.set C95, 0x3e72
.set C96, 0x3e64
.set C97, 0x3e56
.set C98, 0x3e48
.set C99, 0x3e3a
.set C100, 0x3e2c
.set C101, 0x3e1d
.set C102, 0x3e0f
.set C103, 0x3e01
.set C104, 0x3de5
.set C105, 0x3dc9
.set C106, 0x3dac
.set C107, 0x3d8f
.set C108, 0x3d66
.set C109, 0x3d2c
.set C110, 0x3ce6
.set C111, 0x3c66
.set C112, 0x0
.set C113, 0xbc66
.set C114, 0xbce6
.set C115, 0xbd2c
.set C116, 0xbd66
.set C117, 0xbd8f
.set C118, 0xbdac
.set C119, 0xbdc9
.set C120, 0xbde5
.set C121, 0xbe01
.set C122, 0xbe0f
.set C123, 0xbe1d
.set C124, 0xbe2c
.set C125, 0xbe3a
.set C126, 0xbe48
.set C127, 0xbe56
.set C128, 0xbe64
.set C129, 0xbe72
.set C130, 0xbe80
.set C131, 0xbe87
.set C132, 0xbe8e
.set C133, 0xbe95
.set C134, 0xbe9b
.set C135, 0xbea2
.set C136, 0xbea9
.set C137, 0xbeb0
.set C138, 0xbeb7
.set C139, 0xbebd
.set C140, 0xbec4
.set C141, 0xbecb
.set C142, 0xbed1
.set C143, 0xbed8
.set C144, 0xbede
.set C145, 0xbee5
.set C146, 0xbeeb
.set C147, 0xbef1
.set C148, 0xbef8
.set C149, 0xbefe
.set C150, 0xbf02
.set C151, 0xbf05
.set C152, 0xbf08
.set C153, 0xbf0b
.set C154, 0xbf0e
.set C155, 0xbf11
.set C156, 0xbf14
.set C157, 0xbf17
.set C158, 0xbf1a
.set C159, 0xbf1d
.set C160, 0xbf20
.set C161, 0xbf22
.set C162, 0xbf25
.set C163, 0xbf28
.set C164, 0xbf2b
.set C165, 0xbf2d
.set C166, 0xbf30
.set C167, 0xbf32
.set C168, 0xbf35
.set C169, 0xbf38
.set C170, 0xbf3a
.set C171, 0xbf3c
.set C172, 0xbf3f
.set C173, 0xbf41
.set C174, 0xbf44
.set C175, 0xbf46
.set C176, 0xbf48
.set C177, 0xbf4a
.set C178, 0xbf4d
.set C179, 0xbf4f
.set C180, 0xbf51
.set C181, 0xbf53
.set C182, 0xbf55
.set C183, 0xbf57
.set C184, 0xbf59
.set C185, 0xbf5b
.set C186, 0xbf5c
.set C187, 0xbf5e
.set C188, 0xbf60
.set C189, 0xbf62
.set C190, 0xbf63
.set C191, 0xbf65
.set C192, 0xbf67
.set C193, 0xbf68
.set C194, 0xbf6a
.set C195, 0xbf6b
.set C196, 0xbf6d
.set C197, 0xbf6e
.set C198, 0xbf6f
.set C199, 0xbf70
.set C200, 0xbf72
.set C201, 0xbf73
.set C202, 0xbf74
.set C203, 0xbf75
.set C204, 0xbf76
.set C205, 0xbf77
.set C206, 0xbf78
.set C207, 0xbf79
.set C208, 0xbf7a
.set C209, 0xbf7a
.set C210, 0xbf7b
.set C211, 0xbf7c
.set C212, 0xbf7c
.set C213, 0xbf7d
.set C214, 0xbf7d
.set C215, 0xbf7e
.set C216, 0xbf7e
.set C217, 0xbf7f
.set C218, 0xbf7f
.set C219, 0xbf7f
.set C220, 0xbf80
.set C221, 0xbf80
.set C222, 0xbf80
.set C223, 0xbf80
.set C224, 0xbf80
.set C225, 0xbf80
.set C226, 0xbf80
.set C227, 0xbf80
.set C228, 0xbf80
.set C229, 0xbf7f
.set C230, 0xbf7f
.set C231, 0xbf7f
.set C232, 0xbf7e
.set C233, 0xbf7e
.set C234, 0xbf7d
.set C235, 0xbf7d
.set C236, 0xbf7c
.set C237, 0xbf7c
.set C238, 0xbf7b
.set C239, 0xbf7a
.set C240, 0xbf7a
.set C241, 0xbf79
.set C242, 0xbf78
.set C243, 0xbf77
.set C244, 0xbf76
.set C245, 0xbf75
.set C246, 0xbf74
.set C247, 0xbf73
.set C248, 0xbf72
.set C249, 0xbf70
.set C250, 0xbf6f
.set C251, 0xbf6e
.set C252, 0xbf6d
.set C253, 0xbf6b
.set C254, 0xbf6a
.set C255, 0xbf68
.set C256, 0xbf67
.set C257, 0xbf65
.set C258, 0xbf63
.set C259, 0xbf62
.set C260, 0xbf60
.set C261, 0xbf5e
.set C262, 0xbf5c
.set C263, 0xbf5b
.set C264, 0xbf59
.set C265, 0xbf57
.set C266, 0xbf55
.set C267, 0xbf53
.set C268, 0xbf51
.set C269, 0xbf4f
.set C270, 0xbf4d
.set C271, 0xbf4a
.set C272, 0xbf48
.set C273, 0xbf46
.set C274, 0xbf44
.set C275, 0xbf41
.set C276, 0xbf3f
.set C277, 0xbf3c
.set C278, 0xbf3a
.set C279, 0xbf38
.set C280, 0xbf35
.set C281, 0xbf32
.set C282, 0xbf30
.set C283, 0xbf2d
.set C284, 0xbf2b
.set C285, 0xbf28
.set C286, 0xbf25
.set C287, 0xbf22
.set C288, 0xbf20
.set C289, 0xbf1d
.set C290, 0xbf1a
.set C291, 0xbf17
.set C292, 0xbf14
.set C293, 0xbf11
.set C294, 0xbf0e
.set C295, 0xbf0b
.set C296, 0xbf08
.set C297, 0xbf05
.set C298, 0xbf02
.set C299, 0xbefe
.set C300, 0xbef8
.set C301, 0xbef1
.set C302, 0xbeeb
.set C303, 0xbee5
.set C304, 0xbede
.set C305, 0xbed8
.set C306, 0xbed1
.set C307, 0xbecb
.set C308, 0xbec4
.set C309, 0xbebd
.set C310, 0xbeb7
.set C311, 0xbeb0
.set C312, 0xbea9
.set C313, 0xbea2
.set C314, 0xbe9b
.set C315, 0xbe95
.set C316, 0xbe8e
.set C317, 0xbe87
.set C318, 0xbe80
.set C319, 0xbe72
.set C320, 0xbe64
.set C321, 0xbe56
.set C322, 0xbe48
.set C323, 0xbe3a
.set C324, 0xbe2c
.set C325, 0xbe1d
.set C326, 0xbe0f
.set C327, 0xbe01
.set C328, 0xbde5
.set C329, 0xbdc9
.set C330, 0xbdac
.set C331, 0xbd8f
.set C332, 0xbd66
.set C333, 0xbd2c
.set C334, 0xbce6
.set C335, 0xbc66
.set C336, 0x0
.set C337, 0x3c66
.set C338, 0x3ce6
.set C339, 0x3d2c
.set C340, 0x3d66
.set C341, 0x3d8f
.set C342, 0x3dac
.set C343, 0x3dc9
.set C344, 0x3de5
.set C345, 0x3e01
.set C346, 0x3e0f
.set C347, 0x3e1d
.set C348, 0x3e2c
.set C349, 0x3e3a
.set C350, 0x3e48
.set C351, 0x3e56
.set C352, 0x3e64
.set C353, 0x3e72
.set C354, 0x3e80
.set C355, 0x3e87
.set C356, 0x3e8e
.set C357, 0x3e95
.set C358, 0x3e9b
.set C359, 0x3ea2
.set C360, 0x3ea9
.set C361, 0x3eb0
.set C362, 0x3eb7
.set C363, 0x3ebd
.set C364, 0x3ec4
.set C365, 0x3ecb
.set C366, 0x3ed1
.set C367, 0x3ed8
.set C368, 0x3ede
.set C369, 0x3ee5
.set C370, 0x3eeb
.set C371, 0x3ef1
.set C372, 0x3ef8
.set C373, 0x3efe
.set C374, 0x3f02
.set C375, 0x3f05
.set C376, 0x3f08
.set C377, 0x3f0b
.set C378, 0x3f0e
.set C379, 0x3f11
.set C380, 0x3f14
.set C381, 0x3f17
.set C382, 0x3f1a
.set C383, 0x3f1d
.set C384, 0x3f20
.set C385, 0x3f22
.set C386, 0x3f25
.set C387, 0x3f28
.set C388, 0x3f2b
.set C389, 0x3f2d
.set C390, 0x3f30
.set C391, 0x3f32
.set C392, 0x3f35
.set C393, 0x3f38
.set C394, 0x3f3a
.set C395, 0x3f3c
.set C396, 0x3f3f
.set C397, 0x3f41
.set C398, 0x3f44
.set C399, 0x3f46
.set C400, 0x3f48
.set C401, 0x3f4a
.set C402, 0x3f4d
.set C403, 0x3f4f
.set C404, 0x3f51
.set C405, 0x3f53
.set C406, 0x3f55
.set C407, 0x3f57
.set C408, 0x3f59
.set C409, 0x3f5b
.set C410, 0x3f5c
.set C411, 0x3f5e
.set C412, 0x3f60
.set C413, 0x3f62
.set C414, 0x3f63
.set C415, 0x3f65
.set C416, 0x3f67
.set C417, 0x3f68
.set C418, 0x3f6a
.set C419, 0x3f6b
.set C420, 0x3f6d
.set C421, 0x3f6e
.set C422, 0x3f6f
.set C423, 0x3f70
.set C424, 0x3f72
.set C425, 0x3f73
.set C426, 0x3f74
.set C427, 0x3f75
.set C428, 0x3f76
.set C429, 0x3f77
.set C430, 0x3f78
.set C431, 0x3f79
.set C432, 0x3f7a
.set C433, 0x3f7a
.set C434, 0x3f7b
.set C435, 0x3f7c
.set C436, 0x3f7c
.set C437, 0x3f7d
.set C438, 0x3f7d
.set C439, 0x3f7e
.set C440, 0x3f7e
.set C441, 0x3f7f
.set C442, 0x3f7f
.set C443, 0x3f7f
.set C444, 0x3f80
.set C445, 0x3f80
.set C446, 0x3f80
.set C447, 0x3f80
.altmacro
.macro emit i
.short C\i
.endm
.macro emitF
emit %((dd*((kp>>1)+224*((kp==1)&1))+112*(kp&1)*((kp!=1)&1))%448)
.endm
.p2align 8
tabF:
.set dd, 0
.rept 448
.set kp, 0
.rept 448
emitF
.set kp, kp+1
.endr
.set dd, dd+1
.endr
.p2align 8
tabFI:
.set n, 0
.rept 392
.set l, 0
.rept 64
.set e, 0
.rept 8
.set dd, 32*(n/28)+(l&31)
.set kp, 16*(n%28)+8*(e>>2)+4*(l>>5)+(e&3)
emitF
.set e, e+1
.endr
.set l, l+1
.endr
.set n, n+1
.endr
.noaltmacro
```
